```python
import torch

def _softmax(x, axis=-1):
    return torch.softmax(x, dim=axis)

def _gelu(x):
    return torch.nn.functional.gelu(x, approximate='tanh')

def _silu(x):
    return torch.nn.functional.silu(x)

def _sigmoid(x):
    return torch.sigmoid(x)

def _layernorm(x, axis=-1, eps=1e-05):
    m = x.mean(dim=axis, keepdim=True)
    v = x.var(dim=axis, keepdim=True, unbiased=False)
    return (x - m) / torch.sqrt(v + eps)

def _scatter_add(tgt, idx, src, axis=0):
    return tgt.clone().index_add_(axis, idx, src)

def _segment_sum(src, seg, n):
    out = torch.zeros((n,) + src.shape[1:], dtype=src.dtype)
    return out.index_add_(0, seg, src)

def _pad(x, pw):
    flat = tuple((v for pair in reversed(pw) for v in pair))
    return torch.nn.functional.pad(x, flat)
kernel_name = 'interleave_layers__memory_aug_recurrent_mem_tr__spectral_gfnet__prompt'

def setup_inputs():

    _w = lambda a: (lambda t: t.to(torch.bfloat16) if t.is_floating_point() else t)(torch.as_tensor(a))

    def _A_setup():
        B, S, Dm = (1, 2048, 448)
        H, Dh = (16, 256)
        M, seg = (8, 32)
        seg = min(seg, S)
        S = S // seg * seg
        return {'x': _w((lambda *s: torch.randn(*s, dtype=torch.bfloat16) * 0.05)(B, S, Dm)), 'mem0': _w((lambda *s: torch.randn(*s, dtype=torch.bfloat16) * 0.2)(B, M, Dm)), 'Wq': _w((lambda *s: torch.randn(*s, dtype=torch.bfloat16) * 1.6)(Dm, H, Dh) * Dm ** (-0.5)), 'Wk': _w((lambda *s: torch.randn(*s, dtype=torch.bfloat16) * 1.6)(Dm, H, Dh) * Dm ** (-0.5)), 'Wv': _w((lambda *s: torch.randn(*s, dtype=torch.bfloat16) * 0.2)(Dm, H, Dh) * Dm ** (-0.5)), 'Wo': _w((lambda *s: torch.randn(*s, dtype=torch.bfloat16) * 0.2)(H, Dh, Dm) * (H * Dh) ** (-0.5)), 'seg_len': seg}
    _A_in = _A_setup()

    def _B_setup():
        B, S, D = (1, 2048, 448)
        Df = D // 2 + 1
        return {'x': _w((lambda *s: torch.randn(*s, dtype=torch.bfloat16) * 0.05)(B, S, D)), 'w_r': _w((lambda *s: torch.randn(*s, dtype=torch.bfloat16) * 0.4)(S, Df) * 0.02), 'w_i': _w((lambda *s: torch.randn(*s, dtype=torch.bfloat16) * 0.4)(S, Df) * 0.02)}
    _B_in = _B_setup()
    return {'A_x': _A_in['x'], 'A_mem0': _A_in['mem0'], 'A_Wq': _A_in['Wq'], 'A_Wk': _A_in['Wk'], 'A_Wv': _A_in['Wv'], 'A_Wo': _A_in['Wo'], 'A_seg_len': _A_in['seg_len'], 'B_x': _B_in['x'], 'B_w_r': _B_in['w_r'], 'B_w_i': _B_in['w_i']}

def reference(A_x, A_mem0, A_Wq, A_Wk, A_Wv, A_Wo, A_seg_len, B_x, B_w_r, B_w_i):

    def _A_ref(x, mem0, Wq, Wk, Wv, Wo, seg_len):
        B, S, Dm = x.shape
        H, Dh = (Wq.shape[1], Wq.shape[2])
        M = mem0.shape[1]
        scale = Dh ** (-0.5)
        n_seg = S // seg_len
        L = M + seg_len
        idx = torch.arange(L)
        mask = (idx[:, None] < M) | (idx[:, None] >= idx[None, :])
        mem = mem0
        outs = []
        for s in range(n_seg):
            xs = x[:, s * seg_len:(s + 1) * seg_len, :].clone()
            h = torch.concatenate([mem, xs], axis=1)
            q = torch.einsum('btd,dhe->bhte', h, Wq)
            k = torch.einsum('btd,dhe->bhte', h, Wk)
            v = torch.einsum('btd,dhe->bhte', h, Wv)
            scores = torch.einsum('bhqe,bhke->bhqk', q, k) * scale
            scores = torch.where(mask[None, None], scores, -1000000000.0)
            p = _softmax(scores, axis=-1)
            o = torch.einsum('bhqk,bhke->bhqe', p, v)
            o = torch.einsum('bhte,hed->btd', o, Wo)
            mem = o[:, :M, :].clone()
            outs.append(o[:, M:, :])
        return torch.concatenate(outs, axis=1)

    def _B_ref(x, w_r, w_i):
        B, S, D = x.shape
        X = (lambda x, axes=(-2, -1): torch.fft.rfft2(x.float(), dim=axes))(x, axes=(-2, -1))
        W = w_r + 1j * w_i
        X = X * W
        y = (lambda x, s, axes=(-2, -1): torch.fft.irfft2(x, s=s, dim=axes).to(torch.bfloat16))(X, (S, D), axes=(-2, -1))
        return y
    x = A_x
    x = x + _A_ref(_layernorm(x, axis=-1), A_mem0, A_Wq, A_Wk, A_Wv, A_Wo, A_seg_len)
    x = x + _B_ref(_layernorm(x, axis=-1), B_w_r, B_w_i)
    x = x + _A_ref(_layernorm(x, axis=-1), A_mem0, A_Wq, A_Wk, A_Wv, A_Wo, A_seg_len)
    x = x + _B_ref(_layernorm(x, axis=-1), B_w_r, B_w_i)
    return x
```

```asm
; @launch grid=(256,1,1) block=(256,1,1) lds=163840
.amdgcn_target "amdgcn-amd-amdhsa--gfx950"
.text
.globl interleave_layers__memory_aug_recurrent_mem_tr__spectral_gfnet__prompt_kernel
.p2align 8
.type interleave_layers__memory_aug_recurrent_mem_tr__spectral_gfnet__prompt_kernel,@function
interleave_layers__memory_aug_recurrent_mem_tr__spectral_gfnet__prompt_kernel:
 s_mov_b32 s3, 0
 s_cmp_ge_u32 s2, 256
 s_cbranch_scc1 ka_end
 s_load_dwordx2 s[4:5], s[0:1], 96
 v_lshrrev_b32 v1, 6, v0
 s_nop 0
 v_readfirstlane_b32 s6, v1
 s_waitcnt lgkmcnt(0)
 s_load_dwordx2 s[56:57], s[0:1], 88
 s_getreg_b32 s8, hwreg(HW_REG_XCC_ID, 0, 4)
 s_and_b32 s8, s8, 7
 s_lshl_b32 s8, s8, 5
 v_mov_b32 v3, s8
 v_mov_b32 v4, 1
 s_waitcnt lgkmcnt(0)
 s_cmp_eq_u32 s6, 0
 s_cbranch_scc0 ka_ft_2
 s_mov_b64 exec, 1
 global_atomic_add v250, v3, v4, s[56:57] sc0 sc1
 s_mov_b64 exec, -1
ka_ft_2:
 s_cmp_eq_u32 s2, 0
 s_cbranch_scc0 ka_fz_1
 s_cmp_eq_u32 s6, 1
 s_cbranch_scc0 ka_fz_1
 v_and_b32 v3, 63, v0
 v_lshlrev_b32 v3, 4, v3
 v_add_u32 v3, 24150016, v3
 v_mov_b32 v4, 0
 v_mov_b32 v5, 0
 v_mov_b32 v6, 0
 v_mov_b32 v7, 0
 global_store_dwordx4 v3, v[4:7], s[4:5] sc1
ka_fz_1:
 v_and_b32 v1, 63, v0
 v_lshlrev_b32 v2, 4, v1
 v_and_b32 v3, 15, v1
 v_lshrrev_b32 v4, 4, v1
 s_load_dwordx2 s[16:17], s[0:1], 16
 s_load_dwordx2 s[46:47], s[0:1], 32
 s_load_dwordx2 s[20:21], s[0:1], 24
 s_load_dwordx2 s[48:49], s[0:1], 40
 s_load_dwordx2 s[52:53], s[0:1], 0
 s_load_dwordx2 s[36:37], s[0:1], 8

 s_and_b32 s8, s2, 7
 s_lshr_b32 s9, s2, 3
 s_lshr_b32 s10, s9, 3
 s_lshl_b32 s10, s10, 3
 s_add_u32 s8, s8, s10
 s_lshr_b32 s10, s8, 3
 s_and_b32 s8, s8, 7
 s_lshl_b32 s8, s8, 1
 s_and_b32 s11, s10, 1
 s_add_u32 s8, s8, s11
 s_lshr_b32 s10, s10, 1
 s_lshl_b32 s10, s10, 4
 s_add_u32 s8, s8, s10
 s_lshr_b32 s40, s8, 4
 s_and_b32 s41, s8, 15
 s_bfe_u32 s42, s9, 0x10002
 s_and_b32 s43, s9, 3
 s_lshl_b32 s50, s6, 14
 s_add_u32 s50, s50, 98304
 s_mov_b32 s54, 1835008
 s_mov_b32 s55, 0x20000
 s_mov_b32 s38, 7168
 s_mov_b32 s39, 0x20000
 s_waitcnt lgkmcnt(0)
 s_cmp_eq_u32 s40, 0
 s_cselect_b32 s16, s16, s46
 s_cselect_b32 s17, s17, s47
 s_cselect_b32 s20, s20, s48
 s_cselect_b32 s21, s21, s49
 s_mov_b32 s18, 3670016
 s_mov_b32 s19, 0x20000
 s_mov_b32 s22, 3670016
 s_mov_b32 s23, 0x20000
 s_cmp_lg_u32 s6, 3
 s_cbranch_scc1 ka_x0_3
 v_lshrrev_b32 v10, 3, v1
 s_lshl_b32 s8, s2, 3
 v_add_u32 v10, s8, v10
 v_mul_u32_u24 v10, 896, v10
 v_and_b32 v11, 7, v1
 v_lshl_add_u32 v10, v11, 4, v10
 buffer_load_dwordx4 v[144:147], v10, s[52:55], 0 offen offset:0
 buffer_load_dwordx4 v[148:151], v10, s[52:55], 0 offen offset:128
 buffer_load_dwordx4 v[152:155], v10, s[52:55], 0 offen offset:256
 buffer_load_dwordx4 v[156:159], v10, s[52:55], 0 offen offset:384
 buffer_load_dwordx4 v[160:163], v10, s[52:55], 0 offen offset:512
 buffer_load_dwordx4 v[164:167], v10, s[52:55], 0 offen offset:640
 buffer_load_dwordx4 v[168:171], v10, s[52:55], 0 offen offset:768
ka_x0_3:
 v_mov_b32 v133, 0x40000000
 s_cmp_ge_u32 s2, 7
 s_cbranch_scc1 ka_m0_4
 s_lshl_b32 s8, s2, 8
 v_add_u32 v10, s8, v0
 v_mul_u32_u24 v11, 2341, v10
 v_lshrrev_b32 v11, 20, v11
 v_mul_u32_u24 v12, 448, v11
 v_cmp_gt_u32 vcc, 1792, v10
 v_sub_u32 v10, v10, v12
 v_lshrrev_b32 v12, 1, v11
 v_and_b32 v11, 1, v11
 s_mov_b32 s8, 46661632
 v_mul_lo_u32 v12, v12, s8
 s_mov_b32 s8, 466944
 v_mul_lo_u32 v11, v11, s8
 v_add_u32 v12, v12, v11
 v_lshl_add_u32 v12, v10, 4, v12
 v_mov_b32 v13, 0x40000000
 v_cndmask_b32 v133, v13, v12, vcc
 v_lshrrev_b32 v11, 6, v10
 v_lshlrev_b32 v11, 7, v11
 v_bfe_u32 v12, v10, 4, 2
 v_lshl_add_u32 v11, v12, 5, v11
 v_and_b32 v12, 1, v10
 v_lshl_add_u32 v11, v12, 2, v11
 v_bfe_u32 v12, v10, 1, 3
 v_mul_u32_u24 v12, 896, v12
 v_add_u32 v11, v11, v12
 v_cndmask_b32 v11, v13, v11, vcc
 buffer_load_dword v128, v11, s[36:39], 0 offen offset:0
 buffer_load_dword v129, v11, s[36:39], 0 offen offset:8
 buffer_load_dword v130, v11, s[36:39], 0 offen offset:16
 buffer_load_dword v131, v11, s[36:39], 0 offen offset:24
ka_m0_4:
 v_lshrrev_b32 v14, 2, v1
 v_and_b32 v15, 3, v1
 v_xor_b32 v15, v15, v4
 v_lshlrev_b32 v15, 4, v15
 s_cmp_lg_u32 s40, 0
 s_cbranch_scc1 ka_vo_5

 s_mul_i32 s8, s43, 7
 s_lshl_b32 s9, s6, 1
 s_add_u32 s8, s8, s9
 s_lshl_b32 s8, s8, 4
 v_add_u32 v10, s8, v14
 v_lshl_add_u32 v10, v10, 13, v15
 s_lshl_b32 s8, s41, 9
 v_add_u32 v10, s8, v10
 v_add_u32 v11, 131072, v10
 s_lshl_b32 s10, s42, 31
 s_add_u32 s8, s10, 0
 s_and_b32 s8, s8, 7
 s_lshl_b32 s9, s8, 10
 s_add_u32 s9, s9, s50
 s_add_u32 s9, s9, 0
 s_mov_b32 m0, s9
 s_lshl_b32 s8, s8, 6
 buffer_load_dwordx4 v10, s[20:23], s8 offen lds
 s_add_u32 s8, s10, 1
 s_and_b32 s8, s8, 7
 s_lshl_b32 s9, s8, 10
 s_add_u32 s9, s9, s50
 s_add_u32 s9, s9, 0
 s_mov_b32 m0, s9
 s_lshl_b32 s8, s8, 6
 buffer_load_dwordx4 v10, s[20:23], s8 offen lds
 s_add_u32 s8, s10, 2
 s_and_b32 s8, s8, 7
 s_lshl_b32 s9, s8, 10
 s_add_u32 s9, s9, s50
 s_add_u32 s9, s9, 0
 s_mov_b32 m0, s9
 s_lshl_b32 s8, s8, 6
 buffer_load_dwordx4 v10, s[20:23], s8 offen lds
 s_add_u32 s8, s10, 3
 s_and_b32 s8, s8, 7
 s_lshl_b32 s9, s8, 10
 s_add_u32 s9, s9, s50
 s_add_u32 s9, s9, 0
 s_mov_b32 m0, s9
 s_lshl_b32 s8, s8, 6
 buffer_load_dwordx4 v10, s[20:23], s8 offen lds
 s_add_u32 s8, s10, 4
 s_and_b32 s8, s8, 7
 s_lshl_b32 s9, s8, 10
 s_add_u32 s9, s9, s50
 s_add_u32 s9, s9, 0
 s_mov_b32 m0, s9
 s_lshl_b32 s8, s8, 6
 buffer_load_dwordx4 v10, s[20:23], s8 offen lds
 s_add_u32 s8, s10, 5
 s_and_b32 s8, s8, 7
 s_lshl_b32 s9, s8, 10
 s_add_u32 s9, s9, s50
 s_add_u32 s9, s9, 0
 s_mov_b32 m0, s9
 s_lshl_b32 s8, s8, 6
 buffer_load_dwordx4 v10, s[20:23], s8 offen lds
 s_add_u32 s8, s10, 6
 s_and_b32 s8, s8, 7
 s_lshl_b32 s9, s8, 10
 s_add_u32 s9, s9, s50
 s_add_u32 s9, s9, 0
 s_mov_b32 m0, s9
 s_lshl_b32 s8, s8, 6
 buffer_load_dwordx4 v10, s[20:23], s8 offen lds
 s_add_u32 s8, s10, 7
 s_and_b32 s8, s8, 7
 s_lshl_b32 s9, s8, 10
 s_add_u32 s9, s9, s50
 s_add_u32 s9, s9, 0
 s_mov_b32 m0, s9
 s_lshl_b32 s8, s8, 6
 buffer_load_dwordx4 v10, s[20:23], s8 offen lds
 s_cmp_eq_u32 s6, 3
 s_cbranch_scc1 ka_bd_6
 s_add_u32 s8, s10, 0
 s_and_b32 s8, s8, 7
 s_lshl_b32 s9, s8, 10
 s_add_u32 s9, s9, s50
 s_add_u32 s9, s9, 8192
 s_mov_b32 m0, s9
 s_lshl_b32 s8, s8, 6
 buffer_load_dwordx4 v11, s[20:23], s8 offen lds
 s_add_u32 s8, s10, 1
 s_and_b32 s8, s8, 7
 s_lshl_b32 s9, s8, 10
 s_add_u32 s9, s9, s50
 s_add_u32 s9, s9, 8192
 s_mov_b32 m0, s9
 s_lshl_b32 s8, s8, 6
 buffer_load_dwordx4 v11, s[20:23], s8 offen lds
 s_add_u32 s8, s10, 2
 s_and_b32 s8, s8, 7
 s_lshl_b32 s9, s8, 10
 s_add_u32 s9, s9, s50
 s_add_u32 s9, s9, 8192
 s_mov_b32 m0, s9
 s_lshl_b32 s8, s8, 6
 buffer_load_dwordx4 v11, s[20:23], s8 offen lds
 s_add_u32 s8, s10, 3
 s_and_b32 s8, s8, 7
 s_lshl_b32 s9, s8, 10
 s_add_u32 s9, s9, s50
 s_add_u32 s9, s9, 8192
 s_mov_b32 m0, s9
 s_lshl_b32 s8, s8, 6
 buffer_load_dwordx4 v11, s[20:23], s8 offen lds
 s_add_u32 s8, s10, 4
 s_and_b32 s8, s8, 7
 s_lshl_b32 s9, s8, 10
 s_add_u32 s9, s9, s50
 s_add_u32 s9, s9, 8192
 s_mov_b32 m0, s9
 s_lshl_b32 s8, s8, 6
 buffer_load_dwordx4 v11, s[20:23], s8 offen lds
 s_add_u32 s8, s10, 5
 s_and_b32 s8, s8, 7
 s_lshl_b32 s9, s8, 10
 s_add_u32 s9, s9, s50
 s_add_u32 s9, s9, 8192
 s_mov_b32 m0, s9
 s_lshl_b32 s8, s8, 6
 buffer_load_dwordx4 v11, s[20:23], s8 offen lds
 s_add_u32 s8, s10, 6
 s_and_b32 s8, s8, 7
 s_lshl_b32 s9, s8, 10
 s_add_u32 s9, s9, s50
 s_add_u32 s9, s9, 8192
 s_mov_b32 m0, s9
 s_lshl_b32 s8, s8, 6
 buffer_load_dwordx4 v11, s[20:23], s8 offen lds
 s_add_u32 s8, s10, 7
 s_and_b32 s8, s8, 7
 s_lshl_b32 s9, s8, 10
 s_add_u32 s9, s9, s50
 s_add_u32 s9, s9, 8192
 s_mov_b32 m0, s9
 s_lshl_b32 s8, s8, 6
 buffer_load_dwordx4 v11, s[20:23], s8 offen lds
 s_branch ka_bd_6
ka_vo_5:
 v_lshrrev_b32 v10, 2, v1
 s_lshl_b32 s8, s41, 8
 v_add_u32 v10, s8, v10
 v_mul_u32_u24 v10, 896, v10
 v_and_b32 v11, 3, v1
 v_lshl_add_u32 v10, v11, 4, v10
 s_mul_i32 s8, s43, 224
 s_lshl_b32 s9, s6, 6
 s_add_u32 s8, s8, s9
 v_add_u32 v10, s8, v10
 s_lshl_b32 s10, s42, 31
 s_add_u32 s8, s10, 0
 s_and_b32 s8, s8, 15
 s_lshl_b32 s9, s8, 10
 s_add_u32 s9, s9, s50
 s_mov_b32 m0, s9
 s_mul_i32 s8, s8, 14336
 buffer_load_dwordx4 v10, s[20:23], s8 offen lds
 s_add_u32 s8, s10, 1
 s_and_b32 s8, s8, 15
 s_lshl_b32 s9, s8, 10
 s_add_u32 s9, s9, s50
 s_mov_b32 m0, s9
 s_mul_i32 s8, s8, 14336
 buffer_load_dwordx4 v10, s[20:23], s8 offen lds
 s_add_u32 s8, s10, 2
 s_and_b32 s8, s8, 15
 s_lshl_b32 s9, s8, 10
 s_add_u32 s9, s9, s50
 s_mov_b32 m0, s9
 s_mul_i32 s8, s8, 14336
 buffer_load_dwordx4 v10, s[20:23], s8 offen lds
 s_add_u32 s8, s10, 3
 s_and_b32 s8, s8, 15
 s_lshl_b32 s9, s8, 10
 s_add_u32 s9, s9, s50
 s_mov_b32 m0, s9
 s_mul_i32 s8, s8, 14336
 buffer_load_dwordx4 v10, s[20:23], s8 offen lds
 s_add_u32 s8, s10, 4
 s_and_b32 s8, s8, 15
 s_lshl_b32 s9, s8, 10
 s_add_u32 s9, s9, s50
 s_mov_b32 m0, s9
 s_mul_i32 s8, s8, 14336
 buffer_load_dwordx4 v10, s[20:23], s8 offen lds
 s_add_u32 s8, s10, 5
 s_and_b32 s8, s8, 15
 s_lshl_b32 s9, s8, 10
 s_add_u32 s9, s9, s50
 s_mov_b32 m0, s9
 s_mul_i32 s8, s8, 14336
 buffer_load_dwordx4 v10, s[20:23], s8 offen lds
 s_add_u32 s8, s10, 6
 s_and_b32 s8, s8, 15
 s_lshl_b32 s9, s8, 10
 s_add_u32 s9, s9, s50
 s_mov_b32 m0, s9
 s_mul_i32 s8, s8, 14336
 buffer_load_dwordx4 v10, s[20:23], s8 offen lds
 s_add_u32 s8, s10, 7
 s_and_b32 s8, s8, 15
 s_lshl_b32 s9, s8, 10
 s_add_u32 s9, s9, s50
 s_mov_b32 m0, s9
 s_mul_i32 s8, s8, 14336
 buffer_load_dwordx4 v10, s[20:23], s8 offen lds
 s_add_u32 s8, s10, 8
 s_and_b32 s8, s8, 15
 s_lshl_b32 s9, s8, 10
 s_add_u32 s9, s9, s50
 s_mov_b32 m0, s9
 s_mul_i32 s8, s8, 14336
 buffer_load_dwordx4 v10, s[20:23], s8 offen lds
 s_add_u32 s8, s10, 9
 s_and_b32 s8, s8, 15
 s_lshl_b32 s9, s8, 10
 s_add_u32 s9, s9, s50
 s_mov_b32 m0, s9
 s_mul_i32 s8, s8, 14336
 buffer_load_dwordx4 v10, s[20:23], s8 offen lds
 s_add_u32 s8, s10, 10
 s_and_b32 s8, s8, 15
 s_lshl_b32 s9, s8, 10
 s_add_u32 s9, s9, s50
 s_mov_b32 m0, s9
 s_mul_i32 s8, s8, 14336
 buffer_load_dwordx4 v10, s[20:23], s8 offen lds
 s_add_u32 s8, s10, 11
 s_and_b32 s8, s8, 15
 s_lshl_b32 s9, s8, 10
 s_add_u32 s9, s9, s50
 s_mov_b32 m0, s9
 s_mul_i32 s8, s8, 14336
 buffer_load_dwordx4 v10, s[20:23], s8 offen lds
 s_add_u32 s8, s10, 12
 s_and_b32 s8, s8, 15
 s_lshl_b32 s9, s8, 10
 s_add_u32 s9, s9, s50
 s_mov_b32 m0, s9
 s_mul_i32 s8, s8, 14336
 buffer_load_dwordx4 v10, s[20:23], s8 offen lds
 s_add_u32 s8, s10, 13
 s_and_b32 s8, s8, 15
 s_lshl_b32 s9, s8, 10
 s_add_u32 s9, s9, s50
 s_mov_b32 m0, s9
 s_mul_i32 s8, s8, 14336
 buffer_load_dwordx4 v10, s[20:23], s8 offen lds
 s_add_u32 s8, s10, 14
 s_and_b32 s8, s8, 15
 s_lshl_b32 s9, s8, 10
 s_add_u32 s9, s9, s50
 s_mov_b32 m0, s9
 s_mul_i32 s8, s8, 14336
 buffer_load_dwordx4 v10, s[20:23], s8 offen lds
 s_add_u32 s8, s10, 15
 s_and_b32 s8, s8, 15
 s_lshl_b32 s9, s8, 10
 s_add_u32 s9, s9, s50
 s_mov_b32 m0, s9
 s_mul_i32 s8, s8, 14336
 buffer_load_dwordx4 v10, s[20:23], s8 offen lds
ka_bd_6:
 v_lshrrev_b32 v10, 2, v14
 v_lshlrev_b32 v10, 3, v10
 v_and_b32 v11, 3, v14
 v_add_u32 v10, v10, v11
 v_lshl_add_u32 v10, v10, 13, v15
 s_lshl_b32 s8, s41, 9
 s_mul_i32 s9, s42, 1835008
 s_add_u32 s8, s8, s9
 v_add_u32 v134, s8, v10
 v_add_u32 v135, 32768, v134
 s_lshl_b32 s10, s43, 31
 s_add_u32 s8, s10, 0
 s_and_b32 s8, s8, 15
 s_sub_u32 s9, s8, 7
 s_cmp_ge_u32 s8, 7
 s_cselect_b32 s88, s9, s8
 s_add_u32 s8, s10, 1
 s_and_b32 s8, s8, 15
 s_sub_u32 s9, s8, 7
 s_cmp_ge_u32 s8, 7
 s_cselect_b32 s89, s9, s8
 s_add_u32 s8, s10, 2
 s_and_b32 s8, s8, 15
 s_sub_u32 s9, s8, 7
 s_cmp_ge_u32 s8, 7
 s_cselect_b32 s90, s9, s8
 s_add_u32 s8, s10, 3
 s_and_b32 s8, s8, 15
 s_sub_u32 s9, s8, 7
 s_cmp_ge_u32 s8, 7
 s_cselect_b32 s91, s9, s8
 s_add_u32 s8, s10, 4
 s_and_b32 s8, s8, 15
 s_sub_u32 s9, s8, 7
 s_cmp_ge_u32 s8, 7
 s_cselect_b32 s92, s9, s8
 s_add_u32 s8, s10, 5
 s_and_b32 s8, s8, 15
 s_sub_u32 s9, s8, 7
 s_cmp_ge_u32 s8, 7
 s_cselect_b32 s93, s9, s8
 s_add_u32 s8, s10, 6
 s_and_b32 s8, s8, 15
 s_sub_u32 s9, s8, 7
 s_cmp_ge_u32 s8, 7
 s_cselect_b32 s94, s9, s8
 s_lshl_b32 s46, s6, 1
 s_add_u32 s46, s46, 0
 s_lshl_b32 s47, s46, 10
 s_add_u32 s47, s47, 0
 s_mov_b32 m0, s47
 s_lshl_b32 s46, s46, 6
 s_lshl_b32 s47, s88, 18
 s_add_u32 s46, s46, s47
 buffer_load_dwordx4 v134, s[16:19], s46 offen lds
 s_lshl_b32 s46, s6, 1
 s_add_u32 s46, s46, 1
 s_lshl_b32 s47, s46, 10
 s_add_u32 s47, s47, 0
 s_mov_b32 m0, s47
 s_lshl_b32 s46, s46, 6
 s_lshl_b32 s47, s88, 18
 s_add_u32 s46, s46, s47
 buffer_load_dwordx4 v134, s[16:19], s46 offen lds
 s_lshl_b32 s46, s6, 1
 s_add_u32 s46, s46, 0
 s_lshl_b32 s47, s46, 10
 s_add_u32 s47, s47, 8192
 s_mov_b32 m0, s47
 s_lshl_b32 s46, s46, 6
 s_lshl_b32 s47, s88, 18
 s_add_u32 s46, s46, s47
 buffer_load_dwordx4 v135, s[16:19], s46 offen lds
 s_lshl_b32 s46, s6, 1
 s_add_u32 s46, s46, 1
 s_lshl_b32 s47, s46, 10
 s_add_u32 s47, s47, 8192
 s_mov_b32 m0, s47
 s_lshl_b32 s46, s46, 6
 s_lshl_b32 s47, s88, 18
 s_add_u32 s46, s46, s47
 buffer_load_dwordx4 v135, s[16:19], s46 offen lds
 s_lshl_b32 s46, s6, 1
 s_add_u32 s46, s46, 0
 s_lshl_b32 s47, s46, 10
 s_add_u32 s47, s47, 16384
 s_mov_b32 m0, s47
 s_lshl_b32 s46, s46, 6
 s_lshl_b32 s47, s89, 18
 s_add_u32 s46, s46, s47
 buffer_load_dwordx4 v134, s[16:19], s46 offen lds
 s_lshl_b32 s46, s6, 1
 s_add_u32 s46, s46, 1
 s_lshl_b32 s47, s46, 10
 s_add_u32 s47, s47, 16384
 s_mov_b32 m0, s47
 s_lshl_b32 s46, s46, 6
 s_lshl_b32 s47, s89, 18
 s_add_u32 s46, s46, s47
 buffer_load_dwordx4 v134, s[16:19], s46 offen lds
 s_lshl_b32 s46, s6, 1
 s_add_u32 s46, s46, 0
 s_lshl_b32 s47, s46, 10
 s_add_u32 s47, s47, 24576
 s_mov_b32 m0, s47
 s_lshl_b32 s46, s46, 6
 s_lshl_b32 s47, s89, 18
 s_add_u32 s46, s46, s47
 buffer_load_dwordx4 v135, s[16:19], s46 offen lds
 s_lshl_b32 s46, s6, 1
 s_add_u32 s46, s46, 1
 s_lshl_b32 s47, s46, 10
 s_add_u32 s47, s47, 24576
 s_mov_b32 m0, s47
 s_lshl_b32 s46, s46, 6
 s_lshl_b32 s47, s89, 18
 s_add_u32 s46, s46, s47
 buffer_load_dwordx4 v135, s[16:19], s46 offen lds
 s_lshl_b32 s46, s6, 1
 s_add_u32 s46, s46, 0
 s_lshl_b32 s47, s46, 10
 s_add_u32 s47, s47, 32768
 s_mov_b32 m0, s47
 s_lshl_b32 s46, s46, 6
 s_lshl_b32 s47, s90, 18
 s_add_u32 s46, s46, s47
 buffer_load_dwordx4 v134, s[16:19], s46 offen lds
 s_lshl_b32 s46, s6, 1
 s_add_u32 s46, s46, 1
 s_lshl_b32 s47, s46, 10
 s_add_u32 s47, s47, 32768
 s_mov_b32 m0, s47
 s_lshl_b32 s46, s46, 6
 s_lshl_b32 s47, s90, 18
 s_add_u32 s46, s46, s47
 buffer_load_dwordx4 v134, s[16:19], s46 offen lds
 s_lshl_b32 s46, s6, 1
 s_add_u32 s46, s46, 0
 s_lshl_b32 s47, s46, 10
 s_add_u32 s47, s47, 40960
 s_mov_b32 m0, s47
 s_lshl_b32 s46, s46, 6
 s_lshl_b32 s47, s90, 18
 s_add_u32 s46, s46, s47
 buffer_load_dwordx4 v135, s[16:19], s46 offen lds
 s_lshl_b32 s46, s6, 1
 s_add_u32 s46, s46, 1
 s_lshl_b32 s47, s46, 10
 s_add_u32 s47, s47, 40960
 s_mov_b32 m0, s47
 s_lshl_b32 s46, s46, 6
 s_lshl_b32 s47, s90, 18
 s_add_u32 s46, s46, s47
 buffer_load_dwordx4 v135, s[16:19], s46 offen lds
 s_waitcnt vmcnt(12)
 s_cmp_eq_u32 s2, 0
 s_cbranch_scc0 ka_fi_10
 s_cmp_eq_u32 s6, 1
 s_cbranch_scc0 ka_fi_10
 s_mov_b64 exec, 1
 v_mov_b32 v10, 8
 v_mov_b32 v11, 1
 global_store_dword v10, v11, s[56:57] sc1
 s_mov_b64 exec, -1
ka_fi_10:
 s_cmp_lg_u32 s40, 0
 s_cbranch_scc1 ka_vo2_8

 v_lshrrev_b32 v10, 2, v3
 v_xor_b32 v10, v10, v4
 v_lshlrev_b32 v10, 4, v10
 v_lshl_add_u32 v10, v3, 6, v10
 v_add_u32 v7, s50, v10
 ds_read_b128 v[16:19], v7 offset:0
 ds_read_b128 v[20:23], v7 offset:1024
 ds_read_b128 v[24:27], v7 offset:2048
 ds_read_b128 v[28:31], v7 offset:3072
 ds_read_b128 v[32:35], v7 offset:4096
 ds_read_b128 v[36:39], v7 offset:5120
 ds_read_b128 v[40:43], v7 offset:6144
 ds_read_b128 v[44:47], v7 offset:7168
 ds_read_b128 v[48:51], v7 offset:8192
 ds_read_b128 v[52:55], v7 offset:9216
 ds_read_b128 v[56:59], v7 offset:10240
 ds_read_b128 v[60:63], v7 offset:11264
 ds_read_b128 v[64:67], v7 offset:12288
 ds_read_b128 v[68:71], v7 offset:13312
 ds_read_b128 v[72:75], v7 offset:14336
 ds_read_b128 v[76:79], v7 offset:15360
 s_branch ka_bd2_9
ka_vo2_8:
 v_lshrrev_b32 v10, 2, v3
 v_lshl_add_u32 v10, v4, 3, v10
 v_lshlrev_b32 v10, 6, v10
 v_and_b32 v11, 3, v3
 v_lshl_add_u32 v10, v11, 3, v10
 v_add_u32 v7, s50, v10
 ds_read_b64_tr_b16 v[16:17], v7 offset:0
 ds_read_b64_tr_b16 v[18:19], v7 offset:256
 ds_read_b64_tr_b16 v[20:21], v7 offset:2048
 ds_read_b64_tr_b16 v[22:23], v7 offset:2304
 ds_read_b64_tr_b16 v[24:25], v7 offset:4096
 ds_read_b64_tr_b16 v[26:27], v7 offset:4352
 ds_read_b64_tr_b16 v[28:29], v7 offset:6144
 ds_read_b64_tr_b16 v[30:31], v7 offset:6400
 ds_read_b64_tr_b16 v[32:33], v7 offset:8192
 ds_read_b64_tr_b16 v[34:35], v7 offset:8448
 ds_read_b64_tr_b16 v[36:37], v7 offset:10240
 ds_read_b64_tr_b16 v[38:39], v7 offset:10496
 ds_read_b64_tr_b16 v[40:41], v7 offset:12288
 ds_read_b64_tr_b16 v[42:43], v7 offset:12544
 ds_read_b64_tr_b16 v[44:45], v7 offset:14336
 ds_read_b64_tr_b16 v[46:47], v7 offset:14592
 ds_read_b64_tr_b16 v[48:49], v7 offset:32
 ds_read_b64_tr_b16 v[50:51], v7 offset:288
 ds_read_b64_tr_b16 v[52:53], v7 offset:2080
 ds_read_b64_tr_b16 v[54:55], v7 offset:2336
 ds_read_b64_tr_b16 v[56:57], v7 offset:4128
 ds_read_b64_tr_b16 v[58:59], v7 offset:4384
 ds_read_b64_tr_b16 v[60:61], v7 offset:6176
 ds_read_b64_tr_b16 v[62:63], v7 offset:6432
 ds_read_b64_tr_b16 v[64:65], v7 offset:8224
 ds_read_b64_tr_b16 v[66:67], v7 offset:8480
 ds_read_b64_tr_b16 v[68:69], v7 offset:10272
 ds_read_b64_tr_b16 v[70:71], v7 offset:10528
 ds_read_b64_tr_b16 v[72:73], v7 offset:12320
 ds_read_b64_tr_b16 v[74:75], v7 offset:12576
 ds_read_b64_tr_b16 v[76:77], v7 offset:14368
 ds_read_b64_tr_b16 v[78:79], v7 offset:14624
ka_bd2_9:

 s_mul_i32 s8, s41, 28
 s_mul_i32 s9, s43, 7
 s_add_u32 s8, s8, s9
 s_lshl_b32 s9, s6, 1
 s_add_u32 s8, s8, s9
 s_mul_i32 s8, s8, 14
 s_mul_i32 s9, s42, 7
 s_add_u32 s8, s8, s9
 s_lshl_b32 s8, s8, 10
 v_add_u32 v8, s8, v2
 v_add_u32 v9, 14336, v8
 v_mov_b32 v10, 0x40000000
 s_cmp_eq_u32 s6, 3
 s_cselect_b64 vcc, -1, 0
 v_cndmask_b32 v9, v9, v10, vcc
 s_cmp_eq_u32 s40, 0
 s_cselect_b64 vcc, -1, 0
 v_cndmask_b32 v112, v10, v8, vcc
 v_cndmask_b32 v113, v10, v9, vcc
 v_cndmask_b32 v8, v8, v10, vcc
 v_cndmask_b32 v9, v9, v10, vcc
 s_cmp_eq_u32 s40, 0
 s_cselect_b32 s44, 0x3db8aa3b, 0x3f800000
 s_mov_b32 s45, 0
 s_mul_i32 s8, s40, 6422528
 s_add_u32 s8, s8, 0
 s_add_u32 s24, s4, s8
 s_addc_u32 s25, s5, 0
 s_mov_b32 s26, 6422528
 s_mov_b32 s27, 0x20000

 v_lshrrev_b32 v10, 2, v3
 v_xor_b32 v10, v10, v4
 v_lshlrev_b32 v10, 4, v10
 v_lshl_add_u32 v5, v3, 6, v10
 v_add_u32 v7, 65536, v5
 s_cmp_eq_u32 s6, 3
 s_cbranch_scc1 ka_w3_11
 s_waitcnt lgkmcnt(0)
 s_waitcnt vmcnt(8)
 s_barrier
 ds_read_b128 v[80:83], v5 offset:0
 ds_read_b128 v[84:87], v5 offset:1024
 ds_read_b128 v[88:91], v5 offset:2048
 s_waitcnt lgkmcnt(2)
 v_mfma_f32_16x16x32_bf16 v[96:99], v[80:83], v[16:19], 0
 ds_read_b128 v[92:95], v5 offset:3072
 v_mfma_f32_16x16x32_bf16 v[104:107], v[80:83], v[48:51], 0
 s_lshl_b32 s46, s6, 1
 s_add_u32 s46, s46, 0
 s_lshl_b32 s47, s46, 10
 s_add_u32 s47, s47, 49152
 s_mov_b32 m0, s47
 s_lshl_b32 s46, s46, 6
 s_lshl_b32 s47, s91, 18
 s_add_u32 s46, s46, s47
 buffer_load_dwordx4 v134, s[16:19], s46 offen lds
 s_waitcnt lgkmcnt(2)
 v_mfma_f32_16x16x32_bf16 v[96:99], v[84:87], v[20:23], v[96:99]
 ds_read_b128 v[80:83], v5 offset:4096
 v_mfma_f32_16x16x32_bf16 v[104:107], v[84:87], v[52:55], v[104:107]
 s_lshl_b32 s46, s6, 1
 s_add_u32 s46, s46, 1
 s_lshl_b32 s47, s46, 10
 s_add_u32 s47, s47, 49152
 s_mov_b32 m0, s47
 s_lshl_b32 s46, s46, 6
 s_lshl_b32 s47, s91, 18
 s_add_u32 s46, s46, s47
 buffer_load_dwordx4 v134, s[16:19], s46 offen lds
 s_waitcnt lgkmcnt(2)
 v_mfma_f32_16x16x32_bf16 v[96:99], v[88:91], v[24:27], v[96:99]
 ds_read_b128 v[84:87], v5 offset:5120
 v_mfma_f32_16x16x32_bf16 v[104:107], v[88:91], v[56:59], v[104:107]
 s_lshl_b32 s46, s6, 1
 s_add_u32 s46, s46, 0
 s_lshl_b32 s47, s46, 10
 s_add_u32 s47, s47, 57344
 s_mov_b32 m0, s47
 s_lshl_b32 s46, s46, 6
 s_lshl_b32 s47, s91, 18
 s_add_u32 s46, s46, s47
 buffer_load_dwordx4 v135, s[16:19], s46 offen lds
 s_waitcnt lgkmcnt(2)
 v_mfma_f32_16x16x32_bf16 v[96:99], v[92:95], v[28:31], v[96:99]
 ds_read_b128 v[88:91], v5 offset:6144
 v_mfma_f32_16x16x32_bf16 v[104:107], v[92:95], v[60:63], v[104:107]
 s_lshl_b32 s46, s6, 1
 s_add_u32 s46, s46, 1
 s_lshl_b32 s47, s46, 10
 s_add_u32 s47, s47, 57344
 s_mov_b32 m0, s47
 s_lshl_b32 s46, s46, 6
 s_lshl_b32 s47, s91, 18
 s_add_u32 s46, s46, s47
 buffer_load_dwordx4 v135, s[16:19], s46 offen lds
 s_waitcnt lgkmcnt(2)
 v_mfma_f32_16x16x32_bf16 v[96:99], v[80:83], v[32:35], v[96:99]
 ds_read_b128 v[92:95], v5 offset:7168
 v_mfma_f32_16x16x32_bf16 v[104:107], v[80:83], v[64:67], v[104:107]
 s_add_u32 s32, s4, 55382016
 s_addc_u32 s33, s5, 0
 s_mov_b32 s34, 47135744
 s_mov_b32 s35, 0x20000
 buffer_store_dwordx4 v[128:131], v133, s[32:35], 0 offen sc1
 s_waitcnt lgkmcnt(2)
 v_mfma_f32_16x16x32_bf16 v[96:99], v[84:87], v[36:39], v[96:99]
 ds_read_b128 v[80:83], v5 offset:8192
 v_mfma_f32_16x16x32_bf16 v[104:107], v[84:87], v[68:71], v[104:107]
 v_mov_b32 v246, -1
 s_waitcnt lgkmcnt(2)
 v_mfma_f32_16x16x32_bf16 v[96:99], v[88:91], v[40:43], v[96:99]
 ds_read_b128 v[84:87], v5 offset:9216
 v_mfma_f32_16x16x32_bf16 v[104:107], v[88:91], v[72:75], v[104:107]
 v_mov_b32 v247, -1
 s_waitcnt lgkmcnt(2)
 v_mfma_f32_16x16x32_bf16 v[96:99], v[92:95], v[44:47], v[96:99]
 ds_read_b128 v[88:91], v5 offset:10240
 v_mfma_f32_16x16x32_bf16 v[104:107], v[92:95], v[76:79], v[104:107]
 v_mov_b32 v248, -1
 s_waitcnt lgkmcnt(2)
 v_mfma_f32_16x16x32_bf16 v[100:103], v[80:83], v[16:19], 0
 ds_read_b128 v[92:95], v5 offset:11264
 v_mfma_f32_16x16x32_bf16 v[108:111], v[80:83], v[48:51], 0
 v_mov_b32 v249, -1
 s_waitcnt lgkmcnt(2)
 v_mfma_f32_16x16x32_bf16 v[100:103], v[84:87], v[20:23], v[100:103]
 ds_read_b128 v[80:83], v5 offset:12288
 v_mfma_f32_16x16x32_bf16 v[108:111], v[84:87], v[52:55], v[108:111]
 s_mov_b32 s51, s2
 s_add_u32 s32, s4, 55389184
 s_addc_u32 s33, s5, 0
 s_mov_b32 s34, 458752
 s_mov_b32 s35, 0x20000
 s_mul_i32 s8, s51, 1792
 v_lshlrev_b32 v10, 4, v0
 s_waitcnt lgkmcnt(2)
 v_mfma_f32_16x16x32_bf16 v[100:103], v[88:91], v[24:27], v[100:103]
 ds_read_b128 v[84:87], v5 offset:13312
 v_mfma_f32_16x16x32_bf16 v[108:111], v[88:91], v[56:59], v[108:111]
 v_add_u32 v10, s8, v10
 s_waitcnt lgkmcnt(2)
 v_mfma_f32_16x16x32_bf16 v[100:103], v[92:95], v[28:31], v[100:103]
 ds_read_b128 v[88:91], v5 offset:14336
 v_mfma_f32_16x16x32_bf16 v[108:111], v[92:95], v[60:63], v[108:111]
 v_mov_b32 v11, 0x40000000
 s_waitcnt lgkmcnt(2)
 v_mfma_f32_16x16x32_bf16 v[100:103], v[80:83], v[32:35], v[100:103]
 ds_read_b128 v[92:95], v5 offset:15360
 v_mfma_f32_16x16x32_bf16 v[108:111], v[80:83], v[64:67], v[108:111]
 v_cmp_gt_u32 vcc, 112, v0
 s_waitcnt lgkmcnt(2)
 v_mfma_f32_16x16x32_bf16 v[100:103], v[84:87], v[36:39], v[100:103]
 s_waitcnt vmcnt(9)
 s_barrier
 ds_read_b128 v[80:83], v5 offset:16384
 v_mfma_f32_16x16x32_bf16 v[108:111], v[84:87], v[68:71], v[108:111]
 v_cndmask_b32 v10, v11, v10, vcc
 s_waitcnt lgkmcnt(2)
 v_mfma_f32_16x16x32_bf16 v[100:103], v[88:91], v[40:43], v[100:103]
 ds_read_b128 v[84:87], v5 offset:17408
 v_mfma_f32_16x16x32_bf16 v[108:111], v[88:91], v[72:75], v[108:111]
 buffer_store_dwordx4 v[246:249], v10, s[32:35], 0 offen sc1
 s_waitcnt lgkmcnt(2)
 v_mfma_f32_16x16x32_bf16 v[100:103], v[92:95], v[44:47], v[100:103]
 ds_read_b128 v[88:91], v5 offset:18432
 v_mfma_f32_16x16x32_bf16 v[108:111], v[92:95], v[76:79], v[108:111]
 s_add_u32 s32, s4, 55856128
 s_addc_u32 s33, s5, 0
 s_mov_b32 s34, 458752
 s_mov_b32 s35, 0x20000
 s_mul_i32 s8, s51, 1792
 v_lshlrev_b32 v10, 4, v0
 s_waitcnt lgkmcnt(2)
 v_mfma_f32_16x16x32_bf16 v[228:231], v[80:83], v[16:19], 0
 ds_read_b128 v[92:95], v5 offset:19456
 v_mfma_f32_16x16x32_bf16 v[236:239], v[80:83], v[48:51], 0
 s_lshl_b32 s46, s6, 1
 s_add_u32 s46, s46, 0
 s_lshl_b32 s47, s46, 10
 s_add_u32 s47, s47, 65536
 s_mov_b32 m0, s47
 s_lshl_b32 s46, s46, 6
 s_lshl_b32 s47, s92, 18
 s_add_u32 s46, s46, s47
 buffer_load_dwordx4 v134, s[16:19], s46 offen lds
 s_waitcnt lgkmcnt(2)
 v_mfma_f32_16x16x32_bf16 v[228:231], v[84:87], v[20:23], v[228:231]
 ds_read_b128 v[80:83], v5 offset:20480
 s_lshl_b32 s45, s88, 10
 v_mul_f32 v96, s44, v96
 v_mfma_f32_16x16x32_bf16 v[236:239], v[84:87], v[52:55], v[236:239]
 v_mul_f32 v97, s44, v97
 s_lshl_b32 s46, s6, 1
 s_add_u32 s46, s46, 1
 s_lshl_b32 s47, s46, 10
 s_add_u32 s47, s47, 65536
 s_mov_b32 m0, s47
 s_lshl_b32 s46, s46, 6
 s_lshl_b32 s47, s92, 18
 s_add_u32 s46, s46, s47
 buffer_load_dwordx4 v134, s[16:19], s46 offen lds
 s_waitcnt lgkmcnt(2)
 v_mfma_f32_16x16x32_bf16 v[228:231], v[88:91], v[24:27], v[228:231]
 ds_read_b128 v[84:87], v5 offset:21504
 v_mul_f32 v98, s44, v98
 v_mfma_f32_16x16x32_bf16 v[236:239], v[88:91], v[56:59], v[236:239]
 v_mul_f32 v99, s44, v99
 s_lshl_b32 s46, s6, 1
 s_add_u32 s46, s46, 0
 s_lshl_b32 s47, s46, 10
 s_add_u32 s47, s47, 73728
 s_mov_b32 m0, s47
 s_lshl_b32 s46, s46, 6
 s_lshl_b32 s47, s92, 18
 s_add_u32 s46, s46, s47
 buffer_load_dwordx4 v135, s[16:19], s46 offen lds
 s_waitcnt lgkmcnt(2)
 v_mfma_f32_16x16x32_bf16 v[228:231], v[92:95], v[28:31], v[228:231]
 ds_read_b128 v[88:91], v5 offset:22528
 v_mul_f32 v100, s44, v100
 v_mfma_f32_16x16x32_bf16 v[236:239], v[92:95], v[60:63], v[236:239]
 v_mul_f32 v101, s44, v101
 s_lshl_b32 s46, s6, 1
 s_add_u32 s46, s46, 1
 s_lshl_b32 s47, s46, 10
 s_add_u32 s47, s47, 73728
 s_mov_b32 m0, s47
 s_lshl_b32 s46, s46, 6
 s_lshl_b32 s47, s92, 18
 s_add_u32 s46, s46, s47
 buffer_load_dwordx4 v135, s[16:19], s46 offen lds
 s_waitcnt lgkmcnt(2)
 v_mfma_f32_16x16x32_bf16 v[228:231], v[80:83], v[32:35], v[228:231]
 ds_read_b128 v[92:95], v5 offset:23552
 v_mul_f32 v102, s44, v102
 v_mfma_f32_16x16x32_bf16 v[236:239], v[80:83], v[64:67], v[236:239]
 v_mul_f32 v103, s44, v103
 v_add_u32 v10, s8, v10
 s_waitcnt lgkmcnt(2)
 v_mfma_f32_16x16x32_bf16 v[228:231], v[84:87], v[36:39], v[228:231]
 ds_read_b128 v[80:83], v5 offset:24576
 v_cvt_pk_bf16_f32 v144, v96, v97
 v_mfma_f32_16x16x32_bf16 v[236:239], v[84:87], v[68:71], v[236:239]
 v_cvt_pk_bf16_f32 v145, v98, v99
 v_mov_b32 v11, 0x40000000
 s_waitcnt lgkmcnt(2)
 v_mfma_f32_16x16x32_bf16 v[228:231], v[88:91], v[40:43], v[228:231]
 ds_read_b128 v[84:87], v5 offset:25600
 v_cvt_pk_bf16_f32 v146, v100, v101
 v_mfma_f32_16x16x32_bf16 v[236:239], v[88:91], v[72:75], v[236:239]
 v_cvt_pk_bf16_f32 v147, v102, v103
 v_cmp_gt_u32 vcc, 112, v0
 s_waitcnt lgkmcnt(2)
 v_mfma_f32_16x16x32_bf16 v[228:231], v[92:95], v[44:47], v[228:231]
 ds_read_b128 v[88:91], v5 offset:26624
 buffer_store_dwordx4 v[144:147], v8, s[24:27], s45 offen sc1
 v_mfma_f32_16x16x32_bf16 v[236:239], v[92:95], v[76:79], v[236:239]
 v_mul_f32 v104, s44, v104
 v_cndmask_b32 v10, v11, v10, vcc
 s_waitcnt lgkmcnt(2)
 v_mfma_f32_16x16x32_bf16 v[232:235], v[80:83], v[16:19], 0
 ds_read_b128 v[92:95], v5 offset:27648
 v_mul_f32 v105, s44, v105
 v_mfma_f32_16x16x32_bf16 v[240:243], v[80:83], v[48:51], 0
 v_mul_f32 v106, s44, v106
 buffer_store_dwordx4 v[246:249], v10, s[32:35], 0 offen sc1
 s_waitcnt lgkmcnt(2)
 v_mfma_f32_16x16x32_bf16 v[232:235], v[84:87], v[20:23], v[232:235]
 ds_read_b128 v[80:83], v5 offset:28672
 v_mul_f32 v107, s44, v107
 v_mfma_f32_16x16x32_bf16 v[240:243], v[84:87], v[52:55], v[240:243]
 v_mul_f32 v108, s44, v108
 s_add_u32 s32, s4, 56315904
 s_addc_u32 s33, s5, 0
 s_mov_b32 s34, 786432
 s_mov_b32 s35, 0x20000
 s_mul_i32 s8, s51, 3072
 v_lshlrev_b32 v10, 4, v0
 s_waitcnt lgkmcnt(2)
 v_mfma_f32_16x16x32_bf16 v[232:235], v[88:91], v[24:27], v[232:235]
 ds_read_b128 v[84:87], v5 offset:29696
 v_mul_f32 v109, s44, v109
 v_mfma_f32_16x16x32_bf16 v[240:243], v[88:91], v[56:59], v[240:243]
 v_mul_f32 v110, s44, v110
 v_add_u32 v10, s8, v10
 s_waitcnt lgkmcnt(2)
 v_mfma_f32_16x16x32_bf16 v[232:235], v[92:95], v[28:31], v[232:235]
 ds_read_b128 v[88:91], v5 offset:30720
 v_mul_f32 v111, s44, v111
 v_mfma_f32_16x16x32_bf16 v[240:243], v[92:95], v[60:63], v[240:243]
 v_cvt_pk_bf16_f32 v148, v104, v105
 v_mov_b32 v11, 0x40000000
 s_waitcnt lgkmcnt(2)
 v_mfma_f32_16x16x32_bf16 v[232:235], v[80:83], v[32:35], v[232:235]
 ds_read_b128 v[92:95], v5 offset:31744
 v_cvt_pk_bf16_f32 v149, v106, v107
 v_mfma_f32_16x16x32_bf16 v[240:243], v[80:83], v[64:67], v[240:243]
 v_cvt_pk_bf16_f32 v150, v108, v109
 v_cmp_gt_u32 vcc, 192, v0
 s_waitcnt lgkmcnt(2)
 v_mfma_f32_16x16x32_bf16 v[232:235], v[84:87], v[36:39], v[232:235]
 s_waitcnt vmcnt(12)
 s_barrier
 ds_read_b128 v[80:83], v5 offset:32768
 v_cvt_pk_bf16_f32 v151, v110, v111
 v_mfma_f32_16x16x32_bf16 v[240:243], v[84:87], v[68:71], v[240:243]
 buffer_store_dwordx4 v[148:151], v9, s[24:27], s45 offen sc1
 v_cndmask_b32 v10, v11, v10, vcc
 s_waitcnt lgkmcnt(2)
 v_mfma_f32_16x16x32_bf16 v[232:235], v[88:91], v[40:43], v[232:235]
 ds_read_b128 v[84:87], v5 offset:33792
 v_mfma_f32_16x16x32_bf16 v[240:243], v[88:91], v[72:75], v[240:243]
 buffer_store_dwordx4 v[246:249], v10, s[32:35], 0 offen sc1
 s_waitcnt lgkmcnt(2)
 v_mfma_f32_16x16x32_bf16 v[232:235], v[92:95], v[44:47], v[232:235]
 ds_read_b128 v[88:91], v5 offset:34816
 v_mfma_f32_16x16x32_bf16 v[240:243], v[92:95], v[76:79], v[240:243]
 s_lshr_b32 s8, s2, 3
 s_mul_i32 s8, s8, 46661632
 s_and_b32 s9, s2, 7
 s_lshl_b32 s9, s9, 12
 s_add_u32 s8, s8, s9
 v_lshlrev_b32 v10, 4, v0
 s_waitcnt lgkmcnt(2)
 v_mfma_f32_16x16x32_bf16 v[96:99], v[80:83], v[16:19], 0
 ds_read_b128 v[92:95], v5 offset:35840
 v_mfma_f32_16x16x32_bf16 v[104:107], v[80:83], v[48:51], 0
 s_lshl_b32 s46, s6, 1
 s_add_u32 s46, s46, 0
 s_lshl_b32 s47, s46, 10
 s_add_u32 s47, s47, 81920
 s_mov_b32 m0, s47
 s_lshl_b32 s46, s46, 6
 s_lshl_b32 s47, s93, 18
 s_add_u32 s46, s46, s47
 buffer_load_dwordx4 v134, s[16:19], s46 offen lds
 s_waitcnt lgkmcnt(2)
 v_mfma_f32_16x16x32_bf16 v[96:99], v[84:87], v[20:23], v[96:99]
 ds_read_b128 v[80:83], v5 offset:36864
 s_lshl_b32 s45, s89, 10
 v_mul_f32 v228, s44, v228
 v_mfma_f32_16x16x32_bf16 v[104:107], v[84:87], v[52:55], v[104:107]
 v_mul_f32 v229, s44, v229
 s_lshl_b32 s46, s6, 1
 s_add_u32 s46, s46, 1
 s_lshl_b32 s47, s46, 10
 s_add_u32 s47, s47, 81920
 s_mov_b32 m0, s47
 s_lshl_b32 s46, s46, 6
 s_lshl_b32 s47, s93, 18
 s_add_u32 s46, s46, s47
 buffer_load_dwordx4 v134, s[16:19], s46 offen lds
 s_waitcnt lgkmcnt(2)
 v_mfma_f32_16x16x32_bf16 v[96:99], v[88:91], v[24:27], v[96:99]
 ds_read_b128 v[84:87], v5 offset:37888
 v_mul_f32 v230, s44, v230
 v_mfma_f32_16x16x32_bf16 v[104:107], v[88:91], v[56:59], v[104:107]
 v_mul_f32 v231, s44, v231
 s_lshl_b32 s46, s6, 1
 s_add_u32 s46, s46, 0
 s_lshl_b32 s47, s46, 10
 s_add_u32 s47, s47, 90112
 s_mov_b32 m0, s47
 s_lshl_b32 s46, s46, 6
 s_lshl_b32 s47, s93, 18
 s_add_u32 s46, s46, s47
 buffer_load_dwordx4 v135, s[16:19], s46 offen lds
 s_waitcnt lgkmcnt(2)
 v_mfma_f32_16x16x32_bf16 v[96:99], v[92:95], v[28:31], v[96:99]
 ds_read_b128 v[88:91], v5 offset:38912
 v_mul_f32 v232, s44, v232
 v_mfma_f32_16x16x32_bf16 v[104:107], v[92:95], v[60:63], v[104:107]
 v_mul_f32 v233, s44, v233
 s_lshl_b32 s46, s6, 1
 s_add_u32 s46, s46, 1
 s_lshl_b32 s47, s46, 10
 s_add_u32 s47, s47, 90112
 s_mov_b32 m0, s47
 s_lshl_b32 s46, s46, 6
 s_lshl_b32 s47, s93, 18
 s_add_u32 s46, s46, s47
 buffer_load_dwordx4 v135, s[16:19], s46 offen lds
 s_waitcnt lgkmcnt(2)
 v_mfma_f32_16x16x32_bf16 v[96:99], v[80:83], v[32:35], v[96:99]
 ds_read_b128 v[92:95], v5 offset:39936
 v_mul_f32 v234, s44, v234
 v_mfma_f32_16x16x32_bf16 v[104:107], v[80:83], v[64:67], v[104:107]
 v_mul_f32 v235, s44, v235
 v_add_u32 v10, s8, v10
 s_waitcnt lgkmcnt(2)
 v_mfma_f32_16x16x32_bf16 v[96:99], v[84:87], v[36:39], v[96:99]
 ds_read_b128 v[80:83], v5 offset:40960
 v_cvt_pk_bf16_f32 v152, v228, v229
 v_mfma_f32_16x16x32_bf16 v[104:107], v[84:87], v[68:71], v[104:107]
 v_cvt_pk_bf16_f32 v153, v230, v231
 s_cmp_lt_u32 s2, 16
 s_cselect_b64 vcc, -1, 0
 v_mov_b32 v11, 0x40000000
 s_waitcnt lgkmcnt(2)
 v_mfma_f32_16x16x32_bf16 v[96:99], v[88:91], v[40:43], v[96:99]
 ds_read_b128 v[84:87], v5 offset:41984
 v_cvt_pk_bf16_f32 v154, v232, v233
 v_mfma_f32_16x16x32_bf16 v[104:107], v[88:91], v[72:75], v[104:107]
 v_cvt_pk_bf16_f32 v155, v234, v235
 v_cndmask_b32 v10, v11, v10, vcc
 s_waitcnt lgkmcnt(2)
 v_mfma_f32_16x16x32_bf16 v[96:99], v[92:95], v[44:47], v[96:99]
 ds_read_b128 v[88:91], v5 offset:43008
 buffer_store_dwordx4 v[152:155], v8, s[24:27], s45 offen sc1
 v_mfma_f32_16x16x32_bf16 v[104:107], v[92:95], v[76:79], v[104:107]
 v_mul_f32 v236, s44, v236
 s_cmp_eq_u32 s2, 7
 s_cselect_b32 s8, 1, 0
 v_mov_b32 v128, s8
 s_waitcnt lgkmcnt(2)
 v_mfma_f32_16x16x32_bf16 v[100:103], v[80:83], v[16:19], 0
 ds_read_b128 v[92:95], v5 offset:44032
 v_mul_f32 v237, s44, v237
 v_mfma_f32_16x16x32_bf16 v[108:111], v[80:83], v[48:51], 0
 v_mul_f32 v238, s44, v238
 v_mov_b32 v129, s8
 s_waitcnt lgkmcnt(2)
 v_mfma_f32_16x16x32_bf16 v[100:103], v[84:87], v[20:23], v[100:103]
 ds_read_b128 v[80:83], v5 offset:45056
 v_mul_f32 v239, s44, v239
 v_mfma_f32_16x16x32_bf16 v[108:111], v[84:87], v[52:55], v[108:111]
 v_mul_f32 v240, s44, v240
 v_mov_b32 v130, s8
 s_waitcnt lgkmcnt(2)
 v_mfma_f32_16x16x32_bf16 v[100:103], v[88:91], v[24:27], v[100:103]
 ds_read_b128 v[84:87], v5 offset:46080
 v_mul_f32 v241, s44, v241
 v_mfma_f32_16x16x32_bf16 v[108:111], v[88:91], v[56:59], v[108:111]
 v_mul_f32 v242, s44, v242
 v_mov_b32 v131, s8
 s_waitcnt lgkmcnt(2)
 v_mfma_f32_16x16x32_bf16 v[100:103], v[92:95], v[28:31], v[100:103]
 ds_read_b128 v[88:91], v5 offset:47104
 v_mul_f32 v243, s44, v243
 v_mfma_f32_16x16x32_bf16 v[108:111], v[92:95], v[60:63], v[108:111]
 v_cvt_pk_bf16_f32 v156, v236, v237
 s_add_u32 s32, s4, 70758400
 s_addc_u32 s33, s5, 0
 s_mov_b32 s34, 46694400
 s_mov_b32 s35, 0x20000
 buffer_store_dwordx4 v[128:131], v10, s[32:35], 0 offen sc1
 s_waitcnt lgkmcnt(2)
 v_mfma_f32_16x16x32_bf16 v[100:103], v[80:83], v[32:35], v[100:103]
 ds_read_b128 v[92:95], v5 offset:48128
 v_cvt_pk_bf16_f32 v157, v238, v239
 v_mfma_f32_16x16x32_bf16 v[108:111], v[80:83], v[64:67], v[108:111]
 v_cvt_pk_bf16_f32 v158, v240, v241
 s_waitcnt lgkmcnt(2)
 v_mfma_f32_16x16x32_bf16 v[100:103], v[84:87], v[36:39], v[100:103]
 s_waitcnt vmcnt(16)
 s_barrier
 ds_read_b128 v[80:83], v5 offset:49152
 v_cvt_pk_bf16_f32 v159, v242, v243
 v_mfma_f32_16x16x32_bf16 v[108:111], v[84:87], v[68:71], v[108:111]
 buffer_store_dwordx4 v[156:159], v9, s[24:27], s45 offen sc1
 s_waitcnt lgkmcnt(2)
 v_mfma_f32_16x16x32_bf16 v[100:103], v[88:91], v[40:43], v[100:103]
 ds_read_b128 v[84:87], v5 offset:50176
 v_mfma_f32_16x16x32_bf16 v[108:111], v[88:91], v[72:75], v[108:111]
 s_waitcnt lgkmcnt(2)
 v_mfma_f32_16x16x32_bf16 v[100:103], v[92:95], v[44:47], v[100:103]
 ds_read_b128 v[88:91], v5 offset:51200
 v_mfma_f32_16x16x32_bf16 v[108:111], v[92:95], v[76:79], v[108:111]
 s_waitcnt lgkmcnt(2)
 v_mfma_f32_16x16x32_bf16 v[228:231], v[80:83], v[16:19], 0
 ds_read_b128 v[92:95], v5 offset:52224
 v_mfma_f32_16x16x32_bf16 v[236:239], v[80:83], v[48:51], 0
 s_lshl_b32 s46, s6, 1
 s_add_u32 s46, s46, 0
 s_lshl_b32 s47, s46, 10
 s_add_u32 s47, s47, 98304
 s_mov_b32 m0, s47
 s_lshl_b32 s46, s46, 6
 s_lshl_b32 s47, s94, 18
 s_add_u32 s46, s46, s47
 buffer_load_dwordx4 v134, s[16:19], s46 offen lds
 s_waitcnt lgkmcnt(2)
 v_mfma_f32_16x16x32_bf16 v[228:231], v[84:87], v[20:23], v[228:231]
 ds_read_b128 v[80:83], v5 offset:53248
 s_lshl_b32 s45, s90, 10
 v_mul_f32 v96, s44, v96
 v_mfma_f32_16x16x32_bf16 v[236:239], v[84:87], v[52:55], v[236:239]
 v_mul_f32 v97, s44, v97
 s_lshl_b32 s46, s6, 1
 s_add_u32 s46, s46, 1
 s_lshl_b32 s47, s46, 10
 s_add_u32 s47, s47, 98304
 s_mov_b32 m0, s47
 s_lshl_b32 s46, s46, 6
 s_lshl_b32 s47, s94, 18
 s_add_u32 s46, s46, s47
 buffer_load_dwordx4 v134, s[16:19], s46 offen lds
 s_waitcnt lgkmcnt(2)
 v_mfma_f32_16x16x32_bf16 v[228:231], v[88:91], v[24:27], v[228:231]
 ds_read_b128 v[84:87], v5 offset:54272
 v_mul_f32 v98, s44, v98
 v_mfma_f32_16x16x32_bf16 v[236:239], v[88:91], v[56:59], v[236:239]
 v_mul_f32 v99, s44, v99
 s_lshl_b32 s46, s6, 1
 s_add_u32 s46, s46, 0
 s_lshl_b32 s47, s46, 10
 s_add_u32 s47, s47, 106496
 s_mov_b32 m0, s47
 s_lshl_b32 s46, s46, 6
 s_lshl_b32 s47, s94, 18
 s_add_u32 s46, s46, s47
 buffer_load_dwordx4 v135, s[16:19], s46 offen lds
 s_waitcnt lgkmcnt(2)
 v_mfma_f32_16x16x32_bf16 v[228:231], v[92:95], v[28:31], v[228:231]
 ds_read_b128 v[88:91], v5 offset:55296
 v_mul_f32 v100, s44, v100
 v_mfma_f32_16x16x32_bf16 v[236:239], v[92:95], v[60:63], v[236:239]
 v_mul_f32 v101, s44, v101
 s_lshl_b32 s46, s6, 1
 s_add_u32 s46, s46, 1
 s_lshl_b32 s47, s46, 10
 s_add_u32 s47, s47, 106496
 s_mov_b32 m0, s47
 s_lshl_b32 s46, s46, 6
 s_lshl_b32 s47, s94, 18
 s_add_u32 s46, s46, s47
 buffer_load_dwordx4 v135, s[16:19], s46 offen lds
 s_waitcnt lgkmcnt(2)
 v_mfma_f32_16x16x32_bf16 v[228:231], v[80:83], v[32:35], v[228:231]
 ds_read_b128 v[92:95], v5 offset:56320
 v_mul_f32 v102, s44, v102
 v_mfma_f32_16x16x32_bf16 v[236:239], v[80:83], v[64:67], v[236:239]
 v_mul_f32 v103, s44, v103
 s_waitcnt lgkmcnt(2)
 v_mfma_f32_16x16x32_bf16 v[228:231], v[84:87], v[36:39], v[228:231]
 ds_read_b128 v[80:83], v5 offset:57344
 v_cvt_pk_bf16_f32 v160, v96, v97
 v_mfma_f32_16x16x32_bf16 v[236:239], v[84:87], v[68:71], v[236:239]
 v_cvt_pk_bf16_f32 v161, v98, v99
 s_waitcnt lgkmcnt(2)
 v_mfma_f32_16x16x32_bf16 v[228:231], v[88:91], v[40:43], v[228:231]
 ds_read_b128 v[84:87], v5 offset:58368
 v_cvt_pk_bf16_f32 v162, v100, v101
 v_mfma_f32_16x16x32_bf16 v[236:239], v[88:91], v[72:75], v[236:239]
 v_cvt_pk_bf16_f32 v163, v102, v103
 s_waitcnt lgkmcnt(2)
 v_mfma_f32_16x16x32_bf16 v[228:231], v[92:95], v[44:47], v[228:231]
 ds_read_b128 v[88:91], v5 offset:59392
 buffer_store_dwordx4 v[160:163], v8, s[24:27], s45 offen sc1
 v_mfma_f32_16x16x32_bf16 v[236:239], v[92:95], v[76:79], v[236:239]
 v_mul_f32 v104, s44, v104
 s_waitcnt lgkmcnt(2)
 v_mfma_f32_16x16x32_bf16 v[232:235], v[80:83], v[16:19], 0
 ds_read_b128 v[92:95], v5 offset:60416
 v_mul_f32 v105, s44, v105
 v_mfma_f32_16x16x32_bf16 v[240:243], v[80:83], v[48:51], 0
 v_mul_f32 v106, s44, v106
 s_waitcnt lgkmcnt(2)
 v_mfma_f32_16x16x32_bf16 v[232:235], v[84:87], v[20:23], v[232:235]
 ds_read_b128 v[80:83], v5 offset:61440
 v_mul_f32 v107, s44, v107
 v_mfma_f32_16x16x32_bf16 v[240:243], v[84:87], v[52:55], v[240:243]
 v_mul_f32 v108, s44, v108
 s_waitcnt lgkmcnt(2)
 v_mfma_f32_16x16x32_bf16 v[232:235], v[88:91], v[24:27], v[232:235]
 ds_read_b128 v[84:87], v5 offset:62464
 v_mul_f32 v109, s44, v109
 v_mfma_f32_16x16x32_bf16 v[240:243], v[88:91], v[56:59], v[240:243]
 v_mul_f32 v110, s44, v110
 s_waitcnt lgkmcnt(2)
 v_mfma_f32_16x16x32_bf16 v[232:235], v[92:95], v[28:31], v[232:235]
 ds_read_b128 v[88:91], v5 offset:63488
 v_mul_f32 v111, s44, v111
 v_mfma_f32_16x16x32_bf16 v[240:243], v[92:95], v[60:63], v[240:243]
 v_cvt_pk_bf16_f32 v164, v104, v105
 s_waitcnt lgkmcnt(2)
 v_mfma_f32_16x16x32_bf16 v[232:235], v[80:83], v[32:35], v[232:235]
 ds_read_b128 v[92:95], v5 offset:64512
 v_cvt_pk_bf16_f32 v165, v106, v107
 v_mfma_f32_16x16x32_bf16 v[240:243], v[80:83], v[64:67], v[240:243]
 v_cvt_pk_bf16_f32 v166, v108, v109
 s_waitcnt lgkmcnt(2)
 v_mfma_f32_16x16x32_bf16 v[232:235], v[84:87], v[36:39], v[232:235]
 s_waitcnt vmcnt(16)
 s_barrier
 ds_read_b128 v[80:83], v7 offset:0
 v_cvt_pk_bf16_f32 v167, v110, v111
 v_mfma_f32_16x16x32_bf16 v[240:243], v[84:87], v[68:71], v[240:243]
 buffer_store_dwordx4 v[164:167], v9, s[24:27], s45 offen sc1
 s_waitcnt lgkmcnt(2)
 v_mfma_f32_16x16x32_bf16 v[232:235], v[88:91], v[40:43], v[232:235]
 ds_read_b128 v[84:87], v7 offset:1024
 v_mfma_f32_16x16x32_bf16 v[240:243], v[88:91], v[72:75], v[240:243]
 s_waitcnt lgkmcnt(2)
 v_mfma_f32_16x16x32_bf16 v[232:235], v[92:95], v[44:47], v[232:235]
 ds_read_b128 v[88:91], v7 offset:2048
 v_mfma_f32_16x16x32_bf16 v[240:243], v[92:95], v[76:79], v[240:243]
 s_waitcnt lgkmcnt(2)
 v_mfma_f32_16x16x32_bf16 v[96:99], v[80:83], v[16:19], 0
 ds_read_b128 v[92:95], v7 offset:3072
 v_mfma_f32_16x16x32_bf16 v[104:107], v[80:83], v[48:51], 0
 s_waitcnt lgkmcnt(2)
 v_mfma_f32_16x16x32_bf16 v[96:99], v[84:87], v[20:23], v[96:99]
 ds_read_b128 v[80:83], v7 offset:4096
 s_lshl_b32 s45, s91, 10
 v_mul_f32 v228, s44, v228
 v_mfma_f32_16x16x32_bf16 v[104:107], v[84:87], v[52:55], v[104:107]
 v_mul_f32 v229, s44, v229
 s_waitcnt lgkmcnt(2)
 v_mfma_f32_16x16x32_bf16 v[96:99], v[88:91], v[24:27], v[96:99]
 ds_read_b128 v[84:87], v7 offset:5120
 v_mul_f32 v230, s44, v230
 v_mfma_f32_16x16x32_bf16 v[104:107], v[88:91], v[56:59], v[104:107]
 v_mul_f32 v231, s44, v231
 s_waitcnt lgkmcnt(2)
 v_mfma_f32_16x16x32_bf16 v[96:99], v[92:95], v[28:31], v[96:99]
 ds_read_b128 v[88:91], v7 offset:6144
 v_mul_f32 v232, s44, v232
 v_mfma_f32_16x16x32_bf16 v[104:107], v[92:95], v[60:63], v[104:107]
 v_mul_f32 v233, s44, v233
 s_waitcnt lgkmcnt(2)
 v_mfma_f32_16x16x32_bf16 v[96:99], v[80:83], v[32:35], v[96:99]
 ds_read_b128 v[92:95], v7 offset:7168
 v_mul_f32 v234, s44, v234
 v_mfma_f32_16x16x32_bf16 v[104:107], v[80:83], v[64:67], v[104:107]
 v_mul_f32 v235, s44, v235
 s_waitcnt lgkmcnt(2)
 v_mfma_f32_16x16x32_bf16 v[96:99], v[84:87], v[36:39], v[96:99]
 ds_read_b128 v[80:83], v7 offset:8192
 v_cvt_pk_bf16_f32 v168, v228, v229
 v_mfma_f32_16x16x32_bf16 v[104:107], v[84:87], v[68:71], v[104:107]
 v_cvt_pk_bf16_f32 v169, v230, v231
 s_waitcnt lgkmcnt(2)
 v_mfma_f32_16x16x32_bf16 v[96:99], v[88:91], v[40:43], v[96:99]
 ds_read_b128 v[84:87], v7 offset:9216
 v_cvt_pk_bf16_f32 v170, v232, v233
 v_mfma_f32_16x16x32_bf16 v[104:107], v[88:91], v[72:75], v[104:107]
 v_cvt_pk_bf16_f32 v171, v234, v235
 s_waitcnt lgkmcnt(2)
 v_mfma_f32_16x16x32_bf16 v[96:99], v[92:95], v[44:47], v[96:99]
 ds_read_b128 v[88:91], v7 offset:10240
 buffer_store_dwordx4 v[168:171], v8, s[24:27], s45 offen sc1
 v_mfma_f32_16x16x32_bf16 v[104:107], v[92:95], v[76:79], v[104:107]
 v_mul_f32 v236, s44, v236
 s_waitcnt lgkmcnt(2)
 v_mfma_f32_16x16x32_bf16 v[100:103], v[80:83], v[16:19], 0
 ds_read_b128 v[92:95], v7 offset:11264
 v_mul_f32 v237, s44, v237
 v_mfma_f32_16x16x32_bf16 v[108:111], v[80:83], v[48:51], 0
 v_mul_f32 v238, s44, v238
 s_waitcnt lgkmcnt(2)
 v_mfma_f32_16x16x32_bf16 v[100:103], v[84:87], v[20:23], v[100:103]
 ds_read_b128 v[80:83], v7 offset:12288
 v_mul_f32 v239, s44, v239
 v_mfma_f32_16x16x32_bf16 v[108:111], v[84:87], v[52:55], v[108:111]
 v_mul_f32 v240, s44, v240
 s_waitcnt lgkmcnt(2)
 v_mfma_f32_16x16x32_bf16 v[100:103], v[88:91], v[24:27], v[100:103]
 ds_read_b128 v[84:87], v7 offset:13312
 v_mul_f32 v241, s44, v241
 v_mfma_f32_16x16x32_bf16 v[108:111], v[88:91], v[56:59], v[108:111]
 v_mul_f32 v242, s44, v242
 s_waitcnt lgkmcnt(2)
 v_mfma_f32_16x16x32_bf16 v[100:103], v[92:95], v[28:31], v[100:103]
 ds_read_b128 v[88:91], v7 offset:14336
 v_mul_f32 v243, s44, v243
 v_mfma_f32_16x16x32_bf16 v[108:111], v[92:95], v[60:63], v[108:111]
 v_cvt_pk_bf16_f32 v172, v236, v237
 s_waitcnt lgkmcnt(2)
 v_mfma_f32_16x16x32_bf16 v[100:103], v[80:83], v[32:35], v[100:103]
 ds_read_b128 v[92:95], v7 offset:15360
 v_cvt_pk_bf16_f32 v173, v238, v239
 v_mfma_f32_16x16x32_bf16 v[108:111], v[80:83], v[64:67], v[108:111]
 v_cvt_pk_bf16_f32 v174, v240, v241
 s_waitcnt lgkmcnt(2)
 v_mfma_f32_16x16x32_bf16 v[100:103], v[84:87], v[36:39], v[100:103]
 s_waitcnt vmcnt(10)
 s_barrier
 ds_read_b128 v[80:83], v7 offset:16384
 v_cvt_pk_bf16_f32 v175, v242, v243
 v_mfma_f32_16x16x32_bf16 v[108:111], v[84:87], v[68:71], v[108:111]
 buffer_store_dwordx4 v[172:175], v9, s[24:27], s45 offen sc1
 s_waitcnt lgkmcnt(2)
 v_mfma_f32_16x16x32_bf16 v[100:103], v[88:91], v[40:43], v[100:103]
 ds_read_b128 v[84:87], v7 offset:17408
 v_mfma_f32_16x16x32_bf16 v[108:111], v[88:91], v[72:75], v[108:111]
 s_waitcnt lgkmcnt(2)
 v_mfma_f32_16x16x32_bf16 v[100:103], v[92:95], v[44:47], v[100:103]
 ds_read_b128 v[88:91], v7 offset:18432
 v_mfma_f32_16x16x32_bf16 v[108:111], v[92:95], v[76:79], v[108:111]
 s_waitcnt lgkmcnt(2)
 v_mfma_f32_16x16x32_bf16 v[228:231], v[80:83], v[16:19], 0
 ds_read_b128 v[92:95], v7 offset:19456
 v_mfma_f32_16x16x32_bf16 v[236:239], v[80:83], v[48:51], 0
 s_waitcnt lgkmcnt(2)
 v_mfma_f32_16x16x32_bf16 v[228:231], v[84:87], v[20:23], v[228:231]
 ds_read_b128 v[80:83], v7 offset:20480
 s_lshl_b32 s45, s92, 10
 v_mul_f32 v96, s44, v96
 v_mfma_f32_16x16x32_bf16 v[236:239], v[84:87], v[52:55], v[236:239]
 v_mul_f32 v97, s44, v97
 s_waitcnt lgkmcnt(2)
 v_mfma_f32_16x16x32_bf16 v[228:231], v[88:91], v[24:27], v[228:231]
 ds_read_b128 v[84:87], v7 offset:21504
 v_mul_f32 v98, s44, v98
 v_mfma_f32_16x16x32_bf16 v[236:239], v[88:91], v[56:59], v[236:239]
 v_mul_f32 v99, s44, v99
 s_waitcnt lgkmcnt(2)
 v_mfma_f32_16x16x32_bf16 v[228:231], v[92:95], v[28:31], v[228:231]
 ds_read_b128 v[88:91], v7 offset:22528
 v_mul_f32 v100, s44, v100
 v_mfma_f32_16x16x32_bf16 v[236:239], v[92:95], v[60:63], v[236:239]
 v_mul_f32 v101, s44, v101
 s_waitcnt lgkmcnt(2)
 v_mfma_f32_16x16x32_bf16 v[228:231], v[80:83], v[32:35], v[228:231]
 ds_read_b128 v[92:95], v7 offset:23552
 v_mul_f32 v102, s44, v102
 v_mfma_f32_16x16x32_bf16 v[236:239], v[80:83], v[64:67], v[236:239]
 v_mul_f32 v103, s44, v103
 s_waitcnt lgkmcnt(2)
 v_mfma_f32_16x16x32_bf16 v[228:231], v[84:87], v[36:39], v[228:231]
 ds_read_b128 v[80:83], v7 offset:24576
 v_cvt_pk_bf16_f32 v176, v96, v97
 v_mfma_f32_16x16x32_bf16 v[236:239], v[84:87], v[68:71], v[236:239]
 v_cvt_pk_bf16_f32 v177, v98, v99
 s_waitcnt lgkmcnt(2)
 v_mfma_f32_16x16x32_bf16 v[228:231], v[88:91], v[40:43], v[228:231]
 ds_read_b128 v[84:87], v7 offset:25600
 v_cvt_pk_bf16_f32 v178, v100, v101
 v_mfma_f32_16x16x32_bf16 v[236:239], v[88:91], v[72:75], v[236:239]
 v_cvt_pk_bf16_f32 v179, v102, v103
 s_waitcnt lgkmcnt(2)
 v_mfma_f32_16x16x32_bf16 v[228:231], v[92:95], v[44:47], v[228:231]
 ds_read_b128 v[88:91], v7 offset:26624
 buffer_store_dwordx4 v[176:179], v8, s[24:27], s45 offen sc1
 v_mfma_f32_16x16x32_bf16 v[236:239], v[92:95], v[76:79], v[236:239]
 v_mul_f32 v104, s44, v104
 s_waitcnt lgkmcnt(2)
 v_mfma_f32_16x16x32_bf16 v[232:235], v[80:83], v[16:19], 0
 ds_read_b128 v[92:95], v7 offset:27648
 v_mul_f32 v105, s44, v105
 v_mfma_f32_16x16x32_bf16 v[240:243], v[80:83], v[48:51], 0
 v_mul_f32 v106, s44, v106
 s_waitcnt lgkmcnt(2)
 v_mfma_f32_16x16x32_bf16 v[232:235], v[84:87], v[20:23], v[232:235]
 ds_read_b128 v[80:83], v7 offset:28672
 v_mul_f32 v107, s44, v107
 v_mfma_f32_16x16x32_bf16 v[240:243], v[84:87], v[52:55], v[240:243]
 v_mul_f32 v108, s44, v108
 s_waitcnt lgkmcnt(2)
 v_mfma_f32_16x16x32_bf16 v[232:235], v[88:91], v[24:27], v[232:235]
 ds_read_b128 v[84:87], v7 offset:29696
 v_mul_f32 v109, s44, v109
 v_mfma_f32_16x16x32_bf16 v[240:243], v[88:91], v[56:59], v[240:243]
 v_mul_f32 v110, s44, v110
 s_waitcnt lgkmcnt(2)
 v_mfma_f32_16x16x32_bf16 v[232:235], v[92:95], v[28:31], v[232:235]
 ds_read_b128 v[88:91], v7 offset:30720
 v_mul_f32 v111, s44, v111
 v_mfma_f32_16x16x32_bf16 v[240:243], v[92:95], v[60:63], v[240:243]
 v_cvt_pk_bf16_f32 v180, v104, v105
 s_waitcnt lgkmcnt(2)
 v_mfma_f32_16x16x32_bf16 v[232:235], v[80:83], v[32:35], v[232:235]
 ds_read_b128 v[92:95], v7 offset:31744
 v_cvt_pk_bf16_f32 v181, v106, v107
 v_mfma_f32_16x16x32_bf16 v[240:243], v[80:83], v[64:67], v[240:243]
 v_cvt_pk_bf16_f32 v182, v108, v109
 s_waitcnt lgkmcnt(2)
 v_mfma_f32_16x16x32_bf16 v[232:235], v[84:87], v[36:39], v[232:235]
 s_waitcnt vmcnt(5)
 s_barrier
 ds_read_b128 v[80:83], v7 offset:32768
 v_cvt_pk_bf16_f32 v183, v110, v111
 v_mfma_f32_16x16x32_bf16 v[240:243], v[84:87], v[68:71], v[240:243]
 buffer_store_dwordx4 v[180:183], v9, s[24:27], s45 offen sc1
 s_waitcnt lgkmcnt(2)
 v_mfma_f32_16x16x32_bf16 v[232:235], v[88:91], v[40:43], v[232:235]
 ds_read_b128 v[84:87], v7 offset:33792
 v_mfma_f32_16x16x32_bf16 v[240:243], v[88:91], v[72:75], v[240:243]
 s_waitcnt lgkmcnt(2)
 v_mfma_f32_16x16x32_bf16 v[232:235], v[92:95], v[44:47], v[232:235]
 ds_read_b128 v[88:91], v7 offset:34816
 v_mfma_f32_16x16x32_bf16 v[240:243], v[92:95], v[76:79], v[240:243]
 s_waitcnt lgkmcnt(2)
 v_mfma_f32_16x16x32_bf16 v[96:99], v[80:83], v[16:19], 0
 ds_read_b128 v[92:95], v7 offset:35840
 v_mfma_f32_16x16x32_bf16 v[104:107], v[80:83], v[48:51], 0
 s_waitcnt lgkmcnt(2)
 v_mfma_f32_16x16x32_bf16 v[96:99], v[84:87], v[20:23], v[96:99]
 ds_read_b128 v[80:83], v7 offset:36864
 s_lshl_b32 s45, s93, 10
 v_mul_f32 v228, s44, v228
 v_mfma_f32_16x16x32_bf16 v[104:107], v[84:87], v[52:55], v[104:107]
 v_mul_f32 v229, s44, v229
 s_waitcnt lgkmcnt(2)
 v_mfma_f32_16x16x32_bf16 v[96:99], v[88:91], v[24:27], v[96:99]
 ds_read_b128 v[84:87], v7 offset:37888
 v_mul_f32 v230, s44, v230
 v_mfma_f32_16x16x32_bf16 v[104:107], v[88:91], v[56:59], v[104:107]
 v_mul_f32 v231, s44, v231
 s_waitcnt lgkmcnt(2)
 v_mfma_f32_16x16x32_bf16 v[96:99], v[92:95], v[28:31], v[96:99]
 ds_read_b128 v[88:91], v7 offset:38912
 v_mul_f32 v232, s44, v232
 v_mfma_f32_16x16x32_bf16 v[104:107], v[92:95], v[60:63], v[104:107]
 v_mul_f32 v233, s44, v233
 s_waitcnt lgkmcnt(2)
 v_mfma_f32_16x16x32_bf16 v[96:99], v[80:83], v[32:35], v[96:99]
 ds_read_b128 v[92:95], v7 offset:39936
 v_mul_f32 v234, s44, v234
 v_mfma_f32_16x16x32_bf16 v[104:107], v[80:83], v[64:67], v[104:107]
 v_mul_f32 v235, s44, v235
 s_waitcnt lgkmcnt(2)
 v_mfma_f32_16x16x32_bf16 v[96:99], v[84:87], v[36:39], v[96:99]
 ds_read_b128 v[80:83], v7 offset:40960
 v_cvt_pk_bf16_f32 v184, v228, v229
 v_mfma_f32_16x16x32_bf16 v[104:107], v[84:87], v[68:71], v[104:107]
 v_cvt_pk_bf16_f32 v185, v230, v231
 s_waitcnt lgkmcnt(2)
 v_mfma_f32_16x16x32_bf16 v[96:99], v[88:91], v[40:43], v[96:99]
 ds_read_b128 v[84:87], v7 offset:41984
 v_cvt_pk_bf16_f32 v186, v232, v233
 v_mfma_f32_16x16x32_bf16 v[104:107], v[88:91], v[72:75], v[104:107]
 v_cvt_pk_bf16_f32 v187, v234, v235
 s_waitcnt lgkmcnt(2)
 v_mfma_f32_16x16x32_bf16 v[96:99], v[92:95], v[44:47], v[96:99]
 ds_read_b128 v[88:91], v7 offset:43008
 buffer_store_dwordx4 v[184:187], v8, s[24:27], s45 offen sc1
 v_mfma_f32_16x16x32_bf16 v[104:107], v[92:95], v[76:79], v[104:107]
 v_mul_f32 v236, s44, v236
 s_waitcnt lgkmcnt(2)
 v_mfma_f32_16x16x32_bf16 v[100:103], v[80:83], v[16:19], 0
 ds_read_b128 v[92:95], v7 offset:44032
 v_mul_f32 v237, s44, v237
 v_mfma_f32_16x16x32_bf16 v[108:111], v[80:83], v[48:51], 0
 v_mul_f32 v238, s44, v238
 s_waitcnt lgkmcnt(2)
 v_mfma_f32_16x16x32_bf16 v[100:103], v[84:87], v[20:23], v[100:103]
 ds_read_b128 v[80:83], v7 offset:45056
 v_mul_f32 v239, s44, v239
 v_mfma_f32_16x16x32_bf16 v[108:111], v[84:87], v[52:55], v[108:111]
 v_mul_f32 v240, s44, v240
 s_waitcnt lgkmcnt(2)
 v_mfma_f32_16x16x32_bf16 v[100:103], v[88:91], v[24:27], v[100:103]
 ds_read_b128 v[84:87], v7 offset:46080
 v_mul_f32 v241, s44, v241
 v_mfma_f32_16x16x32_bf16 v[108:111], v[88:91], v[56:59], v[108:111]
 v_mul_f32 v242, s44, v242
 s_waitcnt lgkmcnt(2)
 v_mfma_f32_16x16x32_bf16 v[100:103], v[92:95], v[28:31], v[100:103]
 ds_read_b128 v[88:91], v7 offset:47104
 v_mul_f32 v243, s44, v243
 v_mfma_f32_16x16x32_bf16 v[108:111], v[92:95], v[60:63], v[108:111]
 v_cvt_pk_bf16_f32 v188, v236, v237
 s_waitcnt lgkmcnt(2)
 v_mfma_f32_16x16x32_bf16 v[100:103], v[80:83], v[32:35], v[100:103]
 ds_read_b128 v[92:95], v7 offset:48128
 v_cvt_pk_bf16_f32 v189, v238, v239
 v_mfma_f32_16x16x32_bf16 v[108:111], v[80:83], v[64:67], v[108:111]
 v_cvt_pk_bf16_f32 v190, v240, v241
 s_waitcnt lgkmcnt(2)
 v_mfma_f32_16x16x32_bf16 v[100:103], v[84:87], v[36:39], v[100:103]
 v_cvt_pk_bf16_f32 v191, v242, v243
 v_mfma_f32_16x16x32_bf16 v[108:111], v[84:87], v[68:71], v[108:111]
 buffer_store_dwordx4 v[188:191], v9, s[24:27], s45 offen sc1
 s_waitcnt lgkmcnt(1)
 v_mfma_f32_16x16x32_bf16 v[100:103], v[88:91], v[40:43], v[100:103]
 v_mfma_f32_16x16x32_bf16 v[108:111], v[88:91], v[72:75], v[108:111]
 s_waitcnt lgkmcnt(0)
 v_mfma_f32_16x16x32_bf16 v[100:103], v[92:95], v[44:47], v[100:103]
 v_mfma_f32_16x16x32_bf16 v[108:111], v[92:95], v[76:79], v[108:111]
 s_lshl_b32 s45, s94, 10
 v_mul_f32 v96, s44, v96
 v_mul_f32 v97, s44, v97
 v_mul_f32 v98, s44, v98
 v_mul_f32 v99, s44, v99
 s_nop 0
 v_mul_f32 v100, s44, v100
 v_mul_f32 v101, s44, v101
 v_mul_f32 v102, s44, v102
 v_mul_f32 v103, s44, v103
 v_cvt_pk_bf16_f32 v192, v96, v97
 v_cvt_pk_bf16_f32 v193, v98, v99
 v_cvt_pk_bf16_f32 v194, v100, v101
 v_cvt_pk_bf16_f32 v195, v102, v103
 buffer_store_dwordx4 v[192:195], v8, s[24:27], s45 offen sc1
 v_mul_f32 v104, s44, v104
 v_mul_f32 v105, s44, v105
 v_mul_f32 v106, s44, v106
 v_mul_f32 v107, s44, v107
 v_mul_f32 v108, s44, v108
 v_mul_f32 v109, s44, v109
 v_mul_f32 v110, s44, v110
 v_mul_f32 v111, s44, v111
 v_cvt_pk_bf16_f32 v196, v104, v105
 v_cvt_pk_bf16_f32 v197, v106, v107
 v_cvt_pk_bf16_f32 v198, v108, v109
 v_cvt_pk_bf16_f32 v199, v110, v111
 buffer_store_dwordx4 v[196:199], v9, s[24:27], s45 offen sc1
 s_lshl_b32 s45, s88, 10
 buffer_store_dwordx4 v[144:147], v112, s[24:27], s45 offen sc1
 buffer_store_dwordx4 v[148:151], v113, s[24:27], s45 offen sc1
 s_lshl_b32 s45, s89, 10
 buffer_store_dwordx4 v[152:155], v112, s[24:27], s45 offen sc1
 buffer_store_dwordx4 v[156:159], v113, s[24:27], s45 offen sc1
 s_lshl_b32 s45, s90, 10
 buffer_store_dwordx4 v[160:163], v112, s[24:27], s45 offen sc1
 buffer_store_dwordx4 v[164:167], v113, s[24:27], s45 offen sc1
 s_lshl_b32 s45, s91, 10
 buffer_store_dwordx4 v[168:171], v112, s[24:27], s45 offen sc1
 buffer_store_dwordx4 v[172:175], v113, s[24:27], s45 offen sc1
 s_lshl_b32 s45, s92, 10
 buffer_store_dwordx4 v[176:179], v112, s[24:27], s45 offen sc1
 buffer_store_dwordx4 v[180:183], v113, s[24:27], s45 offen sc1
 s_lshl_b32 s45, s93, 10
 buffer_store_dwordx4 v[184:187], v112, s[24:27], s45 offen sc1
 buffer_store_dwordx4 v[188:191], v113, s[24:27], s45 offen sc1
 s_lshl_b32 s45, s94, 10
 buffer_store_dwordx4 v[192:195], v112, s[24:27], s45 offen sc1
 buffer_store_dwordx4 v[196:199], v113, s[24:27], s45 offen sc1
 s_branch ka_pe_12
ka_w3_11:
 s_waitcnt lgkmcnt(0)
 s_waitcnt vmcnt(8)
 s_barrier
 ds_read_b128 v[80:83], v5 offset:0
 ds_read_b128 v[84:87], v5 offset:1024
 ds_read_b128 v[88:91], v5 offset:2048
 s_waitcnt lgkmcnt(2)
 v_mfma_f32_16x16x32_bf16 v[96:99], v[80:83], v[16:19], 0
 ds_read_b128 v[92:95], v5 offset:3072
 s_lshl_b32 s46, s6, 1
 s_add_u32 s46, s46, 0
 s_lshl_b32 s47, s46, 10
 s_add_u32 s47, s47, 49152
 s_mov_b32 m0, s47
 s_lshl_b32 s46, s46, 6
 s_lshl_b32 s47, s91, 18
 s_add_u32 s46, s46, s47
 buffer_load_dwordx4 v134, s[16:19], s46 offen lds
 v_lshlrev_b32 v172, 16, v144
 v_and_b32 v173, 0xffff0000, v144
 v_lshlrev_b32 v174, 16, v145
 s_waitcnt lgkmcnt(2)
 v_mfma_f32_16x16x32_bf16 v[96:99], v[84:87], v[20:23], v[96:99]
 ds_read_b128 v[80:83], v5 offset:4096
 s_lshl_b32 s46, s6, 1
 s_add_u32 s46, s46, 1
 s_lshl_b32 s47, s46, 10
 s_add_u32 s47, s47, 49152
 s_mov_b32 m0, s47
 s_lshl_b32 s46, s46, 6
 s_lshl_b32 s47, s91, 18
 s_add_u32 s46, s46, s47
 buffer_load_dwordx4 v134, s[16:19], s46 offen lds
 v_and_b32 v175, 0xffff0000, v145
 v_lshlrev_b32 v176, 16, v146
 v_and_b32 v177, 0xffff0000, v146
 s_waitcnt lgkmcnt(2)
 v_mfma_f32_16x16x32_bf16 v[96:99], v[88:91], v[24:27], v[96:99]
 ds_read_b128 v[84:87], v5 offset:5120
 s_lshl_b32 s46, s6, 1
 s_add_u32 s46, s46, 0
 s_lshl_b32 s47, s46, 10
 s_add_u32 s47, s47, 57344
 s_mov_b32 m0, s47
 s_lshl_b32 s46, s46, 6
 s_lshl_b32 s47, s91, 18
 s_add_u32 s46, s46, s47
 buffer_load_dwordx4 v135, s[16:19], s46 offen lds
 v_lshlrev_b32 v178, 16, v147
 v_and_b32 v179, 0xffff0000, v147
 v_lshlrev_b32 v180, 16, v148
 s_waitcnt lgkmcnt(2)
 v_mfma_f32_16x16x32_bf16 v[96:99], v[92:95], v[28:31], v[96:99]
 ds_read_b128 v[88:91], v5 offset:6144
 s_lshl_b32 s46, s6, 1
 s_add_u32 s46, s46, 1
 s_lshl_b32 s47, s46, 10
 s_add_u32 s47, s47, 57344
 s_mov_b32 m0, s47
 s_lshl_b32 s46, s46, 6
 s_lshl_b32 s47, s91, 18
 s_add_u32 s46, s46, s47
 buffer_load_dwordx4 v135, s[16:19], s46 offen lds
 v_and_b32 v181, 0xffff0000, v148
 v_lshlrev_b32 v182, 16, v149
 v_and_b32 v183, 0xffff0000, v149
 s_waitcnt lgkmcnt(2)
 v_mfma_f32_16x16x32_bf16 v[96:99], v[80:83], v[32:35], v[96:99]
 ds_read_b128 v[92:95], v5 offset:7168
 s_add_u32 s32, s4, 55382016
 s_addc_u32 s33, s5, 0
 s_mov_b32 s34, 47135744
 s_mov_b32 s35, 0x20000
 buffer_store_dwordx4 v[128:131], v133, s[32:35], 0 offen sc1
 v_lshlrev_b32 v184, 16, v150
 v_and_b32 v185, 0xffff0000, v150
 v_lshlrev_b32 v186, 16, v151
 s_waitcnt lgkmcnt(2)
 v_mfma_f32_16x16x32_bf16 v[96:99], v[84:87], v[36:39], v[96:99]
 ds_read_b128 v[80:83], v5 offset:8192
 v_mov_b32 v246, -1
 v_and_b32 v187, 0xffff0000, v151
 v_lshlrev_b32 v188, 16, v152
 v_and_b32 v189, 0xffff0000, v152
 s_waitcnt lgkmcnt(2)
 v_mfma_f32_16x16x32_bf16 v[96:99], v[88:91], v[40:43], v[96:99]
 ds_read_b128 v[84:87], v5 offset:9216
 v_mov_b32 v247, -1
 v_lshlrev_b32 v190, 16, v153
 v_and_b32 v191, 0xffff0000, v153
 v_lshlrev_b32 v192, 16, v154
 s_waitcnt lgkmcnt(2)
 v_mfma_f32_16x16x32_bf16 v[96:99], v[92:95], v[44:47], v[96:99]
 ds_read_b128 v[88:91], v5 offset:10240
 v_mov_b32 v248, -1
 v_and_b32 v193, 0xffff0000, v154
 v_lshlrev_b32 v194, 16, v155
 v_and_b32 v195, 0xffff0000, v155
 s_waitcnt lgkmcnt(2)
 v_mfma_f32_16x16x32_bf16 v[100:103], v[80:83], v[16:19], 0
 ds_read_b128 v[92:95], v5 offset:11264
 v_mov_b32 v249, -1
 v_lshlrev_b32 v196, 16, v156
 v_and_b32 v197, 0xffff0000, v156
 v_lshlrev_b32 v198, 16, v157
 s_waitcnt lgkmcnt(2)
 v_mfma_f32_16x16x32_bf16 v[100:103], v[84:87], v[20:23], v[100:103]
 ds_read_b128 v[80:83], v5 offset:12288
 s_mov_b32 s51, s2
 s_add_u32 s32, s4, 55389184
 s_addc_u32 s33, s5, 0
 s_mov_b32 s34, 458752
 s_mov_b32 s35, 0x20000
 s_mul_i32 s8, s51, 1792
 v_lshlrev_b32 v10, 4, v0
 v_and_b32 v199, 0xffff0000, v157
 v_lshlrev_b32 v200, 16, v158
 v_and_b32 v201, 0xffff0000, v158
 s_waitcnt lgkmcnt(2)
 v_mfma_f32_16x16x32_bf16 v[100:103], v[88:91], v[24:27], v[100:103]
 ds_read_b128 v[84:87], v5 offset:13312
 v_add_u32 v10, s8, v10
 v_lshlrev_b32 v202, 16, v159
 v_and_b32 v203, 0xffff0000, v159
 v_lshlrev_b32 v204, 16, v160
 s_waitcnt lgkmcnt(2)
 v_mfma_f32_16x16x32_bf16 v[100:103], v[92:95], v[28:31], v[100:103]
 ds_read_b128 v[88:91], v5 offset:14336
 v_mov_b32 v11, 0x40000000
 v_and_b32 v205, 0xffff0000, v160
 v_lshlrev_b32 v206, 16, v161
 v_and_b32 v207, 0xffff0000, v161
 s_waitcnt lgkmcnt(2)
 v_mfma_f32_16x16x32_bf16 v[100:103], v[80:83], v[32:35], v[100:103]
 ds_read_b128 v[92:95], v5 offset:15360
 v_cmp_gt_u32 vcc, 112, v0
 v_lshlrev_b32 v208, 16, v162
 v_and_b32 v209, 0xffff0000, v162
 v_lshlrev_b32 v210, 16, v163
 s_waitcnt lgkmcnt(2)
 v_mfma_f32_16x16x32_bf16 v[100:103], v[84:87], v[36:39], v[100:103]
 s_waitcnt vmcnt(9)
 s_barrier
 ds_read_b128 v[80:83], v5 offset:16384
 v_cndmask_b32 v10, v11, v10, vcc
 v_and_b32 v211, 0xffff0000, v163
 v_lshlrev_b32 v212, 16, v164
 v_and_b32 v213, 0xffff0000, v164
 s_waitcnt lgkmcnt(2)
 v_mfma_f32_16x16x32_bf16 v[100:103], v[88:91], v[40:43], v[100:103]
 ds_read_b128 v[84:87], v5 offset:17408
 buffer_store_dwordx4 v[246:249], v10, s[32:35], 0 offen sc1
 v_lshlrev_b32 v214, 16, v165
 v_and_b32 v215, 0xffff0000, v165
 v_lshlrev_b32 v216, 16, v166
 s_waitcnt lgkmcnt(2)
 v_mfma_f32_16x16x32_bf16 v[100:103], v[92:95], v[44:47], v[100:103]
 ds_read_b128 v[88:91], v5 offset:18432
 s_add_u32 s32, s4, 55856128
 s_addc_u32 s33, s5, 0
 s_mov_b32 s34, 458752
 s_mov_b32 s35, 0x20000
 s_mul_i32 s8, s51, 1792
 v_lshlrev_b32 v10, 4, v0
 v_and_b32 v217, 0xffff0000, v166
 v_lshlrev_b32 v218, 16, v167
 v_and_b32 v219, 0xffff0000, v167
 s_waitcnt lgkmcnt(2)
 v_mfma_f32_16x16x32_bf16 v[228:231], v[80:83], v[16:19], 0
 ds_read_b128 v[92:95], v5 offset:19456
 s_lshl_b32 s46, s6, 1
 s_add_u32 s46, s46, 0
 s_lshl_b32 s47, s46, 10
 s_add_u32 s47, s47, 65536
 s_mov_b32 m0, s47
 s_lshl_b32 s46, s46, 6
 s_lshl_b32 s47, s92, 18
 s_add_u32 s46, s46, s47
 buffer_load_dwordx4 v134, s[16:19], s46 offen lds
 v_lshlrev_b32 v220, 16, v168
 v_and_b32 v221, 0xffff0000, v168
 v_lshlrev_b32 v222, 16, v169
 s_waitcnt lgkmcnt(2)
 v_mfma_f32_16x16x32_bf16 v[228:231], v[84:87], v[20:23], v[228:231]
 ds_read_b128 v[80:83], v5 offset:20480
 s_lshl_b32 s45, s88, 10
 v_mul_f32 v96, s44, v96
 s_lshl_b32 s46, s6, 1
 s_add_u32 s46, s46, 1
 s_lshl_b32 s47, s46, 10
 s_add_u32 s47, s47, 65536
 s_mov_b32 m0, s47
 s_lshl_b32 s46, s46, 6
 s_lshl_b32 s47, s92, 18
 s_add_u32 s46, s46, s47
 buffer_load_dwordx4 v134, s[16:19], s46 offen lds
 v_and_b32 v223, 0xffff0000, v169
 v_lshlrev_b32 v224, 16, v170
 v_and_b32 v225, 0xffff0000, v170
 s_waitcnt lgkmcnt(2)
 v_mfma_f32_16x16x32_bf16 v[228:231], v[88:91], v[24:27], v[228:231]
 ds_read_b128 v[84:87], v5 offset:21504
 v_mul_f32 v97, s44, v97
 s_lshl_b32 s46, s6, 1
 s_add_u32 s46, s46, 0
 s_lshl_b32 s47, s46, 10
 s_add_u32 s47, s47, 73728
 s_mov_b32 m0, s47
 s_lshl_b32 s46, s46, 6
 s_lshl_b32 s47, s92, 18
 s_add_u32 s46, s46, s47
 buffer_load_dwordx4 v135, s[16:19], s46 offen lds
 v_lshlrev_b32 v226, 16, v171
 v_and_b32 v227, 0xffff0000, v171
 v_pk_add_f32 v[240:241], v[172:173], v[174:175]
 s_waitcnt lgkmcnt(2)
 v_mfma_f32_16x16x32_bf16 v[228:231], v[92:95], v[28:31], v[228:231]
 ds_read_b128 v[88:91], v5 offset:22528
 v_mul_f32 v98, s44, v98
 s_lshl_b32 s46, s6, 1
 s_add_u32 s46, s46, 1
 s_lshl_b32 s47, s46, 10
 s_add_u32 s47, s47, 73728
 s_mov_b32 m0, s47
 s_lshl_b32 s46, s46, 6
 s_lshl_b32 s47, s92, 18
 s_add_u32 s46, s46, s47
 buffer_load_dwordx4 v135, s[16:19], s46 offen lds
 v_pk_add_f32 v[242:243], v[176:177], v[178:179]
 v_pk_add_f32 v[240:241], v[240:241], v[180:181]
 v_pk_add_f32 v[242:243], v[242:243], v[182:183]
 s_waitcnt lgkmcnt(2)
 v_mfma_f32_16x16x32_bf16 v[228:231], v[80:83], v[32:35], v[228:231]
 ds_read_b128 v[92:95], v5 offset:23552
 v_mul_f32 v99, s44, v99
 v_add_u32 v10, s8, v10
 v_pk_add_f32 v[240:241], v[240:241], v[184:185]
 v_pk_add_f32 v[242:243], v[242:243], v[186:187]
 v_pk_add_f32 v[240:241], v[240:241], v[188:189]
 s_waitcnt lgkmcnt(2)
 v_mfma_f32_16x16x32_bf16 v[228:231], v[84:87], v[36:39], v[228:231]
 ds_read_b128 v[80:83], v5 offset:24576
 v_mul_f32 v100, s44, v100
 v_mov_b32 v11, 0x40000000
 v_pk_add_f32 v[242:243], v[242:243], v[190:191]
 v_pk_add_f32 v[240:241], v[240:241], v[192:193]
 v_pk_add_f32 v[242:243], v[242:243], v[194:195]
 s_waitcnt lgkmcnt(2)
 v_mfma_f32_16x16x32_bf16 v[228:231], v[88:91], v[40:43], v[228:231]
 ds_read_b128 v[84:87], v5 offset:25600
 v_mul_f32 v101, s44, v101
 v_cmp_gt_u32 vcc, 112, v0
 v_pk_add_f32 v[240:241], v[240:241], v[196:197]
 v_pk_add_f32 v[242:243], v[242:243], v[198:199]
 v_pk_add_f32 v[240:241], v[240:241], v[200:201]
 s_waitcnt lgkmcnt(2)
 v_mfma_f32_16x16x32_bf16 v[228:231], v[92:95], v[44:47], v[228:231]
 ds_read_b128 v[88:91], v5 offset:26624
 v_mul_f32 v102, s44, v102
 v_cndmask_b32 v10, v11, v10, vcc
 v_pk_add_f32 v[242:243], v[242:243], v[202:203]
 v_pk_add_f32 v[240:241], v[240:241], v[204:205]
 v_pk_add_f32 v[242:243], v[242:243], v[206:207]
 s_waitcnt lgkmcnt(2)
 v_mfma_f32_16x16x32_bf16 v[232:235], v[80:83], v[16:19], 0
 ds_read_b128 v[92:95], v5 offset:27648
 v_mul_f32 v103, s44, v103
 buffer_store_dwordx4 v[246:249], v10, s[32:35], 0 offen sc1
 v_pk_add_f32 v[240:241], v[240:241], v[208:209]
 v_pk_add_f32 v[242:243], v[242:243], v[210:211]
 v_pk_add_f32 v[240:241], v[240:241], v[212:213]
 s_waitcnt lgkmcnt(2)
 v_mfma_f32_16x16x32_bf16 v[232:235], v[84:87], v[20:23], v[232:235]
 ds_read_b128 v[80:83], v5 offset:28672
 v_cvt_pk_bf16_f32 v48, v96, v97
 s_add_u32 s32, s4, 56315904
 s_addc_u32 s33, s5, 0
 s_mov_b32 s34, 786432
 s_mov_b32 s35, 0x20000
 s_mul_i32 s8, s51, 3072
 v_lshlrev_b32 v10, 4, v0
 v_pk_add_f32 v[242:243], v[242:243], v[214:215]
 v_pk_add_f32 v[240:241], v[240:241], v[216:217]
 v_pk_add_f32 v[242:243], v[242:243], v[218:219]
 s_waitcnt lgkmcnt(2)
 v_mfma_f32_16x16x32_bf16 v[232:235], v[88:91], v[24:27], v[232:235]
 ds_read_b128 v[84:87], v5 offset:29696
 v_cvt_pk_bf16_f32 v49, v98, v99
 v_add_u32 v10, s8, v10
 v_pk_add_f32 v[240:241], v[240:241], v[220:221]
 v_pk_add_f32 v[242:243], v[242:243], v[222:223]
 v_pk_add_f32 v[240:241], v[240:241], v[224:225]
 s_waitcnt lgkmcnt(2)
 v_mfma_f32_16x16x32_bf16 v[232:235], v[92:95], v[28:31], v[232:235]
 ds_read_b128 v[88:91], v5 offset:30720
 v_cvt_pk_bf16_f32 v50, v100, v101
 v_mov_b32 v11, 0x40000000
 v_pk_add_f32 v[242:243], v[242:243], v[226:227]
 v_pk_add_f32 v[240:241], v[240:241], v[242:243]
 v_add_f32 v240, v240, v241
 s_waitcnt lgkmcnt(2)
 v_mfma_f32_16x16x32_bf16 v[232:235], v[80:83], v[32:35], v[232:235]
 ds_read_b128 v[92:95], v5 offset:31744
 v_cvt_pk_bf16_f32 v51, v102, v103
 v_cmp_gt_u32 vcc, 192, v0
 v_add_f32 v240, v240, v240 quad_perm:[1,0,3,2] row_mask:0xf bank_mask:0xf
 s_nop 1
 v_add_f32 v240, v240, v240 quad_perm:[2,3,0,1] row_mask:0xf bank_mask:0xf
 s_nop 1
 v_add_f32 v240, v240, v240 row_half_mirror row_mask:0xf bank_mask:0xf
 s_waitcnt lgkmcnt(2)
 v_mfma_f32_16x16x32_bf16 v[232:235], v[84:87], v[36:39], v[232:235]
 s_waitcnt vmcnt(11)
 s_barrier
 ds_read_b128 v[80:83], v5 offset:32768
 buffer_store_dwordx4 v[48:51], v8, s[24:27], s45 offen sc1
 v_cndmask_b32 v10, v11, v10, vcc
 v_mul_f32 v240, 0xbb124925, v240
 v_mov_b32 v241, v240
 v_pk_add_f32 v[172:173], v[172:173], v[240:241]
 s_waitcnt lgkmcnt(2)
 v_mfma_f32_16x16x32_bf16 v[232:235], v[88:91], v[40:43], v[232:235]
 ds_read_b128 v[84:87], v5 offset:33792
 buffer_store_dwordx4 v[246:249], v10, s[32:35], 0 offen sc1
 v_pk_add_f32 v[174:175], v[174:175], v[240:241]
 v_pk_add_f32 v[176:177], v[176:177], v[240:241]
 v_pk_add_f32 v[178:179], v[178:179], v[240:241]
 s_waitcnt lgkmcnt(2)
 v_mfma_f32_16x16x32_bf16 v[232:235], v[92:95], v[44:47], v[232:235]
 ds_read_b128 v[88:91], v5 offset:34816
 s_lshr_b32 s8, s2, 3
 s_mul_i32 s8, s8, 46661632
 s_and_b32 s9, s2, 7
 s_lshl_b32 s9, s9, 12
 s_add_u32 s8, s8, s9
 v_lshlrev_b32 v10, 4, v0
 v_pk_add_f32 v[180:181], v[180:181], v[240:241]
 v_pk_add_f32 v[182:183], v[182:183], v[240:241]
 v_pk_add_f32 v[184:185], v[184:185], v[240:241]
 s_waitcnt lgkmcnt(2)
 v_mfma_f32_16x16x32_bf16 v[96:99], v[80:83], v[16:19], 0
 ds_read_b128 v[92:95], v5 offset:35840
 s_lshl_b32 s46, s6, 1
 s_add_u32 s46, s46, 0
 s_lshl_b32 s47, s46, 10
 s_add_u32 s47, s47, 81920
 s_mov_b32 m0, s47
 s_lshl_b32 s46, s46, 6
 s_lshl_b32 s47, s93, 18
 s_add_u32 s46, s46, s47
 buffer_load_dwordx4 v134, s[16:19], s46 offen lds
 v_pk_add_f32 v[186:187], v[186:187], v[240:241]
 v_pk_add_f32 v[188:189], v[188:189], v[240:241]
 v_pk_add_f32 v[190:191], v[190:191], v[240:241]
 s_waitcnt lgkmcnt(2)
 v_mfma_f32_16x16x32_bf16 v[96:99], v[84:87], v[20:23], v[96:99]
 ds_read_b128 v[80:83], v5 offset:36864
 s_lshl_b32 s45, s89, 10
 v_mul_f32 v228, s44, v228
 s_lshl_b32 s46, s6, 1
 s_add_u32 s46, s46, 1
 s_lshl_b32 s47, s46, 10
 s_add_u32 s47, s47, 81920
 s_mov_b32 m0, s47
 s_lshl_b32 s46, s46, 6
 s_lshl_b32 s47, s93, 18
 s_add_u32 s46, s46, s47
 buffer_load_dwordx4 v134, s[16:19], s46 offen lds
 v_pk_add_f32 v[192:193], v[192:193], v[240:241]
 v_pk_add_f32 v[194:195], v[194:195], v[240:241]
 v_pk_add_f32 v[196:197], v[196:197], v[240:241]
 s_waitcnt lgkmcnt(2)
 v_mfma_f32_16x16x32_bf16 v[96:99], v[88:91], v[24:27], v[96:99]
 ds_read_b128 v[84:87], v5 offset:37888
 v_mul_f32 v229, s44, v229
 s_lshl_b32 s46, s6, 1
 s_add_u32 s46, s46, 0
 s_lshl_b32 s47, s46, 10
 s_add_u32 s47, s47, 90112
 s_mov_b32 m0, s47
 s_lshl_b32 s46, s46, 6
 s_lshl_b32 s47, s93, 18
 s_add_u32 s46, s46, s47
 buffer_load_dwordx4 v135, s[16:19], s46 offen lds
 v_pk_add_f32 v[198:199], v[198:199], v[240:241]
 v_pk_add_f32 v[200:201], v[200:201], v[240:241]
 v_pk_add_f32 v[202:203], v[202:203], v[240:241]
 s_waitcnt lgkmcnt(2)
 v_mfma_f32_16x16x32_bf16 v[96:99], v[92:95], v[28:31], v[96:99]
 ds_read_b128 v[88:91], v5 offset:38912
 v_mul_f32 v230, s44, v230
 s_lshl_b32 s46, s6, 1
 s_add_u32 s46, s46, 1
 s_lshl_b32 s47, s46, 10
 s_add_u32 s47, s47, 90112
 s_mov_b32 m0, s47
 s_lshl_b32 s46, s46, 6
 s_lshl_b32 s47, s93, 18
 s_add_u32 s46, s46, s47
 buffer_load_dwordx4 v135, s[16:19], s46 offen lds
 v_pk_add_f32 v[204:205], v[204:205], v[240:241]
 v_pk_add_f32 v[206:207], v[206:207], v[240:241]
 v_pk_add_f32 v[208:209], v[208:209], v[240:241]
 s_waitcnt lgkmcnt(2)
 v_mfma_f32_16x16x32_bf16 v[96:99], v[80:83], v[32:35], v[96:99]
 ds_read_b128 v[92:95], v5 offset:39936
 v_mul_f32 v231, s44, v231
 v_add_u32 v10, s8, v10
 v_pk_add_f32 v[210:211], v[210:211], v[240:241]
 v_pk_add_f32 v[212:213], v[212:213], v[240:241]
 v_pk_add_f32 v[214:215], v[214:215], v[240:241]
 s_waitcnt lgkmcnt(2)
 v_mfma_f32_16x16x32_bf16 v[96:99], v[84:87], v[36:39], v[96:99]
 ds_read_b128 v[80:83], v5 offset:40960
 v_mul_f32 v232, s44, v232
 s_cmp_lt_u32 s2, 16
 s_cselect_b64 vcc, -1, 0
 v_mov_b32 v11, 0x40000000
 v_pk_add_f32 v[216:217], v[216:217], v[240:241]
 v_pk_add_f32 v[218:219], v[218:219], v[240:241]
 v_pk_add_f32 v[220:221], v[220:221], v[240:241]
 s_waitcnt lgkmcnt(2)
 v_mfma_f32_16x16x32_bf16 v[96:99], v[88:91], v[40:43], v[96:99]
 ds_read_b128 v[84:87], v5 offset:41984
 v_mul_f32 v233, s44, v233
 v_cndmask_b32 v10, v11, v10, vcc
 v_pk_add_f32 v[222:223], v[222:223], v[240:241]
 v_pk_add_f32 v[224:225], v[224:225], v[240:241]
 v_pk_add_f32 v[226:227], v[226:227], v[240:241]
 s_waitcnt lgkmcnt(2)
 v_mfma_f32_16x16x32_bf16 v[96:99], v[92:95], v[44:47], v[96:99]
 ds_read_b128 v[88:91], v5 offset:43008
 v_mul_f32 v234, s44, v234
 s_cmp_eq_u32 s2, 7
 s_cselect_b32 s8, 1, 0
 v_mov_b32 v128, s8
 v_pk_mul_f32 v[242:243], v[172:173], v[172:173]
 v_pk_mul_f32 v[244:245], v[174:175], v[174:175]
 v_pk_fma_f32 v[242:243], v[176:177], v[176:177], v[242:243]
 s_waitcnt lgkmcnt(2)
 v_mfma_f32_16x16x32_bf16 v[100:103], v[80:83], v[16:19], 0
 ds_read_b128 v[92:95], v5 offset:44032
 v_mul_f32 v235, s44, v235
 v_mov_b32 v129, s8
 v_pk_fma_f32 v[244:245], v[178:179], v[178:179], v[244:245]
 v_pk_fma_f32 v[242:243], v[180:181], v[180:181], v[242:243]
 v_pk_fma_f32 v[244:245], v[182:183], v[182:183], v[244:245]
 s_waitcnt lgkmcnt(2)
 v_mfma_f32_16x16x32_bf16 v[100:103], v[84:87], v[20:23], v[100:103]
 ds_read_b128 v[80:83], v5 offset:45056
 v_cvt_pk_bf16_f32 v52, v228, v229
 v_mov_b32 v130, s8
 v_pk_fma_f32 v[242:243], v[184:185], v[184:185], v[242:243]
 v_pk_fma_f32 v[244:245], v[186:187], v[186:187], v[244:245]
 v_pk_fma_f32 v[242:243], v[188:189], v[188:189], v[242:243]
 s_waitcnt lgkmcnt(2)
 v_mfma_f32_16x16x32_bf16 v[100:103], v[88:91], v[24:27], v[100:103]
 ds_read_b128 v[84:87], v5 offset:46080
 v_cvt_pk_bf16_f32 v53, v230, v231
 v_mov_b32 v131, s8
 v_pk_fma_f32 v[244:245], v[190:191], v[190:191], v[244:245]
 v_pk_fma_f32 v[242:243], v[192:193], v[192:193], v[242:243]
 v_pk_fma_f32 v[244:245], v[194:195], v[194:195], v[244:245]
 s_waitcnt lgkmcnt(2)
 v_mfma_f32_16x16x32_bf16 v[100:103], v[92:95], v[28:31], v[100:103]
 ds_read_b128 v[88:91], v5 offset:47104
 v_cvt_pk_bf16_f32 v54, v232, v233
 s_add_u32 s32, s4, 70758400
 s_addc_u32 s33, s5, 0
 s_mov_b32 s34, 46694400
 s_mov_b32 s35, 0x20000
 buffer_store_dwordx4 v[128:131], v10, s[32:35], 0 offen sc1
 v_pk_fma_f32 v[242:243], v[196:197], v[196:197], v[242:243]
 v_pk_fma_f32 v[244:245], v[198:199], v[198:199], v[244:245]
 v_pk_fma_f32 v[242:243], v[200:201], v[200:201], v[242:243]
 s_waitcnt lgkmcnt(2)
 v_mfma_f32_16x16x32_bf16 v[100:103], v[80:83], v[32:35], v[100:103]
 ds_read_b128 v[92:95], v5 offset:48128
 v_cvt_pk_bf16_f32 v55, v234, v235
 v_pk_fma_f32 v[244:245], v[202:203], v[202:203], v[244:245]
 v_pk_fma_f32 v[242:243], v[204:205], v[204:205], v[242:243]
 v_pk_fma_f32 v[244:245], v[206:207], v[206:207], v[244:245]
 s_waitcnt lgkmcnt(2)
 v_mfma_f32_16x16x32_bf16 v[100:103], v[84:87], v[36:39], v[100:103]
 s_waitcnt vmcnt(14)
 s_barrier
 ds_read_b128 v[80:83], v5 offset:49152
 buffer_store_dwordx4 v[52:55], v8, s[24:27], s45 offen sc1
 v_pk_fma_f32 v[242:243], v[208:209], v[208:209], v[242:243]
 v_pk_fma_f32 v[244:245], v[210:211], v[210:211], v[244:245]
 v_pk_fma_f32 v[242:243], v[212:213], v[212:213], v[242:243]
 s_waitcnt lgkmcnt(2)
 v_mfma_f32_16x16x32_bf16 v[100:103], v[88:91], v[40:43], v[100:103]
 ds_read_b128 v[84:87], v5 offset:50176
 v_pk_fma_f32 v[244:245], v[214:215], v[214:215], v[244:245]
 v_pk_fma_f32 v[242:243], v[216:217], v[216:217], v[242:243]
 v_pk_fma_f32 v[244:245], v[218:219], v[218:219], v[244:245]
 s_waitcnt lgkmcnt(2)
 v_mfma_f32_16x16x32_bf16 v[100:103], v[92:95], v[44:47], v[100:103]
 ds_read_b128 v[88:91], v5 offset:51200
 v_pk_fma_f32 v[242:243], v[220:221], v[220:221], v[242:243]
 v_pk_fma_f32 v[244:245], v[222:223], v[222:223], v[244:245]
 v_pk_fma_f32 v[242:243], v[224:225], v[224:225], v[242:243]
 s_waitcnt lgkmcnt(2)
 v_mfma_f32_16x16x32_bf16 v[228:231], v[80:83], v[16:19], 0
 ds_read_b128 v[92:95], v5 offset:52224
 s_lshl_b32 s46, s6, 1
 s_add_u32 s46, s46, 0
 s_lshl_b32 s47, s46, 10
 s_add_u32 s47, s47, 98304
 s_mov_b32 m0, s47
 s_lshl_b32 s46, s46, 6
 s_lshl_b32 s47, s94, 18
 s_add_u32 s46, s46, s47
 buffer_load_dwordx4 v134, s[16:19], s46 offen lds
 v_pk_fma_f32 v[244:245], v[226:227], v[226:227], v[244:245]
 v_pk_add_f32 v[242:243], v[242:243], v[244:245]
 v_add_f32 v240, v242, v243
 s_waitcnt lgkmcnt(2)
 v_mfma_f32_16x16x32_bf16 v[228:231], v[84:87], v[20:23], v[228:231]
 ds_read_b128 v[80:83], v5 offset:53248
 s_lshl_b32 s45, s90, 10
 v_mul_f32 v96, s44, v96
 s_lshl_b32 s46, s6, 1
 s_add_u32 s46, s46, 1
 s_lshl_b32 s47, s46, 10
 s_add_u32 s47, s47, 98304
 s_mov_b32 m0, s47
 s_lshl_b32 s46, s46, 6
 s_lshl_b32 s47, s94, 18
 s_add_u32 s46, s46, s47
 buffer_load_dwordx4 v134, s[16:19], s46 offen lds
 v_add_f32 v240, v240, v240 quad_perm:[1,0,3,2] row_mask:0xf bank_mask:0xf
 s_nop 1
 v_add_f32 v240, v240, v240 quad_perm:[2,3,0,1] row_mask:0xf bank_mask:0xf
 s_nop 1
 v_add_f32 v240, v240, v240 row_half_mirror row_mask:0xf bank_mask:0xf
 s_waitcnt lgkmcnt(2)
 v_mfma_f32_16x16x32_bf16 v[228:231], v[88:91], v[24:27], v[228:231]
 ds_read_b128 v[84:87], v5 offset:54272
 v_mul_f32 v97, s44, v97
 s_lshl_b32 s46, s6, 1
 s_add_u32 s46, s46, 0
 s_lshl_b32 s47, s46, 10
 s_add_u32 s47, s47, 106496
 s_mov_b32 m0, s47
 s_lshl_b32 s46, s46, 6
 s_lshl_b32 s47, s94, 18
 s_add_u32 s46, s46, s47
 buffer_load_dwordx4 v135, s[16:19], s46 offen lds
 v_mov_b32 v241, 0x3727c5ac
 v_fmac_f32 v241, 0x3b124925, v240
 v_rsq_f32 v240, v241
 s_waitcnt lgkmcnt(2)
 v_mfma_f32_16x16x32_bf16 v[228:231], v[92:95], v[28:31], v[228:231]
 ds_read_b128 v[88:91], v5 offset:55296
 v_mul_f32 v98, s44, v98
 s_lshl_b32 s46, s6, 1
 s_add_u32 s46, s46, 1
 s_lshl_b32 s47, s46, 10
 s_add_u32 s47, s47, 106496
 s_mov_b32 m0, s47
 s_lshl_b32 s46, s46, 6
 s_lshl_b32 s47, s94, 18
 s_add_u32 s46, s46, s47
 buffer_load_dwordx4 v135, s[16:19], s46 offen lds
 s_nop 0
 v_mov_b32 v241, v240
 v_pk_mul_f32 v[172:173], v[172:173], v[240:241]
 v_pk_mul_f32 v[174:175], v[174:175], v[240:241]
 s_waitcnt lgkmcnt(2)
 v_mfma_f32_16x16x32_bf16 v[228:231], v[80:83], v[32:35], v[228:231]
 ds_read_b128 v[92:95], v5 offset:56320
 v_mul_f32 v99, s44, v99
 v_pk_mul_f32 v[176:177], v[176:177], v[240:241]
 v_pk_mul_f32 v[178:179], v[178:179], v[240:241]
 v_pk_mul_f32 v[180:181], v[180:181], v[240:241]
 s_waitcnt lgkmcnt(2)
 v_mfma_f32_16x16x32_bf16 v[228:231], v[84:87], v[36:39], v[228:231]
 ds_read_b128 v[80:83], v5 offset:57344
 v_mul_f32 v100, s44, v100
 v_pk_mul_f32 v[182:183], v[182:183], v[240:241]
 v_pk_mul_f32 v[184:185], v[184:185], v[240:241]
 v_pk_mul_f32 v[186:187], v[186:187], v[240:241]
 s_waitcnt lgkmcnt(2)
 v_mfma_f32_16x16x32_bf16 v[228:231], v[88:91], v[40:43], v[228:231]
 ds_read_b128 v[84:87], v5 offset:58368
 v_mul_f32 v101, s44, v101
 v_pk_mul_f32 v[188:189], v[188:189], v[240:241]
 v_pk_mul_f32 v[190:191], v[190:191], v[240:241]
 v_pk_mul_f32 v[192:193], v[192:193], v[240:241]
 s_waitcnt lgkmcnt(2)
 v_mfma_f32_16x16x32_bf16 v[228:231], v[92:95], v[44:47], v[228:231]
 ds_read_b128 v[88:91], v5 offset:59392
 v_mul_f32 v102, s44, v102
 v_pk_mul_f32 v[194:195], v[194:195], v[240:241]
 v_pk_mul_f32 v[196:197], v[196:197], v[240:241]
 v_pk_mul_f32 v[198:199], v[198:199], v[240:241]
 s_waitcnt lgkmcnt(2)
 v_mfma_f32_16x16x32_bf16 v[232:235], v[80:83], v[16:19], 0
 ds_read_b128 v[92:95], v5 offset:60416
 v_mul_f32 v103, s44, v103
 v_pk_mul_f32 v[200:201], v[200:201], v[240:241]
 v_pk_mul_f32 v[202:203], v[202:203], v[240:241]
 v_pk_mul_f32 v[204:205], v[204:205], v[240:241]
 s_waitcnt lgkmcnt(2)
 v_mfma_f32_16x16x32_bf16 v[232:235], v[84:87], v[20:23], v[232:235]
 ds_read_b128 v[80:83], v5 offset:61440
 v_cvt_pk_bf16_f32 v56, v96, v97
 v_pk_mul_f32 v[206:207], v[206:207], v[240:241]
 v_pk_mul_f32 v[208:209], v[208:209], v[240:241]
 v_pk_mul_f32 v[210:211], v[210:211], v[240:241]
 s_waitcnt lgkmcnt(2)
 v_mfma_f32_16x16x32_bf16 v[232:235], v[88:91], v[24:27], v[232:235]
 ds_read_b128 v[84:87], v5 offset:62464
 v_cvt_pk_bf16_f32 v57, v98, v99
 v_pk_mul_f32 v[212:213], v[212:213], v[240:241]
 v_pk_mul_f32 v[214:215], v[214:215], v[240:241]
 v_pk_mul_f32 v[216:217], v[216:217], v[240:241]
 s_waitcnt lgkmcnt(2)
 v_mfma_f32_16x16x32_bf16 v[232:235], v[92:95], v[28:31], v[232:235]
 ds_read_b128 v[88:91], v5 offset:63488
 v_cvt_pk_bf16_f32 v58, v100, v101
 v_pk_mul_f32 v[218:219], v[218:219], v[240:241]
 v_pk_mul_f32 v[220:221], v[220:221], v[240:241]
 v_pk_mul_f32 v[222:223], v[222:223], v[240:241]
 s_waitcnt lgkmcnt(2)
 v_mfma_f32_16x16x32_bf16 v[232:235], v[80:83], v[32:35], v[232:235]
 ds_read_b128 v[92:95], v5 offset:64512
 v_cvt_pk_bf16_f32 v59, v102, v103
 v_pk_mul_f32 v[224:225], v[224:225], v[240:241]
 v_pk_mul_f32 v[226:227], v[226:227], v[240:241]
 v_cvt_pk_bf16_f32 v144, v172, v173
 s_waitcnt lgkmcnt(2)
 v_mfma_f32_16x16x32_bf16 v[232:235], v[84:87], v[36:39], v[232:235]
 s_waitcnt vmcnt(13)
 s_barrier
 ds_read_b128 v[80:83], v7 offset:0
 buffer_store_dwordx4 v[56:59], v8, s[24:27], s45 offen sc1
 v_cvt_pk_bf16_f32 v145, v174, v175
 v_cvt_pk_bf16_f32 v146, v176, v177
 v_cvt_pk_bf16_f32 v147, v178, v179
 s_waitcnt lgkmcnt(2)
 v_mfma_f32_16x16x32_bf16 v[232:235], v[88:91], v[40:43], v[232:235]
 ds_read_b128 v[84:87], v7 offset:1024
 v_cvt_pk_bf16_f32 v148, v180, v181
 v_cvt_pk_bf16_f32 v149, v182, v183
 v_cvt_pk_bf16_f32 v150, v184, v185
 s_waitcnt lgkmcnt(2)
 v_mfma_f32_16x16x32_bf16 v[232:235], v[92:95], v[44:47], v[232:235]
 ds_read_b128 v[88:91], v7 offset:2048
 v_cvt_pk_bf16_f32 v151, v186, v187
 v_cvt_pk_bf16_f32 v152, v188, v189
 v_cvt_pk_bf16_f32 v153, v190, v191
 s_waitcnt lgkmcnt(2)
 v_mfma_f32_16x16x32_bf16 v[96:99], v[80:83], v[16:19], 0
 ds_read_b128 v[92:95], v7 offset:3072
 v_cvt_pk_bf16_f32 v154, v192, v193
 v_cvt_pk_bf16_f32 v155, v194, v195
 v_cvt_pk_bf16_f32 v156, v196, v197
 s_waitcnt lgkmcnt(2)
 v_mfma_f32_16x16x32_bf16 v[96:99], v[84:87], v[20:23], v[96:99]
 ds_read_b128 v[80:83], v7 offset:4096
 s_lshl_b32 s45, s91, 10
 v_mul_f32 v228, s44, v228
 v_cvt_pk_bf16_f32 v157, v198, v199
 v_cvt_pk_bf16_f32 v158, v200, v201
 v_cvt_pk_bf16_f32 v159, v202, v203
 s_waitcnt lgkmcnt(2)
 v_mfma_f32_16x16x32_bf16 v[96:99], v[88:91], v[24:27], v[96:99]
 ds_read_b128 v[84:87], v7 offset:5120
 v_mul_f32 v229, s44, v229
 v_cvt_pk_bf16_f32 v160, v204, v205
 v_cvt_pk_bf16_f32 v161, v206, v207
 v_cvt_pk_bf16_f32 v162, v208, v209
 s_waitcnt lgkmcnt(2)
 v_mfma_f32_16x16x32_bf16 v[96:99], v[92:95], v[28:31], v[96:99]
 ds_read_b128 v[88:91], v7 offset:6144
 v_mul_f32 v230, s44, v230
 v_cvt_pk_bf16_f32 v163, v210, v211
 v_cvt_pk_bf16_f32 v164, v212, v213
 v_cvt_pk_bf16_f32 v165, v214, v215
 s_waitcnt lgkmcnt(2)
 v_mfma_f32_16x16x32_bf16 v[96:99], v[80:83], v[32:35], v[96:99]
 ds_read_b128 v[92:95], v7 offset:7168
 v_mul_f32 v231, s44, v231
 v_cvt_pk_bf16_f32 v166, v216, v217
 v_cvt_pk_bf16_f32 v167, v218, v219
 v_cvt_pk_bf16_f32 v168, v220, v221
 s_waitcnt lgkmcnt(2)
 v_mfma_f32_16x16x32_bf16 v[96:99], v[84:87], v[36:39], v[96:99]
 ds_read_b128 v[80:83], v7 offset:8192
 v_mul_f32 v232, s44, v232
 v_cvt_pk_bf16_f32 v169, v222, v223
 v_cvt_pk_bf16_f32 v170, v224, v225
 v_cvt_pk_bf16_f32 v171, v226, v227
 s_waitcnt lgkmcnt(2)
 v_mfma_f32_16x16x32_bf16 v[96:99], v[88:91], v[40:43], v[96:99]
 ds_read_b128 v[84:87], v7 offset:9216
 v_mul_f32 v233, s44, v233
 s_waitcnt lgkmcnt(2)
 v_mfma_f32_16x16x32_bf16 v[96:99], v[92:95], v[44:47], v[96:99]
 ds_read_b128 v[88:91], v7 offset:10240
 v_mul_f32 v234, s44, v234
 s_waitcnt lgkmcnt(2)
 v_mfma_f32_16x16x32_bf16 v[100:103], v[80:83], v[16:19], 0
 ds_read_b128 v[92:95], v7 offset:11264
 v_mul_f32 v235, s44, v235
 s_waitcnt lgkmcnt(2)
 v_mfma_f32_16x16x32_bf16 v[100:103], v[84:87], v[20:23], v[100:103]
 ds_read_b128 v[80:83], v7 offset:12288
 v_cvt_pk_bf16_f32 v60, v228, v229
 s_waitcnt lgkmcnt(2)
 v_mfma_f32_16x16x32_bf16 v[100:103], v[88:91], v[24:27], v[100:103]
 ds_read_b128 v[84:87], v7 offset:13312
 v_cvt_pk_bf16_f32 v61, v230, v231
 s_waitcnt lgkmcnt(2)
 v_mfma_f32_16x16x32_bf16 v[100:103], v[92:95], v[28:31], v[100:103]
 ds_read_b128 v[88:91], v7 offset:14336
 v_cvt_pk_bf16_f32 v62, v232, v233
 s_waitcnt lgkmcnt(2)
 v_mfma_f32_16x16x32_bf16 v[100:103], v[80:83], v[32:35], v[100:103]
 ds_read_b128 v[92:95], v7 offset:15360
 v_cvt_pk_bf16_f32 v63, v234, v235
 s_waitcnt lgkmcnt(2)
 v_mfma_f32_16x16x32_bf16 v[100:103], v[84:87], v[36:39], v[100:103]
 s_waitcnt vmcnt(7)
 s_barrier
 ds_read_b128 v[80:83], v7 offset:16384
 buffer_store_dwordx4 v[60:63], v8, s[24:27], s45 offen sc1
 s_waitcnt lgkmcnt(2)
 v_mfma_f32_16x16x32_bf16 v[100:103], v[88:91], v[40:43], v[100:103]
 ds_read_b128 v[84:87], v7 offset:17408
 s_waitcnt lgkmcnt(2)
 v_mfma_f32_16x16x32_bf16 v[100:103], v[92:95], v[44:47], v[100:103]
 ds_read_b128 v[88:91], v7 offset:18432
 s_waitcnt lgkmcnt(2)
 v_mfma_f32_16x16x32_bf16 v[228:231], v[80:83], v[16:19], 0
 ds_read_b128 v[92:95], v7 offset:19456
 s_waitcnt lgkmcnt(2)
 v_mfma_f32_16x16x32_bf16 v[228:231], v[84:87], v[20:23], v[228:231]
 ds_read_b128 v[80:83], v7 offset:20480
 s_lshl_b32 s45, s92, 10
 v_mul_f32 v96, s44, v96
 s_waitcnt lgkmcnt(2)
 v_mfma_f32_16x16x32_bf16 v[228:231], v[88:91], v[24:27], v[228:231]
 ds_read_b128 v[84:87], v7 offset:21504
 v_mul_f32 v97, s44, v97
 s_waitcnt lgkmcnt(2)
 v_mfma_f32_16x16x32_bf16 v[228:231], v[92:95], v[28:31], v[228:231]
 ds_read_b128 v[88:91], v7 offset:22528
 v_mul_f32 v98, s44, v98
 s_waitcnt lgkmcnt(2)
 v_mfma_f32_16x16x32_bf16 v[228:231], v[80:83], v[32:35], v[228:231]
 ds_read_b128 v[92:95], v7 offset:23552
 v_mul_f32 v99, s44, v99
 s_waitcnt lgkmcnt(2)
 v_mfma_f32_16x16x32_bf16 v[228:231], v[84:87], v[36:39], v[228:231]
 ds_read_b128 v[80:83], v7 offset:24576
 v_mul_f32 v100, s44, v100
 s_waitcnt lgkmcnt(2)
 v_mfma_f32_16x16x32_bf16 v[228:231], v[88:91], v[40:43], v[228:231]
 ds_read_b128 v[84:87], v7 offset:25600
 v_mul_f32 v101, s44, v101
 s_waitcnt lgkmcnt(2)
 v_mfma_f32_16x16x32_bf16 v[228:231], v[92:95], v[44:47], v[228:231]
 ds_read_b128 v[88:91], v7 offset:26624
 v_mul_f32 v102, s44, v102
 s_waitcnt lgkmcnt(2)
 v_mfma_f32_16x16x32_bf16 v[232:235], v[80:83], v[16:19], 0
 ds_read_b128 v[92:95], v7 offset:27648
 v_mul_f32 v103, s44, v103
 s_waitcnt lgkmcnt(2)
 v_mfma_f32_16x16x32_bf16 v[232:235], v[84:87], v[20:23], v[232:235]
 ds_read_b128 v[80:83], v7 offset:28672
 v_cvt_pk_bf16_f32 v64, v96, v97
 s_waitcnt lgkmcnt(2)
 v_mfma_f32_16x16x32_bf16 v[232:235], v[88:91], v[24:27], v[232:235]
 ds_read_b128 v[84:87], v7 offset:29696
 v_cvt_pk_bf16_f32 v65, v98, v99
 s_waitcnt lgkmcnt(2)
 v_mfma_f32_16x16x32_bf16 v[232:235], v[92:95], v[28:31], v[232:235]
 ds_read_b128 v[88:91], v7 offset:30720
 v_cvt_pk_bf16_f32 v66, v100, v101
 s_waitcnt lgkmcnt(2)
 v_mfma_f32_16x16x32_bf16 v[232:235], v[80:83], v[32:35], v[232:235]
 ds_read_b128 v[92:95], v7 offset:31744
 v_cvt_pk_bf16_f32 v67, v102, v103
 s_waitcnt lgkmcnt(2)
 v_mfma_f32_16x16x32_bf16 v[232:235], v[84:87], v[36:39], v[232:235]
 s_waitcnt vmcnt(2)
 s_barrier
 ds_read_b128 v[80:83], v7 offset:32768
 buffer_store_dwordx4 v[64:67], v8, s[24:27], s45 offen sc1
 s_waitcnt lgkmcnt(2)
 v_mfma_f32_16x16x32_bf16 v[232:235], v[88:91], v[40:43], v[232:235]
 ds_read_b128 v[84:87], v7 offset:33792
 s_waitcnt lgkmcnt(2)
 v_mfma_f32_16x16x32_bf16 v[232:235], v[92:95], v[44:47], v[232:235]
 ds_read_b128 v[88:91], v7 offset:34816
 s_waitcnt lgkmcnt(2)
 v_mfma_f32_16x16x32_bf16 v[96:99], v[80:83], v[16:19], 0
 ds_read_b128 v[92:95], v7 offset:35840
 s_waitcnt lgkmcnt(2)
 v_mfma_f32_16x16x32_bf16 v[96:99], v[84:87], v[20:23], v[96:99]
 ds_read_b128 v[80:83], v7 offset:36864
 s_lshl_b32 s45, s93, 10
 v_mul_f32 v228, s44, v228
 s_waitcnt lgkmcnt(2)
 v_mfma_f32_16x16x32_bf16 v[96:99], v[88:91], v[24:27], v[96:99]
 ds_read_b128 v[84:87], v7 offset:37888
 v_mul_f32 v229, s44, v229
 s_waitcnt lgkmcnt(2)
 v_mfma_f32_16x16x32_bf16 v[96:99], v[92:95], v[28:31], v[96:99]
 ds_read_b128 v[88:91], v7 offset:38912
 v_mul_f32 v230, s44, v230
 s_waitcnt lgkmcnt(2)
 v_mfma_f32_16x16x32_bf16 v[96:99], v[80:83], v[32:35], v[96:99]
 ds_read_b128 v[92:95], v7 offset:39936
 v_mul_f32 v231, s44, v231
 s_waitcnt lgkmcnt(2)
 v_mfma_f32_16x16x32_bf16 v[96:99], v[84:87], v[36:39], v[96:99]
 ds_read_b128 v[80:83], v7 offset:40960
 v_mul_f32 v232, s44, v232
 s_waitcnt lgkmcnt(2)
 v_mfma_f32_16x16x32_bf16 v[96:99], v[88:91], v[40:43], v[96:99]
 ds_read_b128 v[84:87], v7 offset:41984
 v_mul_f32 v233, s44, v233
 s_waitcnt lgkmcnt(2)
 v_mfma_f32_16x16x32_bf16 v[96:99], v[92:95], v[44:47], v[96:99]
 ds_read_b128 v[88:91], v7 offset:43008
 v_mul_f32 v234, s44, v234
 s_waitcnt lgkmcnt(2)
 v_mfma_f32_16x16x32_bf16 v[100:103], v[80:83], v[16:19], 0
 ds_read_b128 v[92:95], v7 offset:44032
 v_mul_f32 v235, s44, v235
 s_waitcnt lgkmcnt(2)
 v_mfma_f32_16x16x32_bf16 v[100:103], v[84:87], v[20:23], v[100:103]
 ds_read_b128 v[80:83], v7 offset:45056
 v_cvt_pk_bf16_f32 v68, v228, v229
 s_waitcnt lgkmcnt(2)
 v_mfma_f32_16x16x32_bf16 v[100:103], v[88:91], v[24:27], v[100:103]
 ds_read_b128 v[84:87], v7 offset:46080
 v_cvt_pk_bf16_f32 v69, v230, v231
 s_waitcnt lgkmcnt(2)
 v_mfma_f32_16x16x32_bf16 v[100:103], v[92:95], v[28:31], v[100:103]
 ds_read_b128 v[88:91], v7 offset:47104
 v_cvt_pk_bf16_f32 v70, v232, v233
 s_waitcnt lgkmcnt(2)
 v_mfma_f32_16x16x32_bf16 v[100:103], v[80:83], v[32:35], v[100:103]
 ds_read_b128 v[92:95], v7 offset:48128
 v_cvt_pk_bf16_f32 v71, v234, v235
 s_waitcnt lgkmcnt(2)
 v_mfma_f32_16x16x32_bf16 v[100:103], v[84:87], v[36:39], v[100:103]
 buffer_store_dwordx4 v[68:71], v8, s[24:27], s45 offen sc1
 s_waitcnt lgkmcnt(1)
 v_mfma_f32_16x16x32_bf16 v[100:103], v[88:91], v[40:43], v[100:103]
 s_waitcnt lgkmcnt(0)
 v_mfma_f32_16x16x32_bf16 v[100:103], v[92:95], v[44:47], v[100:103]
 s_lshl_b32 s45, s94, 10
 v_mul_f32 v96, s44, v96
 v_mul_f32 v97, s44, v97
 v_mul_f32 v98, s44, v98
 v_mul_f32 v99, s44, v99
 s_nop 2
 v_mul_f32 v100, s44, v100
 v_mul_f32 v101, s44, v101
 v_mul_f32 v102, s44, v102
 v_mul_f32 v103, s44, v103
 v_cvt_pk_bf16_f32 v72, v96, v97
 v_cvt_pk_bf16_f32 v73, v98, v99
 v_cvt_pk_bf16_f32 v74, v100, v101
 v_cvt_pk_bf16_f32 v75, v102, v103
 buffer_store_dwordx4 v[72:75], v8, s[24:27], s45 offen sc1
 s_lshl_b32 s45, s88, 10
 buffer_store_dwordx4 v[48:51], v112, s[24:27], s45 offen sc1
 s_lshl_b32 s45, s89, 10
 buffer_store_dwordx4 v[52:55], v112, s[24:27], s45 offen sc1
 s_lshl_b32 s45, s90, 10
 buffer_store_dwordx4 v[56:59], v112, s[24:27], s45 offen sc1
 s_lshl_b32 s45, s91, 10
 buffer_store_dwordx4 v[60:63], v112, s[24:27], s45 offen sc1
 s_lshl_b32 s45, s92, 10
 buffer_store_dwordx4 v[64:67], v112, s[24:27], s45 offen sc1
 s_lshl_b32 s45, s93, 10
 buffer_store_dwordx4 v[68:71], v112, s[24:27], s45 offen sc1
 s_lshl_b32 s45, s94, 10
 buffer_store_dwordx4 v[72:75], v112, s[24:27], s45 offen sc1
 s_add_u32 s32, s4, 24182784
 s_addc_u32 s33, s5, 0
 s_mov_b32 s34, 1835008
 s_mov_b32 s35, 0x20000
 v_and_b32 v240, 7, v1
 v_bfe_u32 v241, v1, 3, 2
 s_and_b32 s8, s2, 3
 s_lshl_b32 s8, s8, 2
 v_add_u32 v241, s8, v241
 v_lshlrev_b32 v241, 4, v241
 v_and_b32 v242, 3, v240
 v_lshl_add_u32 v241, v242, 8, v241
 v_lshrrev_b32 v242, 2, v240
 v_lshl_add_u32 v241, v242, 10, v241
 v_lshrrev_b32 v242, 5, v1
 v_mul_u32_u24 v242, 14336, v242
 v_add_u32 v241, v241, v242
 s_lshr_b32 s8, s2, 2
 s_mul_i32 s8, s8, 28672
 v_add_u32 v241, s8, v241
 v_add_u32 v242, 4096, v241
 v_add_u32 v243, 8192, v241
 v_add_u32 v244, 12288, v241
 buffer_store_dwordx4 v[144:147], v241, s[32:35], 0 offen offset:0 sc1
 buffer_store_dwordx4 v[148:151], v241, s[32:35], 0 offen offset:2048 sc1
 buffer_store_dwordx4 v[152:155], v242, s[32:35], 0 offen offset:0 sc1
 buffer_store_dwordx4 v[156:159], v242, s[32:35], 0 offen offset:2048 sc1
 buffer_store_dwordx4 v[160:163], v243, s[32:35], 0 offen offset:0 sc1
 buffer_store_dwordx4 v[164:167], v243, s[32:35], 0 offen offset:2048 sc1
 buffer_store_dwordx4 v[168:171], v244, s[32:35], 0 offen offset:0 sc1
ka_xi_13:
ka_pe_12:
 s_getreg_b32 s8, hwreg(HW_REG_XCC_ID, 0, 4)
 s_and_b32 s8, s8, 7
 s_mov_b32 s76, s4
 s_mov_b32 s77, s5
 s_mov_b32 s10, s56
 s_mov_b32 s11, s57
 s_cmp_eq_u32 s6, 0
 s_cbranch_scc0 ka_iw_16
 s_mov_b32 s13, 0
 v_mov_b32 v3, 8
ka_in_14:
 global_load_dword v4, v3, s[10:11] sc0 sc1
 s_waitcnt vmcnt(0)
 v_readfirstlane_b32 s12, v4
 s_cmp_lg_u32 s12, 0
 s_cbranch_scc1 ka_ik_15
 s_add_u32 s13, s13, 1
 s_cmp_lt_u32 s13, 400000
 s_cbranch_scc1 ka_in_14
 s_branch ka_end
ka_iw_16:
 s_waitcnt vmcnt(0)
ka_ik_15:
 s_barrier
 s_cmp_eq_u32 s6, 0
 s_cbranch_scc0 ka_tk_wait

 s_and_b32 s9, s2, 7
 s_lshr_b32 s12, s2, 6
 s_lshl_b32 s12, s12, 3
 s_add_u32 s9, s9, s12
 s_lshr_b32 s12, s9, 3
 s_and_b32 s9, s9, 7
 s_lshl_b32 s9, s9, 1
 s_and_b32 s13, s12, 1
 s_add_u32 s9, s9, s13
 s_lshr_b32 s12, s12, 1
 s_lshl_b32 s12, s12, 4
 s_add_u32 s9, s9, s12
 s_lshl_b32 s9, s9, 3
 s_bfe_u32 s12, s2, 0x30003
 s_add_u32 s9, s9, s12
 s_lshl_b32 s9, s9, 2
 s_add_u32 s9, s9, 24150016
 v_mov_b32 v3, s9
 v_mov_b32 v4, 1
 s_mov_b64 exec, 1
 global_store_dword v3, v4, s[4:5] sc1
 v_mov_b32 v5, v250
 s_mov_b32 s12, 23
 s_cmp_eq_u32 s8, 0
 s_cselect_b32 s12, 32, s12
 s_cmp_eq_u32 s8, 7
 s_cselect_b32 s12, 22, s12
 v_readfirstlane_b32 s7, v5
 s_and_b32 s7, s7, 0xffff
 s_cmp_lt_u32 s7, s12
 s_cbranch_scc1 ka_tk_pub
ka_rs:
 s_mov_b64 exec, 0xff
 v_and_b32 v7, 63, v0
 v_lshlrev_b32 v6, 5, v7
 v_cmp_eq_u32 vcc, 7, v7
 v_mov_b32 v8, 23
 s_nop 0
 v_cndmask_b32 v8, v8, 22, vcc
 v_cmp_eq_u32 vcc, 0, v7
 s_nop 1
 v_cndmask_b32 v7, v8, 32, vcc
 s_mov_b32 s13, 0
 s_sleep 32
ka_rl:
 global_load_dword v5, v6, s[10:11] sc0 sc1
 s_waitcnt vmcnt(0)
 v_and_b32 v8, 0xffff, v5
 v_cmp_lt_u32 vcc, v8, v7
 s_nop 1
 s_and_b64 vcc, vcc, exec
 s_cbranch_scc0 ka_rx
 s_add_u32 s13, s13, 1
 s_cmp_ge_u32 s13, 400000
 s_cbranch_scc1 ka_rx
 s_cmp_ge_u32 s13, 48
 s_cbranch_scc1 ka_st
 s_sleep 8
 s_branch ka_rl
ka_st:
 s_ff1_i32_b64 s14, vcc
 s_nop 0
 v_readlane_b32 s15, v5, s14
 s_add_u32 s12, s15, 1
 s_cmp_eq_u32 s14, 0
 s_cbranch_scc0 ka_st1
 s_cmp_eq_u32 s8, 0
 s_cbranch_scc1 ka_st1
 s_add_u32 s12, s12, 0x10000
ka_st1:
 s_mov_b64 exec, 1
 s_lshl_b32 s9, s14, 5
 v_mov_b32 v3, s9
 v_mov_b32 v4, s12
 v_mov_b32 v5, s15
 global_atomic_cmpswap v9, v3, v[4:5], s[10:11] sc0 sc1
 s_waitcnt vmcnt(0)
 v_readfirstlane_b32 s12, v9
 s_mov_b64 exec, 0xff
 s_cmp_eq_u32 s12, s15
 s_cbranch_scc0 ka_rl
 s_mov_b32 s8, s14
 s_and_b32 s7, s15, 0xffff
 s_branch ka_tk_pub
ka_rx:

 s_mov_b64 exec, 1
 s_mov_b32 s13, 0
ka_rv:
 s_add_u32 s14, s8, s13
 s_and_b32 s14, s14, 7
 s_cmp_eq_u32 s14, 7
 s_cselect_b32 s15, 10, 9
 s_cmp_eq_u32 s14, 0
 s_cselect_b32 s15, 0, s15
 s_lshl_b32 s9, s14, 5
 s_add_u32 s9, s9, 4
 v_mov_b32 v3, s9
 v_mov_b32 v4, 1
 global_atomic_add v5, v3, v4, s[10:11] sc0 sc1
 s_waitcnt vmcnt(0)
 v_readfirstlane_b32 s12, v5
 s_cmp_lt_u32 s12, s15
 s_cbranch_scc1 ka_rf
 s_add_u32 s13, s13, 1
 s_cmp_lt_u32 s13, 8
 s_cbranch_scc1 ka_rv
 s_mov_b32 s8, 255
 s_mov_b32 s7, 255
 s_branch ka_tk_pub
ka_rf:
 s_sub_u32 s14, s14, 1
 s_mul_i32 s14, s14, 9
 s_add_u32 s7, s14, s12
 s_mov_b32 s8, 254
ka_tk_pub:
 s_mov_b64 exec, 1
 s_lshl_b32 s9, s8, 8
 s_or_b32 s9, s9, s7
 v_mov_b32 v3, 0
 v_mov_b32 v5, s9
 ds_write_b32 v3, v5
 s_waitcnt lgkmcnt(0)
 s_mov_b64 exec, -1
ka_tk_wait:
 s_barrier
 v_mov_b32 v3, 0
 ds_read_b32 v4, v3
 s_waitcnt lgkmcnt(0)
 v_readfirstlane_b32 s7, v4
 s_barrier
 s_lshr_b32 s8, s7, 8
 s_and_b32 s7, s7, 255

 s_lshl_b32 s94, s8, 5
 s_add_u32 s94, s94, s7
 s_mov_b32 s95, s7
 s_cmp_eq_u32 s8, 254
 s_cbranch_scc0 ka_bj
 s_mul_i32 s9, s7, 57
 s_lshr_b32 s9, s9, 9
 s_min_u32 s9, s9, 6
 s_mul_i32 s10, s9, 9
 s_sub_u32 s10, s7, s10
 s_cmp_eq_u32 s9, 6
 s_cselect_b32 s11, 22, 23
 s_add_u32 s10, s10, s11
 s_add_u32 s9, s9, 1
 s_lshl_b32 s9, s9, 5
 s_add_u32 s94, s9, s10
ka_bj:
 s_mov_b32 s92, s8
ka_disp:
 s_mov_b32 s93, -1
 s_cmp_eq_u32 s8, 254
 s_cbranch_scc1 ka_rsv
 s_cmp_ge_u32 s7, 32
 s_cbranch_scc1 ka_end
 s_cmp_eq_u32 s8, 0
 s_cbranch_scc0 ka_wk
 s_cmp_ge_u32 s7, 30
 s_cbranch_scc1 ka_pf
 s_mov_b32 s35, s7
 s_mov_b32 s36, s6
 s_lshl_b32 s9, s7, 1
 s_lshl_b64 s[12:13], 3, s9
 s_cmp_lt_u32 s7, 16
 s_cselect_b32 s12, s12, 0
 s_cselect_b32 s13, 0, -1
 s_cmp_eq_u32 s3, 0
 s_cbranch_scc0 ka_ps_18
 s_cmp_eq_u32 s6, 0
 s_cbranch_scc0 ka_pw_17
 v_and_b32 v20, 63, v0
 v_lshlrev_b32 v20, 4, v20
 v_add_u32 v20, 24150016, v20
 global_load_dwordx4 v[22:25], v20, s[4:5] sc1
 s_waitcnt vmcnt(0)
 s_mov_b32 s61, 0
ka_pd_19:
 v_min_u32 v22, v22, v23
 v_min3_u32 v22, v22, v24, v25
 v_cmp_eq_u32 vcc, 0, v22
 s_nop 1
 s_and_b64 vcc, vcc, s[12:13]
 s_cbranch_scc0 ka_pk_20
 s_add_u32 s61, s61, 1
 s_cmp_lt_u32 s61, 400000
 s_cbranch_scc0 ka_end
 s_sleep 1
 global_load_dwordx4 v[22:25], v20, s[4:5] sc1
 s_waitcnt vmcnt(0)
 s_branch ka_pd_19
ka_pk_20:
ka_pw_17:
 s_barrier
ka_ps_18:
 s_branch ka_team
ka_wk:
 s_sub_u32 s9, s8, 1
 s_cmp_lt_u32 s7, 16
 s_cbranch_scc0 ka_wk_hi
 s_lshr_b32 s10, s7, 3
 s_bfe_u32 s11, s7, 0x10002
 s_mul_i32 s11, s11, 7
 s_add_u32 s36, s11, s9
 s_and_b32 s37, s7, 3
 s_branch ka_wk_xt
ka_wk_hi:
 s_sub_u32 s10, s7, 16
 s_mul_i32 s10, s10, 7
 s_add_u32 s9, s10, s9
 s_cmp_lt_u32 s9, 16
 s_cbranch_scc0 ka_wk_o
 s_lshr_b32 s10, s9, 3
 s_bfe_u32 s11, s9, 0x10002
 s_add_u32 s36, s11, 14
 s_and_b32 s37, s9, 3
ka_wk_xt:
 s_cmp_eq_u32 s10, 0
 s_cbranch_scc1 ka_gx
 s_lshl_b32 s93, s36, 2
 s_add_u32 s93, s93, s37
 s_add_u32 s93, s93, 96
 s_branch ka_gt
ka_wk_o:
 s_sub_u32 s9, s9, 16
 s_cmp_lt_u32 s9, 32
 s_cbranch_scc0 ka_end
 s_add_u32 s93, s9, 64
 s_lshr_b32 s40, s9, 2
 s_and_b32 s41, s9, 3
 s_branch ka_go
ka_gx:
 s_lshl_b32 s9, s36, 1
 s_add_u32 s9, s9, 32
 s_lshl_b64 s[12:13], 3, s9
 s_cmp_eq_u32 s3, 0
 s_cbranch_scc0 ka_ps_22
 s_cmp_eq_u32 s6, 0
 s_cbranch_scc0 ka_pw_21
 v_and_b32 v20, 63, v0
 v_lshlrev_b32 v20, 4, v20
 v_add_u32 v20, 24150016, v20
 global_load_dwordx4 v[22:25], v20, s[4:5] sc1
 s_waitcnt vmcnt(0)
 s_mov_b32 s61, 0
ka_pd_23:
 v_min_u32 v22, v22, v23
 v_min3_u32 v22, v22, v24, v25
 v_cmp_eq_u32 vcc, 0, v22
 s_nop 1
 s_and_b64 vcc, vcc, s[12:13]
 s_cbranch_scc0 ka_pk_24
 s_add_u32 s61, s61, 1
 s_cmp_lt_u32 s61, 400000
 s_cbranch_scc0 ka_end
 s_sleep 1
 global_load_dwordx4 v[22:25], v20, s[4:5] sc1
 s_waitcnt vmcnt(0)
 s_branch ka_pd_23
ka_pk_24:
ka_pw_21:
 s_barrier
ka_ps_22:
 s_add_u32 s16, s4, 6422528
 s_addc_u32 s17, s5, 0
 s_mov_b32 s18, 6422528
 s_mov_b32 s19, 0x20000
 s_add_u32 s20, s76, 24182784
 s_addc_u32 s21, s77, 0
 s_mov_b32 s22, 1835008
 s_mov_b32 s23, 0x20000
 s_add_u32 s24, s76, 26021888
 s_addc_u32 s25, s77, 0
 s_mov_b32 s26, 29360128
 s_mov_b32 s27, 0x20000
 s_add_u32 s56, s76, 70762240
 s_addc_u32 s57, s77, 0
 s_mov_b32 s58, 28928
 s_mov_b32 s59, 0x20000
 v_and_b32 v1, 63, v0
 v_lshlrev_b32 v2, 4, v1
 s_mov_b32 s38, 16
 s_mov_b32 s39, 0
 s_mov_b32 s40, 28672
 s_mov_b32 s41, 57344
 s_mov_b32 s44, 4096
 v_add_u32 v3, 0, v2
 v_add_u32 v4, 28672, v2
 s_mul_i32 s8, s37, 28672
 s_mul_i32 s9, s6, 7168
 s_add_u32 s8, s8, s9
 v_add_u32 v5, s8, v2
 s_cmp_eq_u32 s3, 0
 s_cbranch_scc0 ka_w1_25
 s_mul_i32 s8, s36, 401408
 v_and_b32 v20, 15, v1
 v_lshrrev_b32 v21, 4, v1
 s_mul_i32 s9, s6, 100352
 s_add_u32 s8, s8, s9
 v_add_u32 v48, 0, v2
 v_add_u32 v49, 14336, v2
 v_add_u32 v50, 28672, v2
 v_add_u32 v51, 43008, v2
 v_add_u32 v52, 57344, v2
 v_add_u32 v53, 71680, v2
 v_add_u32 v54, 86016, v2
 s_add_u32 s14, s8, 0
 buffer_load_dwordx4 a[0:3], v48, s[16:19], s14 offen offset:0
 buffer_load_dwordx4 a[4:7], v49, s[16:19], s14 offen offset:0
 buffer_load_dwordx4 a[8:11], v50, s[16:19], s14 offen offset:0
 buffer_load_dwordx4 a[12:15], v51, s[16:19], s14 offen offset:0
 buffer_load_dwordx4 a[16:19], v48, s[16:19], s14 offen offset:1024
 buffer_load_dwordx4 a[20:23], v49, s[16:19], s14 offen offset:1024
 buffer_load_dwordx4 a[24:27], v50, s[16:19], s14 offen offset:1024
 buffer_load_dwordx4 a[28:31], v51, s[16:19], s14 offen offset:1024
 buffer_load_dwordx4 a[32:35], v48, s[16:19], s14 offen offset:2048
 buffer_load_dwordx4 a[36:39], v49, s[16:19], s14 offen offset:2048
 buffer_load_dwordx4 a[40:43], v50, s[16:19], s14 offen offset:2048
 buffer_load_dwordx4 a[44:47], v51, s[16:19], s14 offen offset:2048
 buffer_load_dwordx4 a[48:51], v48, s[16:19], s14 offen offset:3072
 buffer_load_dwordx4 a[52:55], v49, s[16:19], s14 offen offset:3072
 buffer_load_dwordx4 a[56:59], v50, s[16:19], s14 offen offset:3072
 buffer_load_dwordx4 a[60:63], v51, s[16:19], s14 offen offset:3072
 s_add_u32 s14, s8, 4096
 buffer_load_dwordx4 a[64:67], v48, s[16:19], s14 offen offset:0
 buffer_load_dwordx4 a[68:71], v49, s[16:19], s14 offen offset:0
 buffer_load_dwordx4 a[72:75], v50, s[16:19], s14 offen offset:0
 buffer_load_dwordx4 a[76:79], v51, s[16:19], s14 offen offset:0
 buffer_load_dwordx4 a[80:83], v48, s[16:19], s14 offen offset:1024
 buffer_load_dwordx4 a[84:87], v49, s[16:19], s14 offen offset:1024
 buffer_load_dwordx4 a[88:91], v50, s[16:19], s14 offen offset:1024
 buffer_load_dwordx4 a[92:95], v51, s[16:19], s14 offen offset:1024
 buffer_load_dwordx4 a[96:99], v48, s[16:19], s14 offen offset:2048
 buffer_load_dwordx4 a[100:103], v49, s[16:19], s14 offen offset:2048
 buffer_load_dwordx4 a[104:107], v50, s[16:19], s14 offen offset:2048
 buffer_load_dwordx4 a[108:111], v51, s[16:19], s14 offen offset:2048
 buffer_load_dwordx4 a[112:115], v48, s[16:19], s14 offen offset:3072
 buffer_load_dwordx4 a[116:119], v49, s[16:19], s14 offen offset:3072
 buffer_load_dwordx4 a[120:123], v50, s[16:19], s14 offen offset:3072
 buffer_load_dwordx4 a[124:127], v51, s[16:19], s14 offen offset:3072
 s_add_u32 s14, s8, 8192
 buffer_load_dwordx4 a[128:131], v48, s[16:19], s14 offen offset:0
 buffer_load_dwordx4 a[132:135], v49, s[16:19], s14 offen offset:0
 buffer_load_dwordx4 a[136:139], v50, s[16:19], s14 offen offset:0
 buffer_load_dwordx4 a[140:143], v51, s[16:19], s14 offen offset:0
 buffer_load_dwordx4 a[144:147], v48, s[16:19], s14 offen offset:1024
 buffer_load_dwordx4 a[148:151], v49, s[16:19], s14 offen offset:1024
 buffer_load_dwordx4 a[152:155], v50, s[16:19], s14 offen offset:1024
 buffer_load_dwordx4 a[156:159], v51, s[16:19], s14 offen offset:1024
 buffer_load_dwordx4 a[160:163], v48, s[16:19], s14 offen offset:2048
 buffer_load_dwordx4 a[164:167], v49, s[16:19], s14 offen offset:2048
 buffer_load_dwordx4 a[168:171], v50, s[16:19], s14 offen offset:2048
 buffer_load_dwordx4 a[172:175], v51, s[16:19], s14 offen offset:2048
 buffer_load_dwordx4 a[176:179], v48, s[16:19], s14 offen offset:3072
 buffer_load_dwordx4 a[180:183], v49, s[16:19], s14 offen offset:3072
 buffer_load_dwordx4 a[184:187], v50, s[16:19], s14 offen offset:3072
 buffer_load_dwordx4 a[188:191], v51, s[16:19], s14 offen offset:3072
 s_add_u32 s14, s8, 12288
 buffer_load_dwordx4 a[192:195], v48, s[16:19], s14 offen offset:0
 buffer_load_dwordx4 a[196:199], v49, s[16:19], s14 offen offset:0
 buffer_load_dwordx4 a[200:203], v50, s[16:19], s14 offen offset:0
 buffer_load_dwordx4 a[204:207], v51, s[16:19], s14 offen offset:0
 buffer_load_dwordx4 a[208:211], v48, s[16:19], s14 offen offset:1024
 buffer_load_dwordx4 a[212:215], v49, s[16:19], s14 offen offset:1024
 buffer_load_dwordx4 a[216:219], v50, s[16:19], s14 offen offset:1024
 buffer_load_dwordx4 a[220:223], v51, s[16:19], s14 offen offset:1024
 s_add_u32 s14, s8, 0
 buffer_load_dwordx4 a[224:227], v52, s[16:19], s14 offen offset:0
 buffer_load_dwordx4 a[228:231], v53, s[16:19], s14 offen offset:0
 buffer_load_dwordx4 a[232:235], v54, s[16:19], s14 offen offset:0
 buffer_load_dwordx4 a[236:239], v52, s[16:19], s14 offen offset:1024
 buffer_load_dwordx4 a[240:243], v53, s[16:19], s14 offen offset:1024
 buffer_load_dwordx4 a[244:247], v54, s[16:19], s14 offen offset:1024
 buffer_load_dwordx4 a[248:251], v52, s[16:19], s14 offen offset:2048
 buffer_load_dwordx4 a[252:255], v53, s[16:19], s14 offen offset:2048
 buffer_load_dwordx4 v[120:123], v54, s[16:19], s14 offen offset:2048
 buffer_load_dwordx4 v[124:127], v52, s[16:19], s14 offen offset:3072
 buffer_load_dwordx4 v[128:131], v53, s[16:19], s14 offen offset:3072
 buffer_load_dwordx4 v[132:135], v54, s[16:19], s14 offen offset:3072
 s_add_u32 s14, s8, 4096
 buffer_load_dwordx4 v[136:139], v52, s[16:19], s14 offen offset:0
 buffer_load_dwordx4 v[140:143], v53, s[16:19], s14 offen offset:0
 buffer_load_dwordx4 v[144:147], v54, s[16:19], s14 offen offset:0
 buffer_load_dwordx4 v[148:151], v52, s[16:19], s14 offen offset:1024
 buffer_load_dwordx4 v[152:155], v53, s[16:19], s14 offen offset:1024
 buffer_load_dwordx4 v[156:159], v54, s[16:19], s14 offen offset:1024
 buffer_load_dwordx4 v[160:163], v52, s[16:19], s14 offen offset:2048
 buffer_load_dwordx4 v[164:167], v53, s[16:19], s14 offen offset:2048
 buffer_load_dwordx4 v[168:171], v54, s[16:19], s14 offen offset:2048
 buffer_load_dwordx4 v[172:175], v52, s[16:19], s14 offen offset:3072
 buffer_load_dwordx4 v[176:179], v53, s[16:19], s14 offen offset:3072
 buffer_load_dwordx4 v[180:183], v54, s[16:19], s14 offen offset:3072
 s_add_u32 s14, s8, 8192
 buffer_load_dwordx4 v[184:187], v52, s[16:19], s14 offen offset:0
 buffer_load_dwordx4 v[188:191], v53, s[16:19], s14 offen offset:0
 buffer_load_dwordx4 v[192:195], v54, s[16:19], s14 offen offset:0
 buffer_load_dwordx4 v[196:199], v52, s[16:19], s14 offen offset:1024
 buffer_load_dwordx4 v[200:203], v53, s[16:19], s14 offen offset:1024
 buffer_load_dwordx4 v[204:207], v54, s[16:19], s14 offen offset:1024
 buffer_load_dwordx4 v[208:211], v52, s[16:19], s14 offen offset:2048
 buffer_load_dwordx4 v[212:215], v53, s[16:19], s14 offen offset:2048
 buffer_load_dwordx4 v[216:219], v54, s[16:19], s14 offen offset:2048
 buffer_load_dwordx4 v[220:223], v52, s[16:19], s14 offen offset:3072
 buffer_load_dwordx4 v[224:227], v53, s[16:19], s14 offen offset:3072
 buffer_load_dwordx4 v[228:231], v54, s[16:19], s14 offen offset:3072
 s_add_u32 s14, s8, 12288
 buffer_load_dwordx4 v[232:235], v52, s[16:19], s14 offen offset:0
 buffer_load_dwordx4 v[236:239], v53, s[16:19], s14 offen offset:0
 buffer_load_dwordx4 v[240:243], v54, s[16:19], s14 offen offset:0
 buffer_load_dwordx4 v[244:247], v52, s[16:19], s14 offen offset:1024
 buffer_load_dwordx4 v[248:251], v53, s[16:19], s14 offen offset:1024
 buffer_load_dwordx4 v[252:255], v54, s[16:19], s14 offen offset:1024
 s_branch ka_wj_26
ka_w1_25:
 s_mul_i32 s8, s36, 401408
 v_and_b32 v20, 15, v1
 v_lshrrev_b32 v21, 4, v1
 s_mul_i32 s9, s6, 100352
 s_add_u32 s8, s8, s9
 v_add_u32 v48, 0, v2
 v_add_u32 v49, 14336, v2
 v_add_u32 v50, 28672, v2
 v_add_u32 v51, 43008, v2
 v_add_u32 v52, 57344, v2
 v_add_u32 v53, 71680, v2
 v_add_u32 v54, 86016, v2
 s_add_u32 s14, s8, 0
 s_add_u32 s14, s8, 4096
 s_add_u32 s14, s8, 8192
 s_add_u32 s14, s8, 12288
 s_add_u32 s14, s8, 0
 buffer_load_dwordx4 v[120:123], v54, s[16:19], s14 offen offset:2048
 buffer_load_dwordx4 v[124:127], v52, s[16:19], s14 offen offset:3072
 buffer_load_dwordx4 v[128:131], v53, s[16:19], s14 offen offset:3072
 buffer_load_dwordx4 v[132:135], v54, s[16:19], s14 offen offset:3072
 s_add_u32 s14, s8, 4096
 buffer_load_dwordx4 v[136:139], v52, s[16:19], s14 offen offset:0
 buffer_load_dwordx4 v[140:143], v53, s[16:19], s14 offen offset:0
 buffer_load_dwordx4 v[144:147], v54, s[16:19], s14 offen offset:0
 buffer_load_dwordx4 v[148:151], v52, s[16:19], s14 offen offset:1024
 buffer_load_dwordx4 v[152:155], v53, s[16:19], s14 offen offset:1024
 buffer_load_dwordx4 v[156:159], v54, s[16:19], s14 offen offset:1024
 buffer_load_dwordx4 v[160:163], v52, s[16:19], s14 offen offset:2048
 buffer_load_dwordx4 v[164:167], v53, s[16:19], s14 offen offset:2048
 buffer_load_dwordx4 v[168:171], v54, s[16:19], s14 offen offset:2048
 buffer_load_dwordx4 v[172:175], v52, s[16:19], s14 offen offset:3072
 buffer_load_dwordx4 v[176:179], v53, s[16:19], s14 offen offset:3072
 buffer_load_dwordx4 v[180:183], v54, s[16:19], s14 offen offset:3072
 s_add_u32 s14, s8, 8192
 buffer_load_dwordx4 v[184:187], v52, s[16:19], s14 offen offset:0
 buffer_load_dwordx4 v[188:191], v53, s[16:19], s14 offen offset:0
 buffer_load_dwordx4 v[192:195], v54, s[16:19], s14 offen offset:0
 buffer_load_dwordx4 v[196:199], v52, s[16:19], s14 offen offset:1024
 buffer_load_dwordx4 v[200:203], v53, s[16:19], s14 offen offset:1024
 buffer_load_dwordx4 v[204:207], v54, s[16:19], s14 offen offset:1024
 buffer_load_dwordx4 v[208:211], v52, s[16:19], s14 offen offset:2048
 buffer_load_dwordx4 v[212:215], v53, s[16:19], s14 offen offset:2048
 buffer_load_dwordx4 v[216:219], v54, s[16:19], s14 offen offset:2048
 buffer_load_dwordx4 v[220:223], v52, s[16:19], s14 offen offset:3072
 buffer_load_dwordx4 v[224:227], v53, s[16:19], s14 offen offset:3072
 buffer_load_dwordx4 v[228:231], v54, s[16:19], s14 offen offset:3072
 s_add_u32 s14, s8, 12288
 buffer_load_dwordx4 v[232:235], v52, s[16:19], s14 offen offset:0
 buffer_load_dwordx4 v[236:239], v53, s[16:19], s14 offen offset:0
 buffer_load_dwordx4 v[240:243], v54, s[16:19], s14 offen offset:0
 buffer_load_dwordx4 v[244:247], v52, s[16:19], s14 offen offset:1024
 buffer_load_dwordx4 v[248:251], v53, s[16:19], s14 offen offset:1024
 buffer_load_dwordx4 v[252:255], v54, s[16:19], s14 offen offset:1024
ka_wj_26:
 s_cmp_eq_u32 s3, 0
 s_cbranch_scc0 ka_ps_28
 v_and_b32 v20, 63, v0
 v_lshlrev_b32 v20, 4, v20
 v_add_u32 v20, 24150016, v20
 global_load_dwordx4 v[22:25], v20, s[4:5] sc1
 s_waitcnt vmcnt(0)
 s_mov_b32 s61, 0
ka_pd_29:
 v_min_u32 v22, v22, v23
 v_min3_u32 v22, v22, v24, v25
 v_cmp_eq_u32 vcc, 0, v22
 s_nop 1
 s_and_b64 vcc, vcc, exec
 s_cbranch_scc0 ka_pk_30
 s_add_u32 s61, s61, 1
 s_cmp_lt_u32 s61, 400000
 s_cbranch_scc0 ka_end
 s_sleep 1
 global_load_dwordx4 v[22:25], v20, s[4:5] sc1
 s_waitcnt vmcnt(0)
 s_branch ka_pd_29
ka_pk_30:
ka_pw_27:
ka_ps_28:
 s_add_u32 s52, s76, 70787072
 s_addc_u32 s53, s77, 0
 s_mov_b32 s54, 4096
 s_mov_b32 s55, 0x20000
 v_lshrrev_b32 v13, 2, v1
 v_and_b32 v14, 3, v1
 v_lshlrev_b32 v14, 2, v14
 v_lshl_add_u32 v11, v13, 8, v14
 s_lshl_b32 s8, s37, 6
 v_add_u32 v11, s8, v11
 s_mov_b32 s61, 0
 s_cmp_eq_u32 s3, 0
 s_cbranch_scc1 ka_xk_32
 s_mul_i32 s8, s6, 7168
 s_add_u32 s9, s8, s39
 v_add_u32 v104, s9, v2
 s_add_u32 s9, s8, s40
 v_add_u32 v105, s9, v2
ka_xf_31:
 s_mul_i32 s8, s6, 7168
 s_add_u32 s8, s8, s39
 s_mov_b32 m0, s8
 s_nop 0
 buffer_load_dwordx4 v5, s[20:23], 0 offen offset:0 sc1 lds
 buffer_load_dwordx4 v5, s[20:23], 0 offen offset:1024 sc1 lds
 buffer_load_dwordx4 v5, s[20:23], 0 offen offset:2048 sc1 lds
 buffer_load_dwordx4 v5, s[20:23], 0 offen offset:3072 sc1 lds
 s_add_u32 s8, s8, 4096
 s_mov_b32 m0, s8
 s_nop 0
 buffer_load_dwordx4 v5, s[20:23], s44 offen offset:0 sc1 lds
 buffer_load_dwordx4 v5, s[20:23], s44 offen offset:1024 sc1 lds
 buffer_load_dwordx4 v5, s[20:23], s44 offen offset:2048 sc1 lds
 v_add_u32 v5, 114688, v5
 s_mul_i32 s8, s6, 7168
 s_add_u32 s8, s8, s40
 s_mov_b32 m0, s8
 s_nop 0
 buffer_load_dwordx4 v5, s[20:23], 0 offen offset:0 sc1 lds
 buffer_load_dwordx4 v5, s[20:23], 0 offen offset:1024 sc1 lds
 buffer_load_dwordx4 v5, s[20:23], 0 offen offset:2048 sc1 lds
 buffer_load_dwordx4 v5, s[20:23], 0 offen offset:3072 sc1 lds
 s_add_u32 s8, s8, 4096
 s_mov_b32 m0, s8
 s_nop 0
 buffer_load_dwordx4 v5, s[20:23], s44 offen offset:0 sc1 lds
 buffer_load_dwordx4 v5, s[20:23], s44 offen offset:1024 sc1 lds
 buffer_load_dwordx4 v5, s[20:23], s44 offen offset:2048 sc1 lds
 v_subrev_u32 v5, 114688, v5
 s_waitcnt vmcnt(7)
 ds_read_b128 v[48:51], v104 offset:0
 ds_read_b128 v[52:55], v104 offset:1024
 ds_read_b128 v[56:59], v104 offset:2048
 ds_read_b128 v[60:63], v104 offset:3072
 ds_read_b128 v[64:67], v104 offset:4096
 ds_read_b128 v[68:71], v104 offset:5120
 ds_read_b128 v[72:75], v104 offset:6144
 s_waitcnt vmcnt(0)
 ds_read_b128 v[76:79], v105 offset:0
 ds_read_b128 v[80:83], v105 offset:1024
 ds_read_b128 v[84:87], v105 offset:2048
 ds_read_b128 v[88:91], v105 offset:3072
 ds_read_b128 v[92:95], v105 offset:4096
 ds_read_b128 v[96:99], v105 offset:5120
 ds_read_b128 v[100:103], v105 offset:6144
 s_waitcnt lgkmcnt(7)
 v_max3_u32 v16, v49, v51, v53
 v_max3_u32 v17, v55, v57, v59
 v_max3_u32 v18, v61, v63, v65
 v_max3_u32 v19, v67, v69, v71
 v_max3_u32 v20, v16, v17, v18
 v_max3_u32 v21, v19, v73, v75
 v_max_u32 v22, v20, v21
 v_cmp_eq_u32 vcc, -1, v22
 s_nop 1
 s_mov_b64 s[10:11], vcc
 s_waitcnt lgkmcnt(0)
 v_max3_u32 v16, v77, v79, v81
 v_max3_u32 v17, v83, v85, v87
 v_max3_u32 v18, v89, v91, v93
 v_max3_u32 v19, v95, v97, v99
 v_max3_u32 v20, v16, v17, v18
 v_max3_u32 v21, v19, v101, v103
 v_max_u32 v22, v20, v21
 v_cmp_eq_u32 vcc, -1, v22
 s_nop 1
 s_or_b64 vcc, vcc, s[10:11]
 s_cbranch_scc0 ka_xj_33
 s_add_u32 s61, s61, 1
 s_cmp_lt_u32 s61, 400000
 s_cbranch_scc0 ka_end
 s_sleep 1
 s_branch ka_xf_31
ka_xj_33:
 v_add_u32 v5, 229376, v5
 s_branch ka_gx_x1
ka_xk_32:
 s_mul_i32 s8, s6, 7168
 s_add_u32 s8, s8, s39
 s_mov_b32 m0, s8
 s_nop 0
 buffer_load_dwordx4 v5, s[20:23], 0 offen offset:0 lds
 buffer_load_dwordx4 v5, s[20:23], 0 offen offset:1024 lds
 buffer_load_dwordx4 v5, s[20:23], 0 offen offset:2048 lds
 buffer_load_dwordx4 v5, s[20:23], 0 offen offset:3072 lds
 s_add_u32 s8, s8, 4096
 s_mov_b32 m0, s8
 s_nop 0
 buffer_load_dwordx4 v5, s[20:23], s44 offen offset:0 lds
 buffer_load_dwordx4 v5, s[20:23], s44 offen offset:1024 lds
 buffer_load_dwordx4 v5, s[20:23], s44 offen offset:2048 lds
 v_add_u32 v5, 114688, v5
 s_cmp_eq_u32 s3, 0
 s_cbranch_scc1 ka_xh_35
ka_xg_34:
 buffer_load_dword v12, v11, s[52:55], 0 offen sc1
 s_waitcnt vmcnt(0)
 v_cmp_eq_u32 vcc, 1, v13
 s_nop 1
 v_cndmask_b32 v14, 1, v12, vcc
 v_cmp_eq_u32 vcc, 0, v14
 s_cbranch_vccz ka_xh_35
 s_add_u32 s61, s61, 1
 s_cmp_lt_u32 s61, 400000
 s_cbranch_scc0 ka_end
 s_branch ka_xg_34
ka_xh_35:
 s_mul_i32 s8, s6, 7168
 s_add_u32 s8, s8, s40
 s_mov_b32 m0, s8
 s_nop 0
 buffer_load_dwordx4 v5, s[20:23], 0 offen offset:0 lds
 buffer_load_dwordx4 v5, s[20:23], 0 offen offset:1024 lds
 buffer_load_dwordx4 v5, s[20:23], 0 offen offset:2048 lds
 buffer_load_dwordx4 v5, s[20:23], 0 offen offset:3072 lds
 s_add_u32 s8, s8, 4096
 s_mov_b32 m0, s8
 s_nop 0
 buffer_load_dwordx4 v5, s[20:23], s44 offen offset:0 lds
 buffer_load_dwordx4 v5, s[20:23], s44 offen offset:1024 lds
 buffer_load_dwordx4 v5, s[20:23], s44 offen offset:2048 lds
 v_add_u32 v5, 114688, v5
ka_gx_x1:
 s_mul_i32 s8, s36, 28
 s_mul_i32 s9, s6, 7
 s_add_u32 s8, s8, s9
 s_lshl_b32 s8, s8, 10
 v_add_u32 v6, s8, v2
 v_add_u32 v8, 4096, v6
 v_mov_b32 v7, 1073741824
 s_lshl_b32 s8, s36, 2
 s_add_u32 s8, s8, 0
 v_mov_b32 v9, s8
 v_cmp_eq_u32 vcc, 0, v0
 s_nop 1
 v_cndmask_b32 v9, v7, v9, vcc
 v_mov_b32 v10, 1
 s_mov_b32 s60, 0
 s_mul_i32 s42, s37, 458752
 s_mov_b32 s43, s42
 s_waitcnt vmcnt(7)
 s_barrier
 ds_read_b128 v[16:19], v3 offset:0
 ds_read_b128 v[20:23], v3 offset:14336
 ds_read_b128 v[24:27], v3 offset:1024
 ds_read_b128 v[28:31], v3 offset:15360
ka_gx_loop:
 s_waitcnt lgkmcnt(2)
 v_mfma_f32_16x16x32_bf16 v[48:51], v[16:19], a[0:3], 0
 ds_read_b128 v[32:35], v3 offset:2048
 ds_read_b128 v[36:39], v3 offset:16384
 buffer_load_dword v12, v11, s[52:55], 0 offen sc1
 s_lshr_b32 s51, s37, 2
 s_add_u32 s51, s51, 2
 v_mfma_f32_16x16x32_bf16 v[52:55], v[20:23], a[0:3], 0
 v_mfma_f32_16x16x32_bf16 v[56:59], v[16:19], a[4:7], 0
 v_mfma_f32_16x16x32_bf16 v[60:63], v[20:23], a[4:7], 0
 v_mfma_f32_16x16x32_bf16 v[64:67], v[16:19], a[8:11], 0
 v_mfma_f32_16x16x32_bf16 v[68:71], v[20:23], a[8:11], 0
 v_mfma_f32_16x16x32_bf16 v[72:75], v[16:19], a[12:15], 0
 v_mfma_f32_16x16x32_bf16 v[76:79], v[20:23], a[12:15], 0
 s_waitcnt lgkmcnt(2)
 v_mfma_f32_16x16x32_bf16 v[48:51], v[24:27], a[16:19], v[48:51]
 ds_read_b128 v[40:43], v3 offset:3072
 ds_read_b128 v[44:47], v3 offset:17408
 v_mfma_f32_16x16x32_bf16 v[52:55], v[28:31], a[16:19], v[52:55]
 v_cvt_pk_bf16_f32 v104, v80, v81
 v_mfma_f32_16x16x32_bf16 v[56:59], v[24:27], a[20:23], v[56:59]
 v_cvt_pk_bf16_f32 v105, v82, v83
 v_mfma_f32_16x16x32_bf16 v[60:63], v[28:31], a[20:23], v[60:63]
 v_cvt_pk_bf16_f32 v106, v84, v85
 v_mfma_f32_16x16x32_bf16 v[64:67], v[24:27], a[24:27], v[64:67]
 v_cvt_pk_bf16_f32 v107, v86, v87
 v_mfma_f32_16x16x32_bf16 v[68:71], v[28:31], a[24:27], v[68:71]
 v_min_u32 v104, -2, v104
 v_mfma_f32_16x16x32_bf16 v[72:75], v[24:27], a[28:31], v[72:75]
 buffer_store_dwordx4 v[104:107], v7, s[24:27], s43 offen offset:0 sc1
 v_mfma_f32_16x16x32_bf16 v[76:79], v[28:31], a[28:31], v[76:79]
 s_waitcnt lgkmcnt(2)
 v_mfma_f32_16x16x32_bf16 v[48:51], v[32:35], a[32:35], v[48:51]
 ds_read_b128 v[16:19], v3 offset:4096
 ds_read_b128 v[20:23], v3 offset:18432
 v_mfma_f32_16x16x32_bf16 v[52:55], v[36:39], a[32:35], v[52:55]
 v_mfma_f32_16x16x32_bf16 v[56:59], v[32:35], a[36:39], v[56:59]
 v_mfma_f32_16x16x32_bf16 v[60:63], v[36:39], a[36:39], v[60:63]
 v_mfma_f32_16x16x32_bf16 v[64:67], v[32:35], a[40:43], v[64:67]
 v_mfma_f32_16x16x32_bf16 v[68:71], v[36:39], a[40:43], v[68:71]
 v_mfma_f32_16x16x32_bf16 v[72:75], v[32:35], a[44:47], v[72:75]
 v_mfma_f32_16x16x32_bf16 v[76:79], v[36:39], a[44:47], v[76:79]
 s_waitcnt lgkmcnt(2)
 v_mfma_f32_16x16x32_bf16 v[48:51], v[40:43], a[48:51], v[48:51]
 ds_read_b128 v[24:27], v3 offset:5120
 ds_read_b128 v[28:31], v3 offset:19456
 v_mfma_f32_16x16x32_bf16 v[52:55], v[44:47], a[48:51], v[52:55]
 v_cvt_pk_bf16_f32 v108, v88, v89
 v_mfma_f32_16x16x32_bf16 v[56:59], v[40:43], a[52:55], v[56:59]
 v_cvt_pk_bf16_f32 v109, v90, v91
 v_mfma_f32_16x16x32_bf16 v[60:63], v[44:47], a[52:55], v[60:63]
 v_cvt_pk_bf16_f32 v110, v92, v93
 v_mfma_f32_16x16x32_bf16 v[64:67], v[40:43], a[56:59], v[64:67]
 v_cvt_pk_bf16_f32 v111, v94, v95
 v_mfma_f32_16x16x32_bf16 v[68:71], v[44:47], a[56:59], v[68:71]
 v_min_u32 v108, -2, v108
 v_mfma_f32_16x16x32_bf16 v[72:75], v[40:43], a[60:63], v[72:75]
 buffer_store_dwordx4 v[108:111], v7, s[24:27], s43 offen offset:1024 sc1
 v_mfma_f32_16x16x32_bf16 v[76:79], v[44:47], a[60:63], v[76:79]
 s_waitcnt lgkmcnt(2)
 v_mfma_f32_16x16x32_bf16 v[48:51], v[16:19], a[64:67], v[48:51]
 ds_read_b128 v[32:35], v3 offset:6144
 ds_read_b128 v[36:39], v3 offset:20480
 v_mfma_f32_16x16x32_bf16 v[52:55], v[20:23], a[64:67], v[52:55]
 v_mfma_f32_16x16x32_bf16 v[56:59], v[16:19], a[68:71], v[56:59]
 v_mfma_f32_16x16x32_bf16 v[60:63], v[20:23], a[68:71], v[60:63]
 v_mfma_f32_16x16x32_bf16 v[64:67], v[16:19], a[72:75], v[64:67]
 v_mfma_f32_16x16x32_bf16 v[68:71], v[20:23], a[72:75], v[68:71]
 v_mfma_f32_16x16x32_bf16 v[72:75], v[16:19], a[76:79], v[72:75]
 v_mfma_f32_16x16x32_bf16 v[76:79], v[20:23], a[76:79], v[76:79]
 s_waitcnt lgkmcnt(2)
 v_mfma_f32_16x16x32_bf16 v[48:51], v[24:27], a[80:83], v[48:51]
 ds_read_b128 v[40:43], v3 offset:7168
 ds_read_b128 v[44:47], v3 offset:21504
 v_mfma_f32_16x16x32_bf16 v[52:55], v[28:31], a[80:83], v[52:55]
 v_cvt_pk_bf16_f32 v104, v96, v97
 v_mfma_f32_16x16x32_bf16 v[56:59], v[24:27], a[84:87], v[56:59]
 v_cvt_pk_bf16_f32 v105, v98, v99
 v_mfma_f32_16x16x32_bf16 v[60:63], v[28:31], a[84:87], v[60:63]
 v_cvt_pk_bf16_f32 v106, v100, v101
 v_mfma_f32_16x16x32_bf16 v[64:67], v[24:27], a[88:91], v[64:67]
 v_cvt_pk_bf16_f32 v107, v102, v103
 v_mfma_f32_16x16x32_bf16 v[68:71], v[28:31], a[88:91], v[68:71]
 v_min_u32 v104, -2, v104
 v_mfma_f32_16x16x32_bf16 v[72:75], v[24:27], a[92:95], v[72:75]
 buffer_store_dwordx4 v[104:107], v7, s[24:27], s43 offen offset:2048 sc1
 v_mfma_f32_16x16x32_bf16 v[76:79], v[28:31], a[92:95], v[76:79]
 s_waitcnt lgkmcnt(2)
 v_mfma_f32_16x16x32_bf16 v[48:51], v[32:35], a[96:99], v[48:51]
 ds_read_b128 v[16:19], v3 offset:8192
 ds_read_b128 v[20:23], v3 offset:22528
 v_mfma_f32_16x16x32_bf16 v[52:55], v[36:39], a[96:99], v[52:55]
 v_mfma_f32_16x16x32_bf16 v[56:59], v[32:35], a[100:103], v[56:59]
 v_mfma_f32_16x16x32_bf16 v[60:63], v[36:39], a[100:103], v[60:63]
 v_mfma_f32_16x16x32_bf16 v[64:67], v[32:35], a[104:107], v[64:67]
 v_mfma_f32_16x16x32_bf16 v[68:71], v[36:39], a[104:107], v[68:71]
 v_mfma_f32_16x16x32_bf16 v[72:75], v[32:35], a[108:111], v[72:75]
 v_mfma_f32_16x16x32_bf16 v[76:79], v[36:39], a[108:111], v[76:79]
 s_waitcnt lgkmcnt(2)
 v_mfma_f32_16x16x32_bf16 v[48:51], v[40:43], a[112:115], v[48:51]
 ds_read_b128 v[24:27], v3 offset:9216
 ds_read_b128 v[28:31], v3 offset:23552
 v_mfma_f32_16x16x32_bf16 v[52:55], v[44:47], a[112:115], v[52:55]
 v_mfma_f32_16x16x32_bf16 v[56:59], v[40:43], a[116:119], v[56:59]
 v_mfma_f32_16x16x32_bf16 v[60:63], v[44:47], a[116:119], v[60:63]
 v_mfma_f32_16x16x32_bf16 v[64:67], v[40:43], a[120:123], v[64:67]
 v_mfma_f32_16x16x32_bf16 v[68:71], v[44:47], a[120:123], v[68:71]
 v_mfma_f32_16x16x32_bf16 v[72:75], v[40:43], a[124:127], v[72:75]
 v_mfma_f32_16x16x32_bf16 v[76:79], v[44:47], a[124:127], v[76:79]
 s_waitcnt lgkmcnt(2)
 v_mfma_f32_16x16x32_bf16 v[48:51], v[16:19], a[128:131], v[48:51]
 ds_read_b128 v[32:35], v3 offset:10240
 ds_read_b128 v[36:39], v3 offset:24576
 v_mfma_f32_16x16x32_bf16 v[52:55], v[20:23], a[128:131], v[52:55]
 v_mfma_f32_16x16x32_bf16 v[56:59], v[16:19], a[132:135], v[56:59]
 v_mfma_f32_16x16x32_bf16 v[60:63], v[20:23], a[132:135], v[60:63]
 v_mfma_f32_16x16x32_bf16 v[64:67], v[16:19], a[136:139], v[64:67]
 v_mfma_f32_16x16x32_bf16 v[68:71], v[20:23], a[136:139], v[68:71]
 v_mfma_f32_16x16x32_bf16 v[72:75], v[16:19], a[140:143], v[72:75]
 v_mfma_f32_16x16x32_bf16 v[76:79], v[20:23], a[140:143], v[76:79]
 s_waitcnt lgkmcnt(2)
 v_mfma_f32_16x16x32_bf16 v[48:51], v[24:27], a[144:147], v[48:51]
 ds_read_b128 v[40:43], v3 offset:11264
 ds_read_b128 v[44:47], v3 offset:25600
 v_mfma_f32_16x16x32_bf16 v[52:55], v[28:31], a[144:147], v[52:55]
 v_mfma_f32_16x16x32_bf16 v[56:59], v[24:27], a[148:151], v[56:59]
 v_mfma_f32_16x16x32_bf16 v[60:63], v[28:31], a[148:151], v[60:63]
 v_mfma_f32_16x16x32_bf16 v[64:67], v[24:27], a[152:155], v[64:67]
 v_mfma_f32_16x16x32_bf16 v[68:71], v[28:31], a[152:155], v[68:71]
 v_mfma_f32_16x16x32_bf16 v[72:75], v[24:27], a[156:159], v[72:75]
 v_mfma_f32_16x16x32_bf16 v[76:79], v[28:31], a[156:159], v[76:79]
 s_waitcnt lgkmcnt(2)
 v_mfma_f32_16x16x32_bf16 v[48:51], v[32:35], a[160:163], v[48:51]
 ds_read_b128 v[16:19], v3 offset:12288
 ds_read_b128 v[20:23], v3 offset:26624
 v_mfma_f32_16x16x32_bf16 v[52:55], v[36:39], a[160:163], v[52:55]
 v_mfma_f32_16x16x32_bf16 v[56:59], v[32:35], a[164:167], v[56:59]
 v_mfma_f32_16x16x32_bf16 v[60:63], v[36:39], a[164:167], v[60:63]
 v_mfma_f32_16x16x32_bf16 v[64:67], v[32:35], a[168:171], v[64:67]
 v_mfma_f32_16x16x32_bf16 v[68:71], v[36:39], a[168:171], v[68:71]
 v_mfma_f32_16x16x32_bf16 v[72:75], v[32:35], a[172:175], v[72:75]
 v_mfma_f32_16x16x32_bf16 v[76:79], v[36:39], a[172:175], v[76:79]
 s_waitcnt lgkmcnt(2)
 v_mfma_f32_16x16x32_bf16 v[48:51], v[40:43], a[176:179], v[48:51]
 ds_read_b128 v[24:27], v3 offset:13312
 ds_read_b128 v[28:31], v3 offset:27648
 v_mfma_f32_16x16x32_bf16 v[52:55], v[44:47], a[176:179], v[52:55]
 v_mfma_f32_16x16x32_bf16 v[56:59], v[40:43], a[180:183], v[56:59]
 v_mfma_f32_16x16x32_bf16 v[60:63], v[44:47], a[180:183], v[60:63]
 v_mfma_f32_16x16x32_bf16 v[64:67], v[40:43], a[184:187], v[64:67]
 v_mfma_f32_16x16x32_bf16 v[68:71], v[44:47], a[184:187], v[68:71]
 v_mfma_f32_16x16x32_bf16 v[72:75], v[40:43], a[188:191], v[72:75]
 v_mfma_f32_16x16x32_bf16 v[76:79], v[44:47], a[188:191], v[76:79]
 s_waitcnt lgkmcnt(2)
 v_mfma_f32_16x16x32_bf16 v[48:51], v[16:19], a[192:195], v[48:51]
 ds_read_b128 v[32:35], v3 offset:0
 ds_read_b128 v[36:39], v3 offset:14336
 v_mfma_f32_16x16x32_bf16 v[52:55], v[20:23], a[192:195], v[52:55]
 v_mfma_f32_16x16x32_bf16 v[56:59], v[16:19], a[196:199], v[56:59]
 v_mfma_f32_16x16x32_bf16 v[60:63], v[20:23], a[196:199], v[60:63]
 v_mfma_f32_16x16x32_bf16 v[64:67], v[16:19], a[200:203], v[64:67]
 v_mfma_f32_16x16x32_bf16 v[68:71], v[20:23], a[200:203], v[68:71]
 v_mfma_f32_16x16x32_bf16 v[72:75], v[16:19], a[204:207], v[72:75]
 v_mfma_f32_16x16x32_bf16 v[76:79], v[20:23], a[204:207], v[76:79]
 s_waitcnt lgkmcnt(2)
 v_mfma_f32_16x16x32_bf16 v[48:51], v[24:27], a[208:211], v[48:51]
 ds_read_b128 v[40:43], v3 offset:1024
 ds_read_b128 v[44:47], v3 offset:15360
 v_mfma_f32_16x16x32_bf16 v[52:55], v[28:31], a[208:211], v[52:55]
 v_mfma_f32_16x16x32_bf16 v[56:59], v[24:27], a[212:215], v[56:59]
 v_mfma_f32_16x16x32_bf16 v[60:63], v[28:31], a[212:215], v[60:63]
 v_mfma_f32_16x16x32_bf16 v[64:67], v[24:27], a[216:219], v[64:67]
 v_mfma_f32_16x16x32_bf16 v[68:71], v[28:31], a[216:219], v[68:71]
 v_mfma_f32_16x16x32_bf16 v[72:75], v[24:27], a[220:223], v[72:75]
 v_mfma_f32_16x16x32_bf16 v[76:79], v[28:31], a[220:223], v[76:79]
 s_waitcnt lgkmcnt(2)
 s_waitcnt vmcnt(0)
 s_barrier
 buffer_store_dword v10, v9, s[56:59], s60 offen sc1
 v_mfma_f32_16x16x32_bf16 v[80:83], v[32:35], a[224:227], 0
 ds_read_b128 v[16:19], v3 offset:2048
 ds_read_b128 v[20:23], v3 offset:16384
 v_mfma_f32_16x16x32_bf16 v[84:87], v[36:39], a[224:227], 0
 v_mfma_f32_16x16x32_bf16 v[88:91], v[32:35], a[228:231], 0
 v_mfma_f32_16x16x32_bf16 v[92:95], v[36:39], a[228:231], 0
 v_mfma_f32_16x16x32_bf16 v[96:99], v[32:35], a[232:235], 0
 v_mfma_f32_16x16x32_bf16 v[100:103], v[36:39], a[232:235], 0
 s_waitcnt lgkmcnt(2)
 v_mfma_f32_16x16x32_bf16 v[80:83], v[40:43], a[236:239], v[80:83]
 ds_read_b128 v[24:27], v3 offset:3072
 ds_read_b128 v[28:31], v3 offset:17408
 v_mfma_f32_16x16x32_bf16 v[84:87], v[44:47], a[236:239], v[84:87]
 v_cvt_pk_bf16_f32 v104, v48, v49
 v_mfma_f32_16x16x32_bf16 v[88:91], v[40:43], a[240:243], v[88:91]
 v_cvt_pk_bf16_f32 v105, v50, v51
 v_mfma_f32_16x16x32_bf16 v[92:95], v[44:47], a[240:243], v[92:95]
 v_cvt_pk_bf16_f32 v106, v52, v53
 v_mfma_f32_16x16x32_bf16 v[96:99], v[40:43], a[244:247], v[96:99]
 v_cvt_pk_bf16_f32 v107, v54, v55
 v_mfma_f32_16x16x32_bf16 v[100:103], v[44:47], a[244:247], v[100:103]
 s_waitcnt lgkmcnt(2)
 v_min_u32 v104, -2, v104
 v_mfma_f32_16x16x32_bf16 v[80:83], v[16:19], a[248:251], v[80:83]
 ds_read_b128 v[32:35], v3 offset:4096
 ds_read_b128 v[36:39], v3 offset:18432
 buffer_store_dwordx4 v[104:107], v6, s[24:27], s42 offen offset:0 sc1
 v_mfma_f32_16x16x32_bf16 v[84:87], v[20:23], a[248:251], v[84:87]
 v_mfma_f32_16x16x32_bf16 v[88:91], v[16:19], a[252:255], v[88:91]
 v_mfma_f32_16x16x32_bf16 v[92:95], v[20:23], a[252:255], v[92:95]
 v_mfma_f32_16x16x32_bf16 v[96:99], v[16:19], v[120:123], v[96:99]
 v_mfma_f32_16x16x32_bf16 v[100:103], v[20:23], v[120:123], v[100:103]
 s_waitcnt lgkmcnt(2)
 v_mfma_f32_16x16x32_bf16 v[80:83], v[24:27], v[124:127], v[80:83]
 ds_read_b128 v[40:43], v3 offset:5120
 ds_read_b128 v[44:47], v3 offset:19456
 v_mfma_f32_16x16x32_bf16 v[84:87], v[28:31], v[124:127], v[84:87]
 v_cvt_pk_bf16_f32 v108, v56, v57
 v_mfma_f32_16x16x32_bf16 v[88:91], v[24:27], v[128:131], v[88:91]
 v_cvt_pk_bf16_f32 v109, v58, v59
 v_mfma_f32_16x16x32_bf16 v[92:95], v[28:31], v[128:131], v[92:95]
 v_cvt_pk_bf16_f32 v110, v60, v61
 v_mfma_f32_16x16x32_bf16 v[96:99], v[24:27], v[132:135], v[96:99]
 v_cvt_pk_bf16_f32 v111, v62, v63
 v_mfma_f32_16x16x32_bf16 v[100:103], v[28:31], v[132:135], v[100:103]
 s_waitcnt lgkmcnt(2)
 v_min_u32 v108, -2, v108
 v_mfma_f32_16x16x32_bf16 v[80:83], v[32:35], v[136:139], v[80:83]
 ds_read_b128 v[16:19], v3 offset:6144
 ds_read_b128 v[20:23], v3 offset:20480
 buffer_store_dwordx4 v[108:111], v6, s[24:27], s42 offen offset:1024 sc1
 v_mfma_f32_16x16x32_bf16 v[84:87], v[36:39], v[136:139], v[84:87]
 v_mfma_f32_16x16x32_bf16 v[88:91], v[32:35], v[140:143], v[88:91]
 v_mfma_f32_16x16x32_bf16 v[92:95], v[36:39], v[140:143], v[92:95]
 v_mfma_f32_16x16x32_bf16 v[96:99], v[32:35], v[144:147], v[96:99]
 v_mfma_f32_16x16x32_bf16 v[100:103], v[36:39], v[144:147], v[100:103]
 s_waitcnt lgkmcnt(2)
 v_mfma_f32_16x16x32_bf16 v[80:83], v[40:43], v[148:151], v[80:83]
 ds_read_b128 v[24:27], v3 offset:7168
 ds_read_b128 v[28:31], v3 offset:21504
 v_mfma_f32_16x16x32_bf16 v[84:87], v[44:47], v[148:151], v[84:87]
 v_cvt_pk_bf16_f32 v104, v64, v65
 v_mfma_f32_16x16x32_bf16 v[88:91], v[40:43], v[152:155], v[88:91]
 v_cvt_pk_bf16_f32 v105, v66, v67
 v_mfma_f32_16x16x32_bf16 v[92:95], v[44:47], v[152:155], v[92:95]
 v_cvt_pk_bf16_f32 v106, v68, v69
 v_mfma_f32_16x16x32_bf16 v[96:99], v[40:43], v[156:159], v[96:99]
 v_cvt_pk_bf16_f32 v107, v70, v71
 v_mfma_f32_16x16x32_bf16 v[100:103], v[44:47], v[156:159], v[100:103]
 s_waitcnt lgkmcnt(2)
 v_min_u32 v104, -2, v104
 v_mfma_f32_16x16x32_bf16 v[80:83], v[16:19], v[160:163], v[80:83]
 ds_read_b128 v[32:35], v3 offset:8192
 ds_read_b128 v[36:39], v3 offset:22528
 buffer_store_dwordx4 v[104:107], v6, s[24:27], s42 offen offset:2048 sc1
 v_mfma_f32_16x16x32_bf16 v[84:87], v[20:23], v[160:163], v[84:87]
 v_mfma_f32_16x16x32_bf16 v[88:91], v[16:19], v[164:167], v[88:91]
 v_mfma_f32_16x16x32_bf16 v[92:95], v[20:23], v[164:167], v[92:95]
 v_mfma_f32_16x16x32_bf16 v[96:99], v[16:19], v[168:171], v[96:99]
 v_mfma_f32_16x16x32_bf16 v[100:103], v[20:23], v[168:171], v[100:103]
 s_waitcnt lgkmcnt(2)
 v_mfma_f32_16x16x32_bf16 v[80:83], v[24:27], v[172:175], v[80:83]
 ds_read_b128 v[40:43], v3 offset:9216
 ds_read_b128 v[44:47], v3 offset:23552
 v_mfma_f32_16x16x32_bf16 v[84:87], v[28:31], v[172:175], v[84:87]
 v_cvt_pk_bf16_f32 v108, v72, v73
 v_mfma_f32_16x16x32_bf16 v[88:91], v[24:27], v[176:179], v[88:91]
 v_cvt_pk_bf16_f32 v109, v74, v75
 v_mfma_f32_16x16x32_bf16 v[92:95], v[28:31], v[176:179], v[92:95]
 v_cvt_pk_bf16_f32 v110, v76, v77
 v_mfma_f32_16x16x32_bf16 v[96:99], v[24:27], v[180:183], v[96:99]
 v_cvt_pk_bf16_f32 v111, v78, v79
 v_mfma_f32_16x16x32_bf16 v[100:103], v[28:31], v[180:183], v[100:103]
 s_waitcnt lgkmcnt(2)
 v_min_u32 v108, -2, v108
 v_mfma_f32_16x16x32_bf16 v[80:83], v[32:35], v[184:187], v[80:83]
 ds_read_b128 v[16:19], v3 offset:10240
 ds_read_b128 v[20:23], v3 offset:24576
 buffer_store_dwordx4 v[108:111], v6, s[24:27], s42 offen offset:3072 sc1
 v_mfma_f32_16x16x32_bf16 v[84:87], v[36:39], v[184:187], v[84:87]
 v_mfma_f32_16x16x32_bf16 v[88:91], v[32:35], v[188:191], v[88:91]
 v_mfma_f32_16x16x32_bf16 v[92:95], v[36:39], v[188:191], v[92:95]
 v_mfma_f32_16x16x32_bf16 v[96:99], v[32:35], v[192:195], v[96:99]
 v_mfma_f32_16x16x32_bf16 v[100:103], v[36:39], v[192:195], v[100:103]
 s_waitcnt lgkmcnt(2)
 v_mfma_f32_16x16x32_bf16 v[80:83], v[40:43], v[196:199], v[80:83]
 ds_read_b128 v[24:27], v3 offset:11264
 ds_read_b128 v[28:31], v3 offset:25600
 v_mfma_f32_16x16x32_bf16 v[84:87], v[44:47], v[196:199], v[84:87]
 v_mfma_f32_16x16x32_bf16 v[88:91], v[40:43], v[200:203], v[88:91]
 v_mfma_f32_16x16x32_bf16 v[92:95], v[44:47], v[200:203], v[92:95]
 v_mfma_f32_16x16x32_bf16 v[96:99], v[40:43], v[204:207], v[96:99]
 v_cmp_eq_u32 vcc, s51, v13
 s_nop 1
 v_cndmask_b32 v14, 1, v12, vcc
 v_cmp_eq_u32 vcc, 0, v14
 v_mfma_f32_16x16x32_bf16 v[100:103], v[44:47], v[204:207], v[100:103]
 s_waitcnt lgkmcnt(2)
 s_cbranch_vccnz ka_xs_36
ka_xb_37:
 v_mfma_f32_16x16x32_bf16 v[80:83], v[16:19], v[208:211], v[80:83]
 ds_read_b128 v[32:35], v3 offset:12288
 ds_read_b128 v[36:39], v3 offset:26624
 v_mfma_f32_16x16x32_bf16 v[84:87], v[20:23], v[208:211], v[84:87]
 s_mul_i32 s8, s6, 7168
 v_mfma_f32_16x16x32_bf16 v[88:91], v[16:19], v[212:215], v[88:91]
 s_add_u32 s8, s8, s41
 v_mfma_f32_16x16x32_bf16 v[92:95], v[20:23], v[212:215], v[92:95]
 v_mfma_f32_16x16x32_bf16 v[96:99], v[16:19], v[216:219], v[96:99]
 s_mov_b32 m0, s8
 v_mfma_f32_16x16x32_bf16 v[100:103], v[20:23], v[216:219], v[100:103]
 s_waitcnt lgkmcnt(2)
 buffer_load_dwordx4 v5, s[20:23], 0 offen offset:0 lds
 v_mfma_f32_16x16x32_bf16 v[80:83], v[24:27], v[220:223], v[80:83]
 ds_read_b128 v[40:43], v3 offset:13312
 ds_read_b128 v[44:47], v3 offset:27648
 v_mfma_f32_16x16x32_bf16 v[84:87], v[28:31], v[220:223], v[84:87]
 buffer_load_dwordx4 v5, s[20:23], 0 offen offset:1024 lds
 v_mfma_f32_16x16x32_bf16 v[88:91], v[24:27], v[224:227], v[88:91]
 buffer_load_dwordx4 v5, s[20:23], 0 offen offset:2048 lds
 v_mfma_f32_16x16x32_bf16 v[92:95], v[28:31], v[224:227], v[92:95]
 v_mfma_f32_16x16x32_bf16 v[96:99], v[24:27], v[228:231], v[96:99]
 buffer_load_dwordx4 v5, s[20:23], 0 offen offset:3072 lds
 v_mfma_f32_16x16x32_bf16 v[100:103], v[28:31], v[228:231], v[100:103]
 s_waitcnt lgkmcnt(2)
 s_add_u32 s8, s8, 4096
 v_mfma_f32_16x16x32_bf16 v[80:83], v[32:35], v[232:235], v[80:83]
 ds_read_b128 v[16:19], v4 offset:0
 ds_read_b128 v[20:23], v4 offset:14336
 v_mfma_f32_16x16x32_bf16 v[84:87], v[36:39], v[232:235], v[84:87]
 s_mov_b32 m0, s8
 v_mfma_f32_16x16x32_bf16 v[88:91], v[32:35], v[236:239], v[88:91]
 buffer_load_dwordx4 v5, s[20:23], s44 offen offset:0 lds
 v_mfma_f32_16x16x32_bf16 v[92:95], v[36:39], v[236:239], v[92:95]
 v_mfma_f32_16x16x32_bf16 v[96:99], v[32:35], v[240:243], v[96:99]
 buffer_load_dwordx4 v5, s[20:23], s44 offen offset:1024 lds
 v_mfma_f32_16x16x32_bf16 v[100:103], v[36:39], v[240:243], v[100:103]
 s_waitcnt lgkmcnt(2)
 buffer_load_dwordx4 v5, s[20:23], s44 offen offset:2048 lds
 v_mfma_f32_16x16x32_bf16 v[80:83], v[40:43], v[244:247], v[80:83]
 ds_read_b128 v[24:27], v4 offset:1024
 ds_read_b128 v[28:31], v4 offset:15360
 v_mfma_f32_16x16x32_bf16 v[84:87], v[44:47], v[244:247], v[84:87]
 v_add_u32 v5, 114688, v5
 v_mfma_f32_16x16x32_bf16 v[88:91], v[40:43], v[248:251], v[88:91]
 v_mfma_f32_16x16x32_bf16 v[92:95], v[44:47], v[248:251], v[92:95]
 v_mfma_f32_16x16x32_bf16 v[96:99], v[40:43], v[252:255], v[96:99]
 v_mfma_f32_16x16x32_bf16 v[100:103], v[44:47], v[252:255], v[100:103]
 s_mov_b32 s8, s39
 s_mov_b32 s39, s40
 s_mov_b32 s40, s41
 s_mov_b32 s41, s8
 v_mov_b32 v3, v4
 v_add_u32 v4, s40, v2
 v_mov_b32 v7, v8
 s_mov_b32 s43, s42
 s_add_u32 s42, s42, 1835008
 s_add_u32 s60, s37, 1
 s_lshl_b32 s60, s60, 8
 s_add_u32 s37, s37, 4
 s_sub_u32 s38, s38, 1
 s_cmp_eq_u32 s38, 15
 s_cbranch_scc1 ka_ef_38
 s_cmp_lg_u32 s38, 0
 s_cbranch_scc1 ka_gx_loop
 s_nop 7
 v_cvt_pk_bf16_f32 v104, v80, v81
 v_cvt_pk_bf16_f32 v105, v82, v83
 v_cvt_pk_bf16_f32 v106, v84, v85
 v_cvt_pk_bf16_f32 v107, v86, v87
 v_min_u32 v104, -2, v104
 buffer_store_dwordx4 v[104:107], v7, s[24:27], s43 offen offset:0 sc1
 v_cvt_pk_bf16_f32 v108, v88, v89
 v_cvt_pk_bf16_f32 v109, v90, v91
 v_cvt_pk_bf16_f32 v110, v92, v93
 v_cvt_pk_bf16_f32 v111, v94, v95
 v_min_u32 v108, -2, v108
 buffer_store_dwordx4 v[108:111], v7, s[24:27], s43 offen offset:1024 sc1
 v_cvt_pk_bf16_f32 v104, v96, v97
 v_cvt_pk_bf16_f32 v105, v98, v99
 v_cvt_pk_bf16_f32 v106, v100, v101
 v_cvt_pk_bf16_f32 v107, v102, v103
 v_min_u32 v104, -2, v104
 buffer_store_dwordx4 v[104:107], v7, s[24:27], s43 offen offset:2048 sc1
 s_waitcnt vmcnt(0)
 s_barrier
 buffer_store_dword v10, v9, s[56:59], s60 offen sc1
 s_add_u32 s28, s76, 55848960
 s_addc_u32 s29, s77, 0
 s_mov_b32 s30, 465920
 s_mov_b32 s31, 0x20000
 s_add_u32 s24, s76, 57102336
 s_addc_u32 s25, s77, 0
 s_mov_b32 s26, 7340032
 s_mov_b32 s27, 0x20000
 s_sub_u32 s37, s37, 64
 s_mov_b32 s38, 16
 s_mov_b32 s61, 0
 s_lshl_b32 s12, s6, 10
 v_add_u32 v3, s12, v2
 s_add_u32 s13, s12, 4096
 s_cmp_eq_u32 s6, 3
 s_cselect_b32 s12, s12, s13
 v_add_u32 v4, s12, v2
 v_and_b32 v20, 15, v1
 v_lshrrev_b32 v21, 4, v1

 v_and_b32 v22, 7, v20
 v_lshlrev_b32 v22, 5, v22
 v_lshrrev_b32 v23, 1, v21
 v_lshl_add_u32 v22, v23, 8, v22
 v_and_b32 v23, 1, v21
 v_lshl_add_u32 v22, v23, 3, v22
 v_add_u32 v52, 0, v22
 v_add_u32 v60, 1024, v22
 v_add_u32 v68, 2048, v22
 v_add_u32 v76, 3072, v22
 v_add_u32 v84, 4096, v22
 v_add_u32 v92, 5120, v22
 v_add_u32 v100, 6144, v22

 s_lshr_b32 s8, s36, 2
 s_mul_i32 s8, s8, 28
 s_mul_i32 s9, s6, 7
 s_add_u32 s8, s8, s9
 s_lshl_b32 s8, s8, 10
 s_and_b32 s9, s36, 3
 s_lshl_b32 s9, s9, 8
 s_add_u32 s8, s8, s9
 v_lshlrev_b32 v22, 4, v20
 v_lshl_add_u32 v22, v21, 3, v22
 v_add_u32 v22, s8, v22
 v_mov_b32 v23, 1073741824
 v_cmp_gt_u32 vcc, 2, v21
 s_nop 1
 v_cndmask_b32 v6, v23, v22, vcc
 v_add_u32 v7, 4096, v6
 v_add_u32 v9, 64, v9
 s_mul_i32 s45, s37, 7168
 s_mul_i32 s42, s37, 114688
 s_add_u32 s60, s37, 1
 s_lshl_b32 s60, s60, 8
 v_and_b32 v20, 63, v0
 v_lshlrev_b32 v20, 2, v20
 s_mov_b32 s8, 20736
ka_ff_39:
 buffer_load_dword v21, v20, s[56:59], s8 offen sc1
 s_waitcnt vmcnt(0)
 v_cmp_eq_u32 vcc, 0, v21
 s_cbranch_vccz ka_fk_40
 s_add_u32 s61, s61, 1
 s_cmp_lt_u32 s61, 400000
 s_cbranch_scc1 ka_ff_39
 s_branch ka_end
ka_fk_40:
ka_gu_loop:
ka_mp_41:
 buffer_load_dwordx4 v[16:19], v3, s[28:31], s45 offen sc0 sc1
 buffer_load_dwordx4 v[20:23], v4, s[28:31], s45 offen sc0 sc1
 s_waitcnt vmcnt(0)
 v_max3_u32 v104, v16, v17, v18
 v_max3_u32 v105, v19, v20, v21
 v_max3_u32 v104, v104, v22, v23
 v_max_u32 v104, v104, v105
 v_cmp_eq_u32 vcc, -1, v104
 s_cbranch_vccz ka_mok_42
 s_add_u32 s61, s61, 1
 s_cmp_lt_u32 s61, 400000
 s_cbranch_scc1 ka_mp_41
 s_branch ka_end
ka_mok_42:
 ds_write_b128 v3, v[16:19]
 ds_write_b128 v4, v[20:23]
 s_waitcnt lgkmcnt(0)
 s_barrier
 ds_read2_b32 v[16:17], v52 offset0:0 offset1:4
 ds_read2_b32 v[18:19], v52 offset0:1 offset1:5
 ds_read2_b32 v[20:21], v52 offset0:128 offset1:132
 ds_read2_b32 v[22:23], v52 offset0:129 offset1:133
 ds_read2_b32 v[24:25], v60 offset0:0 offset1:4
 ds_read2_b32 v[26:27], v60 offset0:1 offset1:5
 ds_read2_b32 v[28:29], v60 offset0:128 offset1:132
 ds_read2_b32 v[30:31], v60 offset0:129 offset1:133
 s_waitcnt lgkmcnt(6)
 v_mfma_f32_16x16x32_bf16 v[48:51], v[16:19], a[0:3], 0
 v_mfma_f32_16x16x32_bf16 v[56:59], v[16:19], a[4:7], 0
 v_mfma_f32_16x16x32_bf16 v[64:67], v[16:19], a[8:11], 0
 v_mfma_f32_16x16x32_bf16 v[72:75], v[16:19], a[12:15], 0
 v_mfma_f32_16x16x32_bf16 v[80:83], v[16:19], a[224:227], 0
 v_mfma_f32_16x16x32_bf16 v[88:91], v[16:19], a[228:231], 0
 v_mfma_f32_16x16x32_bf16 v[96:99], v[16:19], a[232:235], 0
 ds_read2_b32 v[16:17], v68 offset0:0 offset1:4
 ds_read2_b32 v[18:19], v68 offset0:1 offset1:5
 s_waitcnt lgkmcnt(6)
 v_mfma_f32_16x16x32_bf16 v[48:51], v[20:23], a[16:19], v[48:51]
 v_mfma_f32_16x16x32_bf16 v[56:59], v[20:23], a[20:23], v[56:59]
 v_mfma_f32_16x16x32_bf16 v[64:67], v[20:23], a[24:27], v[64:67]
 v_mfma_f32_16x16x32_bf16 v[72:75], v[20:23], a[28:31], v[72:75]
 v_mfma_f32_16x16x32_bf16 v[80:83], v[20:23], a[236:239], v[80:83]
 v_mfma_f32_16x16x32_bf16 v[88:91], v[20:23], a[240:243], v[88:91]
 v_mfma_f32_16x16x32_bf16 v[96:99], v[20:23], a[244:247], v[96:99]
 ds_read2_b32 v[20:21], v68 offset0:128 offset1:132
 ds_read2_b32 v[22:23], v68 offset0:129 offset1:133
 s_waitcnt lgkmcnt(6)
 v_mfma_f32_16x16x32_bf16 v[48:51], v[24:27], a[32:35], v[48:51]
 v_mfma_f32_16x16x32_bf16 v[56:59], v[24:27], a[36:39], v[56:59]
 v_mfma_f32_16x16x32_bf16 v[64:67], v[24:27], a[40:43], v[64:67]
 v_mfma_f32_16x16x32_bf16 v[72:75], v[24:27], a[44:47], v[72:75]
 v_mfma_f32_16x16x32_bf16 v[80:83], v[24:27], a[248:251], v[80:83]
 v_mfma_f32_16x16x32_bf16 v[88:91], v[24:27], a[252:255], v[88:91]
 v_mfma_f32_16x16x32_bf16 v[96:99], v[24:27], v[120:123], v[96:99]
 ds_read2_b32 v[24:25], v76 offset0:0 offset1:4
 ds_read2_b32 v[26:27], v76 offset0:1 offset1:5
 s_waitcnt lgkmcnt(6)
 v_mfma_f32_16x16x32_bf16 v[48:51], v[28:31], a[48:51], v[48:51]
 v_mfma_f32_16x16x32_bf16 v[56:59], v[28:31], a[52:55], v[56:59]
 v_mfma_f32_16x16x32_bf16 v[64:67], v[28:31], a[56:59], v[64:67]
 v_mfma_f32_16x16x32_bf16 v[72:75], v[28:31], a[60:63], v[72:75]
 v_mfma_f32_16x16x32_bf16 v[80:83], v[28:31], v[124:127], v[80:83]
 v_mfma_f32_16x16x32_bf16 v[88:91], v[28:31], v[128:131], v[88:91]
 v_mfma_f32_16x16x32_bf16 v[96:99], v[28:31], v[132:135], v[96:99]
 ds_read2_b32 v[28:29], v76 offset0:128 offset1:132
 ds_read2_b32 v[30:31], v76 offset0:129 offset1:133
 s_waitcnt lgkmcnt(6)
 v_mfma_f32_16x16x32_bf16 v[48:51], v[16:19], a[64:67], v[48:51]
 v_mfma_f32_16x16x32_bf16 v[56:59], v[16:19], a[68:71], v[56:59]
 v_mfma_f32_16x16x32_bf16 v[64:67], v[16:19], a[72:75], v[64:67]
 v_mfma_f32_16x16x32_bf16 v[72:75], v[16:19], a[76:79], v[72:75]
 v_mfma_f32_16x16x32_bf16 v[80:83], v[16:19], v[136:139], v[80:83]
 v_mfma_f32_16x16x32_bf16 v[88:91], v[16:19], v[140:143], v[88:91]
 v_mfma_f32_16x16x32_bf16 v[96:99], v[16:19], v[144:147], v[96:99]
 ds_read2_b32 v[16:17], v84 offset0:0 offset1:4
 ds_read2_b32 v[18:19], v84 offset0:1 offset1:5
 s_waitcnt lgkmcnt(6)
 v_mfma_f32_16x16x32_bf16 v[48:51], v[20:23], a[80:83], v[48:51]
 v_mfma_f32_16x16x32_bf16 v[56:59], v[20:23], a[84:87], v[56:59]
 v_mfma_f32_16x16x32_bf16 v[64:67], v[20:23], a[88:91], v[64:67]
 v_mfma_f32_16x16x32_bf16 v[72:75], v[20:23], a[92:95], v[72:75]
 v_mfma_f32_16x16x32_bf16 v[80:83], v[20:23], v[148:151], v[80:83]
 v_mfma_f32_16x16x32_bf16 v[88:91], v[20:23], v[152:155], v[88:91]
 v_mfma_f32_16x16x32_bf16 v[96:99], v[20:23], v[156:159], v[96:99]
 ds_read2_b32 v[20:21], v84 offset0:128 offset1:132
 ds_read2_b32 v[22:23], v84 offset0:129 offset1:133
 s_waitcnt lgkmcnt(6)
 v_mfma_f32_16x16x32_bf16 v[48:51], v[24:27], a[96:99], v[48:51]
 v_mfma_f32_16x16x32_bf16 v[56:59], v[24:27], a[100:103], v[56:59]
 v_mfma_f32_16x16x32_bf16 v[64:67], v[24:27], a[104:107], v[64:67]
 v_mfma_f32_16x16x32_bf16 v[72:75], v[24:27], a[108:111], v[72:75]
 v_mfma_f32_16x16x32_bf16 v[80:83], v[24:27], v[160:163], v[80:83]
 v_mfma_f32_16x16x32_bf16 v[88:91], v[24:27], v[164:167], v[88:91]
 v_mfma_f32_16x16x32_bf16 v[96:99], v[24:27], v[168:171], v[96:99]
 ds_read2_b32 v[24:25], v92 offset0:0 offset1:4
 ds_read2_b32 v[26:27], v92 offset0:1 offset1:5
 s_waitcnt lgkmcnt(6)
 v_mfma_f32_16x16x32_bf16 v[48:51], v[28:31], a[112:115], v[48:51]
 v_mfma_f32_16x16x32_bf16 v[56:59], v[28:31], a[116:119], v[56:59]
 v_mfma_f32_16x16x32_bf16 v[64:67], v[28:31], a[120:123], v[64:67]
 v_mfma_f32_16x16x32_bf16 v[72:75], v[28:31], a[124:127], v[72:75]
 v_mfma_f32_16x16x32_bf16 v[80:83], v[28:31], v[172:175], v[80:83]
 v_mfma_f32_16x16x32_bf16 v[88:91], v[28:31], v[176:179], v[88:91]
 v_mfma_f32_16x16x32_bf16 v[96:99], v[28:31], v[180:183], v[96:99]
 ds_read2_b32 v[28:29], v92 offset0:128 offset1:132
 ds_read2_b32 v[30:31], v92 offset0:129 offset1:133
 s_waitcnt lgkmcnt(6)
 v_mfma_f32_16x16x32_bf16 v[48:51], v[16:19], a[128:131], v[48:51]
 v_mfma_f32_16x16x32_bf16 v[56:59], v[16:19], a[132:135], v[56:59]
 v_mfma_f32_16x16x32_bf16 v[64:67], v[16:19], a[136:139], v[64:67]
 v_mfma_f32_16x16x32_bf16 v[72:75], v[16:19], a[140:143], v[72:75]
 v_mfma_f32_16x16x32_bf16 v[80:83], v[16:19], v[184:187], v[80:83]
 v_mfma_f32_16x16x32_bf16 v[88:91], v[16:19], v[188:191], v[88:91]
 v_mfma_f32_16x16x32_bf16 v[96:99], v[16:19], v[192:195], v[96:99]
 ds_read2_b32 v[16:17], v100 offset0:0 offset1:4
 ds_read2_b32 v[18:19], v100 offset0:1 offset1:5
 s_waitcnt lgkmcnt(6)
 v_mfma_f32_16x16x32_bf16 v[48:51], v[20:23], a[144:147], v[48:51]
 v_mfma_f32_16x16x32_bf16 v[56:59], v[20:23], a[148:151], v[56:59]
 v_mfma_f32_16x16x32_bf16 v[64:67], v[20:23], a[152:155], v[64:67]
 v_mfma_f32_16x16x32_bf16 v[72:75], v[20:23], a[156:159], v[72:75]
 v_mfma_f32_16x16x32_bf16 v[80:83], v[20:23], v[196:199], v[80:83]
 v_mfma_f32_16x16x32_bf16 v[88:91], v[20:23], v[200:203], v[88:91]
 v_mfma_f32_16x16x32_bf16 v[96:99], v[20:23], v[204:207], v[96:99]
 ds_read2_b32 v[20:21], v100 offset0:128 offset1:132
 ds_read2_b32 v[22:23], v100 offset0:129 offset1:133
 s_waitcnt lgkmcnt(6)
 v_mfma_f32_16x16x32_bf16 v[48:51], v[24:27], a[160:163], v[48:51]
 v_mfma_f32_16x16x32_bf16 v[56:59], v[24:27], a[164:167], v[56:59]
 v_mfma_f32_16x16x32_bf16 v[64:67], v[24:27], a[168:171], v[64:67]
 v_mfma_f32_16x16x32_bf16 v[72:75], v[24:27], a[172:175], v[72:75]
 v_mfma_f32_16x16x32_bf16 v[80:83], v[24:27], v[208:211], v[80:83]
 v_mfma_f32_16x16x32_bf16 v[88:91], v[24:27], v[212:215], v[88:91]
 v_mfma_f32_16x16x32_bf16 v[96:99], v[24:27], v[216:219], v[96:99]
 s_waitcnt lgkmcnt(4)
 v_mfma_f32_16x16x32_bf16 v[48:51], v[28:31], a[176:179], v[48:51]
 v_mfma_f32_16x16x32_bf16 v[56:59], v[28:31], a[180:183], v[56:59]
 v_mfma_f32_16x16x32_bf16 v[64:67], v[28:31], a[184:187], v[64:67]
 v_mfma_f32_16x16x32_bf16 v[72:75], v[28:31], a[188:191], v[72:75]
 v_mfma_f32_16x16x32_bf16 v[80:83], v[28:31], v[220:223], v[80:83]
 v_mfma_f32_16x16x32_bf16 v[88:91], v[28:31], v[224:227], v[88:91]
 v_mfma_f32_16x16x32_bf16 v[96:99], v[28:31], v[228:231], v[96:99]
 s_waitcnt lgkmcnt(2)
 v_mfma_f32_16x16x32_bf16 v[48:51], v[16:19], a[192:195], v[48:51]
 v_mfma_f32_16x16x32_bf16 v[56:59], v[16:19], a[196:199], v[56:59]
 v_mfma_f32_16x16x32_bf16 v[64:67], v[16:19], a[200:203], v[64:67]
 v_mfma_f32_16x16x32_bf16 v[72:75], v[16:19], a[204:207], v[72:75]
 v_mfma_f32_16x16x32_bf16 v[80:83], v[16:19], v[232:235], v[80:83]
 v_mfma_f32_16x16x32_bf16 v[88:91], v[16:19], v[236:239], v[88:91]
 v_mfma_f32_16x16x32_bf16 v[96:99], v[16:19], v[240:243], v[96:99]
 s_waitcnt lgkmcnt(0)
 v_mfma_f32_16x16x32_bf16 v[48:51], v[20:23], a[208:211], v[48:51]
 v_mfma_f32_16x16x32_bf16 v[56:59], v[20:23], a[212:215], v[56:59]
 v_mfma_f32_16x16x32_bf16 v[64:67], v[20:23], a[216:219], v[64:67]
 v_mfma_f32_16x16x32_bf16 v[72:75], v[20:23], a[220:223], v[72:75]
 v_mfma_f32_16x16x32_bf16 v[80:83], v[20:23], v[244:247], v[80:83]
 v_mfma_f32_16x16x32_bf16 v[88:91], v[20:23], v[248:251], v[88:91]
 v_mfma_f32_16x16x32_bf16 v[96:99], v[20:23], v[252:255], v[96:99]
 v_cvt_pk_bf16_f32 v48, v48, v49
 v_cvt_pk_bf16_f32 v49, v50, v51
 v_min_u32 v48, -2, v48
 buffer_store_dwordx2 v[48:49], v6, s[24:27], s42 offen offset:0 sc1
 v_cvt_pk_bf16_f32 v56, v56, v57
 v_cvt_pk_bf16_f32 v57, v58, v59
 v_min_u32 v56, -2, v56
 buffer_store_dwordx2 v[56:57], v6, s[24:27], s42 offen offset:1024 sc1
 v_cvt_pk_bf16_f32 v64, v64, v65
 v_cvt_pk_bf16_f32 v65, v66, v67
 v_min_u32 v64, -2, v64
 buffer_store_dwordx2 v[64:65], v6, s[24:27], s42 offen offset:2048 sc1
 v_cvt_pk_bf16_f32 v72, v72, v73
 v_cvt_pk_bf16_f32 v73, v74, v75
 v_min_u32 v72, -2, v72
 buffer_store_dwordx2 v[72:73], v6, s[24:27], s42 offen offset:3072 sc1
 v_cvt_pk_bf16_f32 v80, v80, v81
 v_cvt_pk_bf16_f32 v81, v82, v83
 v_min_u32 v80, -2, v80
 buffer_store_dwordx2 v[80:81], v7, s[24:27], s42 offen offset:0 sc1
 v_cvt_pk_bf16_f32 v88, v88, v89
 v_cvt_pk_bf16_f32 v89, v90, v91
 v_min_u32 v88, -2, v88
 buffer_store_dwordx2 v[88:89], v7, s[24:27], s42 offen offset:1024 sc1
 v_cvt_pk_bf16_f32 v96, v96, v97
 v_cvt_pk_bf16_f32 v97, v98, v99
 v_min_u32 v96, -2, v96
 buffer_store_dwordx2 v[96:97], v7, s[24:27], s42 offen offset:2048 sc1
 s_waitcnt vmcnt(0)
 s_barrier
 buffer_store_dword v10, v9, s[56:59], s60 offen sc1
 s_add_u32 s45, s45, 28672
 s_add_u32 s42, s42, 458752
 s_add_u32 s60, s60, 1024
 s_sub_u32 s38, s38, 1
 s_cmp_lg_u32 s38, 0
 s_cbranch_scc1 ka_gu_loop
 s_waitcnt vmcnt(0)
 s_branch ka_done
ka_xs_36:
 buffer_load_dword v12, v11, s[52:55], 0 offen sc1
 s_waitcnt vmcnt(0)
 v_cmp_eq_u32 vcc, s51, v13
 s_nop 1
 v_cndmask_b32 v14, 1, v12, vcc
 v_cmp_eq_u32 vcc, 0, v14
 s_cbranch_vccz ka_xb_37
 s_add_u32 s61, s61, 1
 s_cmp_lt_u32 s61, 400000
 s_cbranch_scc0 ka_end
 s_branch ka_xs_36
ka_ef_38:
 s_nop 7
 v_cvt_pk_bf16_f32 v104, v80, v81
 v_cvt_pk_bf16_f32 v105, v82, v83
 v_cvt_pk_bf16_f32 v106, v84, v85
 v_cvt_pk_bf16_f32 v107, v86, v87
 v_min_u32 v104, -2, v104
 buffer_store_dwordx4 v[104:107], v7, s[24:27], s43 offen offset:0 sc1
 v_cvt_pk_bf16_f32 v108, v88, v89
 v_cvt_pk_bf16_f32 v109, v90, v91
 v_cvt_pk_bf16_f32 v110, v92, v93
 v_cvt_pk_bf16_f32 v111, v94, v95
 v_min_u32 v108, -2, v108
 buffer_store_dwordx4 v[108:111], v7, s[24:27], s43 offen offset:1024 sc1
 v_cvt_pk_bf16_f32 v104, v96, v97
 v_cvt_pk_bf16_f32 v105, v98, v99
 v_cvt_pk_bf16_f32 v106, v100, v101
 v_cvt_pk_bf16_f32 v107, v102, v103
 v_min_u32 v104, -2, v104
 buffer_store_dwordx4 v[104:107], v7, s[24:27], s43 offen offset:2048 sc1
 s_waitcnt vmcnt(0)
 s_barrier
 buffer_store_dword v10, v9, s[56:59], s60 offen sc1
 v_mov_b32 v7, 1073741824
 s_mov_b32 s60, 0
 s_branch ka_gx_loop
ka_gt:
 s_cmp_eq_u32 s3, 0
 s_cbranch_scc0 ka_ps_44
 s_cmp_eq_u32 s6, 0
 s_cbranch_scc0 ka_pw_43
 v_and_b32 v20, 63, v0
 v_lshlrev_b32 v20, 4, v20
 v_add_u32 v20, 24150016, v20
 global_load_dwordx4 v[22:25], v20, s[4:5] sc1
 s_waitcnt vmcnt(0)
 s_mov_b32 s61, 0
ka_pd_45:
 v_min_u32 v22, v22, v23
 v_min3_u32 v22, v22, v24, v25
 v_cmp_eq_u32 vcc, 0, v22
 s_nop 1
 s_and_b64 vcc, vcc, exec
 s_cbranch_scc0 ka_pk_46
 s_add_u32 s61, s61, 1
 s_cmp_lt_u32 s61, 400000
 s_cbranch_scc0 ka_end
 s_sleep 1
 global_load_dwordx4 v[22:25], v20, s[4:5] sc1
 s_waitcnt vmcnt(0)
 s_branch ka_pd_45
ka_pk_46:
ka_pw_43:
 s_barrier
ka_ps_44:
 s_add_u32 s52, s76, 70762496
 s_addc_u32 s53, s77, 0
 s_mov_b32 s54, 64
 s_mov_b32 s55, 0x20000
 s_cmp_eq_u32 s3, 0
 s_cbranch_scc0 ka_xs_49
 s_cmp_eq_u32 s6, 0
 s_cbranch_scc0 ka_xo_48
 v_and_b32 v20, 15, v0
 v_lshlrev_b32 v20, 2, v20
 s_mov_b32 s61, 0
ka_xv_47:
 buffer_load_dword v21, v20, s[52:55], 0 offen sc1
 s_waitcnt vmcnt(0)
 v_cmp_eq_u32 vcc, 0, v21
 s_cbranch_vccz ka_xo_48
 s_add_u32 s61, s61, 1
 s_cmp_lt_u32 s61, 400000
 s_cbranch_scc0 ka_end
 s_sleep 8
 s_branch ka_xv_47
ka_xo_48:
 s_barrier
ka_xs_49:
 s_add_u32 s16, s4, 0
 s_addc_u32 s17, s5, 0
 s_mov_b32 s18, 6422528
 s_mov_b32 s19, 0x20000
 s_add_u32 s20, s76, 24182784
 s_addc_u32 s21, s77, 0
 s_mov_b32 s22, 1835008
 s_mov_b32 s23, 0x20000
 s_add_u32 s24, s76, 64442368
 s_addc_u32 s25, s77, 0
 s_mov_b32 s26, 2097152
 s_mov_b32 s27, 0x20000
 s_add_u32 s32, s76, 66539520
 s_addc_u32 s33, s77, 0
 s_mov_b32 s34, 524288
 s_mov_b32 s35, 0x20000
 s_add_u32 s28, s76, 55848960
 s_addc_u32 s29, s77, 0
 s_mov_b32 s30, 465920
 s_mov_b32 s31, 0x20000
 s_add_u32 s56, s76, 70762240
 s_addc_u32 s57, s77, 0
 s_mov_b32 s58, 28928
 s_mov_b32 s59, 0x20000
 v_and_b32 v1, 63, v0
 v_lshlrev_b32 v2, 4, v1
 s_mov_b32 s38, 16
 s_mov_b32 s61, 0
 s_mov_b32 s39, 8192
 s_mov_b32 s40, 36864
 s_mov_b32 s41, 65536
 s_mov_b32 s44, 4096
 v_add_u32 v3, 8192, v2
 v_add_u32 v4, 36864, v2
 s_mul_i32 s8, s37, 28672
 s_mul_i32 s9, s6, 7168
 s_add_u32 s8, s8, s9
 v_add_u32 v5, s8, v2
 s_add_u32 s52, s76, 70787072
 s_addc_u32 s53, s77, 0
 s_mov_b32 s54, 4096
 s_mov_b32 s55, 0x20000
 v_and_b32 v20, 63, v0
 v_lshrrev_b32 v21, 2, v20
 v_lshlrev_b32 v21, 8, v21
 v_and_b32 v20, 3, v20
 v_lshl_add_u32 v20, v20, 2, v21
 s_lshl_b32 s8, s37, 6
 s_mov_b32 s61, 0
ka_xf_50:
 buffer_load_dword v21, v20, s[52:55], s8 offen sc1
 s_waitcnt vmcnt(0)
 v_cmp_eq_u32 vcc, 0, v21
 s_cbranch_vccz ka_xk_51
 s_add_u32 s61, s61, 1
 s_cmp_lt_u32 s61, 400000
 s_cbranch_scc0 ka_end
 s_sleep 2
 s_branch ka_xf_50
ka_xk_51:
 s_mul_i32 s8, s6, 7168
 s_add_u32 s8, s8, s39
 s_mov_b32 m0, s8
 s_nop 0
 buffer_load_dwordx4 v5, s[20:23], 0 offen offset:0 sc1 lds
 buffer_load_dwordx4 v5, s[20:23], 0 offen offset:1024 sc1 lds
 buffer_load_dwordx4 v5, s[20:23], 0 offen offset:2048 sc1 lds
 buffer_load_dwordx4 v5, s[20:23], 0 offen offset:3072 sc1 lds
 s_add_u32 s8, s8, 4096
 s_mov_b32 m0, s8
 s_nop 0
 buffer_load_dwordx4 v5, s[20:23], s44 offen offset:0 sc1 lds
 buffer_load_dwordx4 v5, s[20:23], s44 offen offset:1024 sc1 lds
 buffer_load_dwordx4 v5, s[20:23], s44 offen offset:2048 sc1 lds
 v_add_u32 v5, 114688, v5
 s_mul_i32 s8, s36, 401408
 v_and_b32 v20, 15, v1
 v_lshrrev_b32 v21, 4, v1
 v_lshrrev_b32 v22, 3, v20
 v_mul_u32_u24 v22, 14336, v22
 v_bfe_u32 v23, v20, 2, 1
 v_lshlrev_b32 v23, 3, v23
 v_and_b32 v24, 3, v20
 v_add_u32 v23, v23, v24
 v_lshl_add_u32 v23, v21, 4, v23
 v_lshl_add_u32 v22, v23, 4, v22
 s_mul_i32 s9, s6, 7
 s_add_u32 s9, s9, 1
 s_lshr_b32 s9, s9, 1
 s_lshr_b32 s10, s6, 1
 s_mul_i32 s10, s10, 7
 s_add_u32 s10, s10, 3
 s_and_b32 s11, s6, 1
 s_add_u32 s12, s9, 0
 s_mul_i32 s12, s12, 28672
 v_add_u32 v48, s12, v22
 v_add_u32 v49, 64, v48
 s_add_u32 s12, s9, 1
 s_mul_i32 s12, s12, 28672
 v_add_u32 v50, s12, v22
 v_add_u32 v51, 64, v50
 s_add_u32 s12, s9, 2
 s_mul_i32 s12, s12, 28672
 v_add_u32 v52, s12, v22
 v_add_u32 v53, 64, v52
 s_mul_i32 s12, s10, 28672
 s_lshl_b32 s13, s11, 6
 s_add_u32 s12, s12, s13
 v_add_u32 v54, s12, v22
 s_add_u32 s14, s8, 0
 buffer_load_dwordx4 a[0:3], v48, s[16:19], s14 offen offset:0
 buffer_load_dwordx4 a[4:7], v49, s[16:19], s14 offen offset:0
 buffer_load_dwordx4 a[8:11], v50, s[16:19], s14 offen offset:0
 buffer_load_dwordx4 a[12:15], v51, s[16:19], s14 offen offset:0
 buffer_load_dwordx4 a[16:19], v48, s[16:19], s14 offen offset:1024
 buffer_load_dwordx4 a[20:23], v49, s[16:19], s14 offen offset:1024
 buffer_load_dwordx4 a[24:27], v50, s[16:19], s14 offen offset:1024
 buffer_load_dwordx4 a[28:31], v51, s[16:19], s14 offen offset:1024
 buffer_load_dwordx4 a[32:35], v48, s[16:19], s14 offen offset:2048
 buffer_load_dwordx4 a[36:39], v49, s[16:19], s14 offen offset:2048
 buffer_load_dwordx4 a[40:43], v50, s[16:19], s14 offen offset:2048
 buffer_load_dwordx4 a[44:47], v51, s[16:19], s14 offen offset:2048
 buffer_load_dwordx4 a[48:51], v48, s[16:19], s14 offen offset:3072
 buffer_load_dwordx4 a[52:55], v49, s[16:19], s14 offen offset:3072
 buffer_load_dwordx4 a[56:59], v50, s[16:19], s14 offen offset:3072
 buffer_load_dwordx4 a[60:63], v51, s[16:19], s14 offen offset:3072
 s_add_u32 s14, s8, 4096
 buffer_load_dwordx4 a[64:67], v48, s[16:19], s14 offen offset:0
 buffer_load_dwordx4 a[68:71], v49, s[16:19], s14 offen offset:0
 buffer_load_dwordx4 a[72:75], v50, s[16:19], s14 offen offset:0
 buffer_load_dwordx4 a[76:79], v51, s[16:19], s14 offen offset:0
 buffer_load_dwordx4 a[80:83], v48, s[16:19], s14 offen offset:1024
 buffer_load_dwordx4 a[84:87], v49, s[16:19], s14 offen offset:1024
 buffer_load_dwordx4 a[88:91], v50, s[16:19], s14 offen offset:1024
 buffer_load_dwordx4 a[92:95], v51, s[16:19], s14 offen offset:1024
 buffer_load_dwordx4 a[96:99], v48, s[16:19], s14 offen offset:2048
 buffer_load_dwordx4 a[100:103], v49, s[16:19], s14 offen offset:2048
 buffer_load_dwordx4 a[104:107], v50, s[16:19], s14 offen offset:2048
 buffer_load_dwordx4 a[108:111], v51, s[16:19], s14 offen offset:2048
 buffer_load_dwordx4 a[112:115], v48, s[16:19], s14 offen offset:3072
 buffer_load_dwordx4 a[116:119], v49, s[16:19], s14 offen offset:3072
 buffer_load_dwordx4 a[120:123], v50, s[16:19], s14 offen offset:3072
 buffer_load_dwordx4 a[124:127], v51, s[16:19], s14 offen offset:3072
 s_add_u32 s14, s8, 8192
 buffer_load_dwordx4 a[128:131], v48, s[16:19], s14 offen offset:0
 buffer_load_dwordx4 a[132:135], v49, s[16:19], s14 offen offset:0
 buffer_load_dwordx4 a[136:139], v50, s[16:19], s14 offen offset:0
 buffer_load_dwordx4 a[140:143], v51, s[16:19], s14 offen offset:0
 buffer_load_dwordx4 a[144:147], v48, s[16:19], s14 offen offset:1024
 buffer_load_dwordx4 a[148:151], v49, s[16:19], s14 offen offset:1024
 buffer_load_dwordx4 a[152:155], v50, s[16:19], s14 offen offset:1024
 buffer_load_dwordx4 a[156:159], v51, s[16:19], s14 offen offset:1024
 buffer_load_dwordx4 a[160:163], v48, s[16:19], s14 offen offset:2048
 buffer_load_dwordx4 a[164:167], v49, s[16:19], s14 offen offset:2048
 buffer_load_dwordx4 a[168:171], v50, s[16:19], s14 offen offset:2048
 buffer_load_dwordx4 a[172:175], v51, s[16:19], s14 offen offset:2048
 buffer_load_dwordx4 a[176:179], v48, s[16:19], s14 offen offset:3072
 buffer_load_dwordx4 a[180:183], v49, s[16:19], s14 offen offset:3072
 buffer_load_dwordx4 a[184:187], v50, s[16:19], s14 offen offset:3072
 buffer_load_dwordx4 a[188:191], v51, s[16:19], s14 offen offset:3072
 s_add_u32 s14, s8, 12288
 buffer_load_dwordx4 a[192:195], v48, s[16:19], s14 offen offset:0
 buffer_load_dwordx4 a[196:199], v49, s[16:19], s14 offen offset:0
 buffer_load_dwordx4 a[200:203], v50, s[16:19], s14 offen offset:0
 buffer_load_dwordx4 a[204:207], v51, s[16:19], s14 offen offset:0
 buffer_load_dwordx4 a[208:211], v48, s[16:19], s14 offen offset:1024
 buffer_load_dwordx4 a[212:215], v49, s[16:19], s14 offen offset:1024
 buffer_load_dwordx4 a[216:219], v50, s[16:19], s14 offen offset:1024
 buffer_load_dwordx4 a[220:223], v51, s[16:19], s14 offen offset:1024
 s_add_u32 s14, s8, 0
 buffer_load_dwordx4 a[224:227], v52, s[16:19], s14 offen offset:0
 buffer_load_dwordx4 a[228:231], v53, s[16:19], s14 offen offset:0
 buffer_load_dwordx4 a[232:235], v54, s[16:19], s14 offen offset:0
 buffer_load_dwordx4 a[236:239], v52, s[16:19], s14 offen offset:1024
 buffer_load_dwordx4 a[240:243], v53, s[16:19], s14 offen offset:1024
 buffer_load_dwordx4 a[244:247], v54, s[16:19], s14 offen offset:1024
 buffer_load_dwordx4 a[248:251], v52, s[16:19], s14 offen offset:2048
 buffer_load_dwordx4 a[252:255], v53, s[16:19], s14 offen offset:2048
 buffer_load_dwordx4 v[120:123], v54, s[16:19], s14 offen offset:2048
 buffer_load_dwordx4 v[124:127], v52, s[16:19], s14 offen offset:3072
 buffer_load_dwordx4 v[128:131], v53, s[16:19], s14 offen offset:3072
 buffer_load_dwordx4 v[132:135], v54, s[16:19], s14 offen offset:3072
 s_add_u32 s14, s8, 4096
 buffer_load_dwordx4 v[136:139], v52, s[16:19], s14 offen offset:0
 buffer_load_dwordx4 v[140:143], v53, s[16:19], s14 offen offset:0
 buffer_load_dwordx4 v[144:147], v54, s[16:19], s14 offen offset:0
 buffer_load_dwordx4 v[148:151], v52, s[16:19], s14 offen offset:1024
 buffer_load_dwordx4 v[152:155], v53, s[16:19], s14 offen offset:1024
 buffer_load_dwordx4 v[156:159], v54, s[16:19], s14 offen offset:1024
 buffer_load_dwordx4 v[160:163], v52, s[16:19], s14 offen offset:2048
 buffer_load_dwordx4 v[164:167], v53, s[16:19], s14 offen offset:2048
 buffer_load_dwordx4 v[168:171], v54, s[16:19], s14 offen offset:2048
 buffer_load_dwordx4 v[172:175], v52, s[16:19], s14 offen offset:3072
 buffer_load_dwordx4 v[176:179], v53, s[16:19], s14 offen offset:3072
 buffer_load_dwordx4 v[180:183], v54, s[16:19], s14 offen offset:3072
 s_add_u32 s14, s8, 8192
 buffer_load_dwordx4 v[184:187], v52, s[16:19], s14 offen offset:0
 buffer_load_dwordx4 v[188:191], v53, s[16:19], s14 offen offset:0
 buffer_load_dwordx4 v[192:195], v54, s[16:19], s14 offen offset:0
 buffer_load_dwordx4 v[196:199], v52, s[16:19], s14 offen offset:1024
 buffer_load_dwordx4 v[200:203], v53, s[16:19], s14 offen offset:1024
 buffer_load_dwordx4 v[204:207], v54, s[16:19], s14 offen offset:1024
 buffer_load_dwordx4 v[208:211], v52, s[16:19], s14 offen offset:2048
 buffer_load_dwordx4 v[212:215], v53, s[16:19], s14 offen offset:2048
 buffer_load_dwordx4 v[216:219], v54, s[16:19], s14 offen offset:2048
 buffer_load_dwordx4 v[220:223], v52, s[16:19], s14 offen offset:3072
 buffer_load_dwordx4 v[224:227], v53, s[16:19], s14 offen offset:3072
 buffer_load_dwordx4 v[228:231], v54, s[16:19], s14 offen offset:3072
 s_add_u32 s14, s8, 12288
 buffer_load_dwordx4 v[232:235], v52, s[16:19], s14 offen offset:0
 buffer_load_dwordx4 v[236:239], v53, s[16:19], s14 offen offset:0
 buffer_load_dwordx4 v[240:243], v54, s[16:19], s14 offen offset:0
 buffer_load_dwordx4 v[244:247], v52, s[16:19], s14 offen offset:1024
 buffer_load_dwordx4 v[248:251], v53, s[16:19], s14 offen offset:1024
 buffer_load_dwordx4 v[252:255], v54, s[16:19], s14 offen offset:1024
 s_cmp_lg_u32 s11, 0
 s_cselect_b64 s[48:49], -1, 0
 s_lshl_b32 s12, s9, 10
 s_lshl_b32 s13, s10, 10
 v_mov_b32 v8, s12
 v_mov_b32 v9, s13
 v_and_b32 v20, 15, v1
 v_lshrrev_b32 v21, 4, v1

 v_and_b32 v22, 7, v20
 v_lshlrev_b32 v22, 5, v22
 v_lshrrev_b32 v23, 1, v21
 v_lshl_add_u32 v22, v23, 8, v22
 v_and_b32 v23, 1, v21
 v_lshl_add_u32 v22, v23, 3, v22
 s_add_u32 s12, s9, 0
 s_lshl_b32 s12, s12, 9
 v_add_u32 v10, s12, v22
 s_add_u32 s12, s9, 1
 s_lshl_b32 s12, s12, 9
 v_add_u32 v11, s12, v22
 s_add_u32 s12, s9, 2
 s_lshl_b32 s12, s12, 9
 v_add_u32 v12, s12, v22
 s_mov_b32 s12, s10
 s_lshl_b32 s12, s12, 9
 v_add_u32 v13, s12, v22

 s_mul_i32 s12, s6, 6144
 s_add_u32 s12, s12, 94208
 v_add_u32 v14, s12, v2
 s_and_b32 s13, s6, 1
 s_mul_i32 s12, s13, 3072
 s_add_u32 s12, s12, 94208
 v_add_u32 v15, s12, v2

 v_lshrrev_b32 v22, 2, v20
 v_lshlrev_b32 v22, 3, v22
 v_and_b32 v23, 3, v20
 v_add_u32 v22, v22, v23
 s_lshl_b32 s12, s13, 2
 v_add_u32 v22, s12, v22
 v_lshlrev_b32 v23, 3, v21
 v_sub_u32 v22, v22, v23
 v_mov_b32 v23, 0xff800000
 v_cmp_gt_i32 vcc, 0, v22
 s_nop 1
 v_cndmask_b32 v112, 0, v23, vcc
 v_cmp_gt_i32 vcc, 1, v22
 s_nop 1
 v_cndmask_b32 v113, 0, v23, vcc
 v_cmp_gt_i32 vcc, 2, v22
 s_nop 1
 v_cndmask_b32 v114, 0, v23, vcc
 v_cmp_gt_i32 vcc, 3, v22
 s_nop 1
 v_cndmask_b32 v115, 0, v23, vcc
 v_cmp_gt_i32 vcc, 4, v22
 s_nop 1
 v_cndmask_b32 v116, 0, v23, vcc
 v_cmp_gt_i32 vcc, 5, v22
 s_nop 1
 v_cndmask_b32 v117, 0, v23, vcc
 v_cmp_gt_i32 vcc, 6, v22
 s_nop 1
 v_cndmask_b32 v118, 0, v23, vcc
 v_cmp_gt_i32 vcc, 7, v22
 s_nop 1
 v_cndmask_b32 v119, 0, v23, vcc

 s_lshl_b32 s12, s36, 1
 s_add_u32 s12, s12, s13
 s_lshl_b32 s14, s12, 2
 s_add_u32 s14, s14, 128
 v_mov_b32 v22, s14
 v_mov_b32 v23, 1073741824
 v_cmp_eq_u32 vcc, 0, v1
 s_nop 1
 v_cndmask_b32 v6, v23, v22, vcc
 s_lshl_b32 s12, s12, 10
 v_add_u32 v108, s12, v2

 s_lshr_b32 s12, s36, 2
 s_lshl_b32 s12, s12, 1
 s_add_u32 s12, s12, s13
 s_lshl_b32 s12, s12, 10
 s_and_b32 s14, s36, 3
 s_lshl_b32 s14, s14, 8
 s_add_u32 s12, s12, s14
 v_lshlrev_b32 v22, 4, v20
 v_lshl_add_u32 v22, v21, 3, v22
 v_add_u32 v22, s12, v22
 v_cmp_gt_u32 vcc, 2, v21
 s_nop 1
 v_cndmask_b32 v109, v23, v22, vcc
 s_lshl_b32 s46, s37, 15
 s_lshl_b32 s47, s37, 13
 s_mul_i32 s45, s37, 7168
 s_add_u32 s60, s37, 1
 s_lshl_b32 s60, s60, 8

 s_lshl_b32 s12, s6, 10
 v_add_u32 v110, s12, v2
 s_add_u32 s13, s12, 4096
 s_cmp_eq_u32 s6, 3
 s_cselect_b32 s12, s12, s13
 v_add_u32 v111, s12, v2
 s_mul_i32 s8, s6, 7168
 s_add_u32 s8, s8, s40
 s_mov_b32 m0, s8
 s_nop 0
 buffer_load_dwordx4 v5, s[20:23], 0 offen offset:0 sc1 lds
 buffer_load_dwordx4 v5, s[20:23], 0 offen offset:1024 sc1 lds
 buffer_load_dwordx4 v5, s[20:23], 0 offen offset:2048 sc1 lds
 buffer_load_dwordx4 v5, s[20:23], 0 offen offset:3072 sc1 lds
 s_add_u32 s8, s8, 4096
 s_mov_b32 m0, s8
 s_nop 0
 buffer_load_dwordx4 v5, s[20:23], s44 offen offset:0 sc1 lds
 buffer_load_dwordx4 v5, s[20:23], s44 offen offset:1024 sc1 lds
 buffer_load_dwordx4 v5, s[20:23], s44 offen offset:2048 sc1 lds
 v_add_u32 v5, 114688, v5
 s_waitcnt vmcnt(49)
 s_barrier
ka_gt_loop:
 s_cmp_lg_u32 s38, 2
 s_cbranch_scc1 ka_gq_52
 v_and_b32 v104, 63, v0
 v_lshlrev_b32 v104, 2, v104
 s_mov_b32 s8, 20736
ka_ff_53:
 buffer_load_dword v105, v104, s[56:59], s8 offen sc1
 s_waitcnt vmcnt(0)
 v_cmp_eq_u32 vcc, 0, v105
 s_cbranch_vccz ka_fk_54
 s_add_u32 s61, s61, 1
 s_cmp_lt_u32 s61, 400000
 s_cbranch_scc1 ka_ff_53
 s_branch ka_end
ka_fk_54:
ka_gq_52:
 ds_read_b128 v[16:19], v3 offset:0
 ds_read_b128 v[20:23], v3 offset:14336
 ds_read_b128 v[24:27], v3 offset:1024
 ds_read_b128 v[28:31], v3 offset:15360
 s_waitcnt lgkmcnt(2)
 v_mfma_f32_16x16x32_bf16 v[48:51], a[0:3], v[16:19], 0
 ds_read_b128 v[32:35], v3 offset:2048
 ds_read_b128 v[36:39], v3 offset:16384
 v_mfma_f32_16x16x32_bf16 v[52:55], a[0:3], v[20:23], 0
 v_mfma_f32_16x16x32_bf16 v[56:59], a[4:7], v[16:19], 0
 v_mfma_f32_16x16x32_bf16 v[60:63], a[4:7], v[20:23], 0
 v_mfma_f32_16x16x32_bf16 v[64:67], a[8:11], v[16:19], 0
 v_mfma_f32_16x16x32_bf16 v[68:71], a[8:11], v[20:23], 0
 v_mfma_f32_16x16x32_bf16 v[72:75], a[12:15], v[16:19], 0
 v_mfma_f32_16x16x32_bf16 v[76:79], a[12:15], v[20:23], 0
 s_waitcnt lgkmcnt(2)
 v_mfma_f32_16x16x32_bf16 v[48:51], a[16:19], v[24:27], v[48:51]
 ds_read_b128 v[40:43], v3 offset:3072
 ds_read_b128 v[44:47], v3 offset:17408
 v_mfma_f32_16x16x32_bf16 v[52:55], a[16:19], v[28:31], v[52:55]
 v_mfma_f32_16x16x32_bf16 v[56:59], a[20:23], v[24:27], v[56:59]
 v_mfma_f32_16x16x32_bf16 v[60:63], a[20:23], v[28:31], v[60:63]
 v_mfma_f32_16x16x32_bf16 v[64:67], a[24:27], v[24:27], v[64:67]
 v_mfma_f32_16x16x32_bf16 v[68:71], a[24:27], v[28:31], v[68:71]
 v_mfma_f32_16x16x32_bf16 v[72:75], a[28:31], v[24:27], v[72:75]
 v_mfma_f32_16x16x32_bf16 v[76:79], a[28:31], v[28:31], v[76:79]
 s_waitcnt lgkmcnt(2)
 v_mfma_f32_16x16x32_bf16 v[48:51], a[32:35], v[32:35], v[48:51]
 ds_read_b128 v[16:19], v3 offset:4096
 ds_read_b128 v[20:23], v3 offset:18432
 v_mfma_f32_16x16x32_bf16 v[52:55], a[32:35], v[36:39], v[52:55]
 v_mfma_f32_16x16x32_bf16 v[56:59], a[36:39], v[32:35], v[56:59]
 v_mfma_f32_16x16x32_bf16 v[60:63], a[36:39], v[36:39], v[60:63]
 v_mfma_f32_16x16x32_bf16 v[64:67], a[40:43], v[32:35], v[64:67]
 v_mfma_f32_16x16x32_bf16 v[68:71], a[40:43], v[36:39], v[68:71]
 v_mfma_f32_16x16x32_bf16 v[72:75], a[44:47], v[32:35], v[72:75]
 v_mfma_f32_16x16x32_bf16 v[76:79], a[44:47], v[36:39], v[76:79]
 s_waitcnt lgkmcnt(2)
 v_mfma_f32_16x16x32_bf16 v[48:51], a[48:51], v[40:43], v[48:51]
 ds_read_b128 v[24:27], v3 offset:5120
 ds_read_b128 v[28:31], v3 offset:19456
 v_mfma_f32_16x16x32_bf16 v[52:55], a[48:51], v[44:47], v[52:55]
 v_mfma_f32_16x16x32_bf16 v[56:59], a[52:55], v[40:43], v[56:59]
 v_mfma_f32_16x16x32_bf16 v[60:63], a[52:55], v[44:47], v[60:63]
 v_mfma_f32_16x16x32_bf16 v[64:67], a[56:59], v[40:43], v[64:67]
 v_mfma_f32_16x16x32_bf16 v[68:71], a[56:59], v[44:47], v[68:71]
 v_mfma_f32_16x16x32_bf16 v[72:75], a[60:63], v[40:43], v[72:75]
 v_mfma_f32_16x16x32_bf16 v[76:79], a[60:63], v[44:47], v[76:79]
 s_waitcnt lgkmcnt(2)
 v_mfma_f32_16x16x32_bf16 v[48:51], a[64:67], v[16:19], v[48:51]
 ds_read_b128 v[32:35], v3 offset:6144
 ds_read_b128 v[36:39], v3 offset:20480
 v_mfma_f32_16x16x32_bf16 v[52:55], a[64:67], v[20:23], v[52:55]
 v_mfma_f32_16x16x32_bf16 v[56:59], a[68:71], v[16:19], v[56:59]
 v_mfma_f32_16x16x32_bf16 v[60:63], a[68:71], v[20:23], v[60:63]
 v_mfma_f32_16x16x32_bf16 v[64:67], a[72:75], v[16:19], v[64:67]
 v_mfma_f32_16x16x32_bf16 v[68:71], a[72:75], v[20:23], v[68:71]
 v_mfma_f32_16x16x32_bf16 v[72:75], a[76:79], v[16:19], v[72:75]
 v_mfma_f32_16x16x32_bf16 v[76:79], a[76:79], v[20:23], v[76:79]
 s_waitcnt lgkmcnt(2)
 v_mfma_f32_16x16x32_bf16 v[48:51], a[80:83], v[24:27], v[48:51]
 ds_read_b128 v[40:43], v3 offset:7168
 ds_read_b128 v[44:47], v3 offset:21504
 v_mfma_f32_16x16x32_bf16 v[52:55], a[80:83], v[28:31], v[52:55]
 v_mfma_f32_16x16x32_bf16 v[56:59], a[84:87], v[24:27], v[56:59]
 v_mfma_f32_16x16x32_bf16 v[60:63], a[84:87], v[28:31], v[60:63]
 v_mfma_f32_16x16x32_bf16 v[64:67], a[88:91], v[24:27], v[64:67]
 v_mfma_f32_16x16x32_bf16 v[68:71], a[88:91], v[28:31], v[68:71]
 v_mfma_f32_16x16x32_bf16 v[72:75], a[92:95], v[24:27], v[72:75]
 v_mfma_f32_16x16x32_bf16 v[76:79], a[92:95], v[28:31], v[76:79]
 s_waitcnt lgkmcnt(2)
 v_mfma_f32_16x16x32_bf16 v[48:51], a[96:99], v[32:35], v[48:51]
 ds_read_b128 v[16:19], v3 offset:8192
 ds_read_b128 v[20:23], v3 offset:22528
 v_mfma_f32_16x16x32_bf16 v[52:55], a[96:99], v[36:39], v[52:55]
 v_mfma_f32_16x16x32_bf16 v[56:59], a[100:103], v[32:35], v[56:59]
 v_mfma_f32_16x16x32_bf16 v[60:63], a[100:103], v[36:39], v[60:63]
 v_mfma_f32_16x16x32_bf16 v[64:67], a[104:107], v[32:35], v[64:67]
 v_mfma_f32_16x16x32_bf16 v[68:71], a[104:107], v[36:39], v[68:71]
 v_mfma_f32_16x16x32_bf16 v[72:75], a[108:111], v[32:35], v[72:75]
 v_mfma_f32_16x16x32_bf16 v[76:79], a[108:111], v[36:39], v[76:79]
 s_waitcnt lgkmcnt(2)
 v_mfma_f32_16x16x32_bf16 v[48:51], a[112:115], v[40:43], v[48:51]
 ds_read_b128 v[24:27], v3 offset:9216
 ds_read_b128 v[28:31], v3 offset:23552
 v_mfma_f32_16x16x32_bf16 v[52:55], a[112:115], v[44:47], v[52:55]
 v_mfma_f32_16x16x32_bf16 v[56:59], a[116:119], v[40:43], v[56:59]
 v_mfma_f32_16x16x32_bf16 v[60:63], a[116:119], v[44:47], v[60:63]
 v_mfma_f32_16x16x32_bf16 v[64:67], a[120:123], v[40:43], v[64:67]
 v_mfma_f32_16x16x32_bf16 v[68:71], a[120:123], v[44:47], v[68:71]
 v_mfma_f32_16x16x32_bf16 v[72:75], a[124:127], v[40:43], v[72:75]
 v_mfma_f32_16x16x32_bf16 v[76:79], a[124:127], v[44:47], v[76:79]
 s_waitcnt lgkmcnt(2)
 v_mfma_f32_16x16x32_bf16 v[48:51], a[128:131], v[16:19], v[48:51]
 ds_read_b128 v[32:35], v3 offset:10240
 ds_read_b128 v[36:39], v3 offset:24576
 v_mfma_f32_16x16x32_bf16 v[52:55], a[128:131], v[20:23], v[52:55]
 v_mfma_f32_16x16x32_bf16 v[56:59], a[132:135], v[16:19], v[56:59]
 v_mfma_f32_16x16x32_bf16 v[60:63], a[132:135], v[20:23], v[60:63]
 v_mfma_f32_16x16x32_bf16 v[64:67], a[136:139], v[16:19], v[64:67]
 v_mfma_f32_16x16x32_bf16 v[68:71], a[136:139], v[20:23], v[68:71]
 v_mfma_f32_16x16x32_bf16 v[72:75], a[140:143], v[16:19], v[72:75]
 v_mfma_f32_16x16x32_bf16 v[76:79], a[140:143], v[20:23], v[76:79]
 s_waitcnt lgkmcnt(2)
 v_mfma_f32_16x16x32_bf16 v[48:51], a[144:147], v[24:27], v[48:51]
 ds_read_b128 v[40:43], v3 offset:11264
 ds_read_b128 v[44:47], v3 offset:25600
 v_mfma_f32_16x16x32_bf16 v[52:55], a[144:147], v[28:31], v[52:55]
 v_mfma_f32_16x16x32_bf16 v[56:59], a[148:151], v[24:27], v[56:59]
 v_mfma_f32_16x16x32_bf16 v[60:63], a[148:151], v[28:31], v[60:63]
 v_mfma_f32_16x16x32_bf16 v[64:67], a[152:155], v[24:27], v[64:67]
 v_mfma_f32_16x16x32_bf16 v[68:71], a[152:155], v[28:31], v[68:71]
 v_mfma_f32_16x16x32_bf16 v[72:75], a[156:159], v[24:27], v[72:75]
 v_mfma_f32_16x16x32_bf16 v[76:79], a[156:159], v[28:31], v[76:79]
 s_waitcnt lgkmcnt(2)
 v_mfma_f32_16x16x32_bf16 v[48:51], a[160:163], v[32:35], v[48:51]
 ds_read_b128 v[16:19], v3 offset:12288
 ds_read_b128 v[20:23], v3 offset:26624
 v_mfma_f32_16x16x32_bf16 v[52:55], a[160:163], v[36:39], v[52:55]
 v_mfma_f32_16x16x32_bf16 v[56:59], a[164:167], v[32:35], v[56:59]
 v_mfma_f32_16x16x32_bf16 v[60:63], a[164:167], v[36:39], v[60:63]
 v_mfma_f32_16x16x32_bf16 v[64:67], a[168:171], v[32:35], v[64:67]
 v_mfma_f32_16x16x32_bf16 v[68:71], a[168:171], v[36:39], v[68:71]
 v_mfma_f32_16x16x32_bf16 v[72:75], a[172:175], v[32:35], v[72:75]
 v_mfma_f32_16x16x32_bf16 v[76:79], a[172:175], v[36:39], v[76:79]
 s_waitcnt lgkmcnt(2)
 v_mfma_f32_16x16x32_bf16 v[48:51], a[176:179], v[40:43], v[48:51]
 ds_read_b128 v[24:27], v3 offset:13312
 ds_read_b128 v[28:31], v3 offset:27648
 v_mfma_f32_16x16x32_bf16 v[52:55], a[176:179], v[44:47], v[52:55]
 v_mfma_f32_16x16x32_bf16 v[56:59], a[180:183], v[40:43], v[56:59]
 v_mfma_f32_16x16x32_bf16 v[60:63], a[180:183], v[44:47], v[60:63]
 v_mfma_f32_16x16x32_bf16 v[64:67], a[184:187], v[40:43], v[64:67]
 v_mfma_f32_16x16x32_bf16 v[68:71], a[184:187], v[44:47], v[68:71]
 v_mfma_f32_16x16x32_bf16 v[72:75], a[188:191], v[40:43], v[72:75]
 v_mfma_f32_16x16x32_bf16 v[76:79], a[188:191], v[44:47], v[76:79]
 s_waitcnt lgkmcnt(2)
 v_mfma_f32_16x16x32_bf16 v[48:51], a[192:195], v[16:19], v[48:51]
 ds_read_b128 v[32:35], v3 offset:0
 ds_read_b128 v[36:39], v3 offset:14336
 v_mfma_f32_16x16x32_bf16 v[52:55], a[192:195], v[20:23], v[52:55]
 v_mfma_f32_16x16x32_bf16 v[56:59], a[196:199], v[16:19], v[56:59]
 v_mfma_f32_16x16x32_bf16 v[60:63], a[196:199], v[20:23], v[60:63]
 v_mfma_f32_16x16x32_bf16 v[64:67], a[200:203], v[16:19], v[64:67]
 v_mfma_f32_16x16x32_bf16 v[68:71], a[200:203], v[20:23], v[68:71]
 v_mfma_f32_16x16x32_bf16 v[72:75], a[204:207], v[16:19], v[72:75]
 v_mfma_f32_16x16x32_bf16 v[76:79], a[204:207], v[20:23], v[76:79]
 s_waitcnt lgkmcnt(2)
 v_mfma_f32_16x16x32_bf16 v[48:51], a[208:211], v[24:27], v[48:51]
 ds_read_b128 v[40:43], v3 offset:1024
 ds_read_b128 v[44:47], v3 offset:15360
 v_mfma_f32_16x16x32_bf16 v[52:55], a[208:211], v[28:31], v[52:55]
 v_mfma_f32_16x16x32_bf16 v[56:59], a[212:215], v[24:27], v[56:59]
 v_mfma_f32_16x16x32_bf16 v[60:63], a[212:215], v[28:31], v[60:63]
 v_mfma_f32_16x16x32_bf16 v[64:67], a[216:219], v[24:27], v[64:67]
 v_mfma_f32_16x16x32_bf16 v[68:71], a[216:219], v[28:31], v[68:71]
 v_mfma_f32_16x16x32_bf16 v[72:75], a[220:223], v[24:27], v[72:75]
 v_mfma_f32_16x16x32_bf16 v[76:79], a[220:223], v[28:31], v[76:79]
 s_waitcnt lgkmcnt(2)
 s_waitcnt vmcnt(7)
 v_mfma_f32_16x16x32_bf16 v[80:83], a[224:227], v[32:35], 0
 ds_read_b128 v[16:19], v3 offset:2048
 ds_read_b128 v[20:23], v3 offset:16384
 v_mfma_f32_16x16x32_bf16 v[84:87], a[224:227], v[36:39], 0
 v_mfma_f32_16x16x32_bf16 v[88:91], a[228:231], v[32:35], 0
 v_mfma_f32_16x16x32_bf16 v[92:95], a[228:231], v[36:39], 0
 v_mfma_f32_16x16x32_bf16 v[96:99], a[232:235], v[32:35], 0
 v_mfma_f32_16x16x32_bf16 v[100:103], a[232:235], v[36:39], 0
 s_waitcnt lgkmcnt(2)
 v_mfma_f32_16x16x32_bf16 v[80:83], a[236:239], v[40:43], v[80:83]
 ds_read_b128 v[24:27], v3 offset:3072
 ds_read_b128 v[28:31], v3 offset:17408
 v_cvt_pk_bf16_f32 v48, v48, v49
 v_mfma_f32_16x16x32_bf16 v[84:87], a[236:239], v[44:47], v[84:87]
 v_cvt_pk_bf16_f32 v49, v50, v51
 v_mfma_f32_16x16x32_bf16 v[88:91], a[240:243], v[40:43], v[88:91]
 v_cvt_pk_bf16_f32 v50, v56, v57
 v_mfma_f32_16x16x32_bf16 v[92:95], a[240:243], v[44:47], v[92:95]
 v_cvt_pk_bf16_f32 v51, v58, v59
 v_mfma_f32_16x16x32_bf16 v[96:99], a[244:247], v[40:43], v[96:99]
 v_cvt_pk_bf16_f32 v52, v52, v53
 v_mfma_f32_16x16x32_bf16 v[100:103], a[244:247], v[44:47], v[100:103]
 s_waitcnt lgkmcnt(2)
 v_cvt_pk_bf16_f32 v53, v54, v55
 v_mfma_f32_16x16x32_bf16 v[80:83], a[248:251], v[16:19], v[80:83]
 ds_read_b128 v[32:35], v3 offset:4096
 ds_read_b128 v[36:39], v3 offset:18432
 v_cvt_pk_bf16_f32 v54, v60, v61
 v_mfma_f32_16x16x32_bf16 v[84:87], a[248:251], v[20:23], v[84:87]
 v_cvt_pk_bf16_f32 v55, v62, v63
 v_mfma_f32_16x16x32_bf16 v[88:91], a[252:255], v[16:19], v[88:91]
 v_cvt_pk_bf16_f32 v64, v64, v65
 v_mfma_f32_16x16x32_bf16 v[92:95], a[252:255], v[20:23], v[92:95]
 v_cvt_pk_bf16_f32 v65, v66, v67
 v_mfma_f32_16x16x32_bf16 v[96:99], v[120:123], v[16:19], v[96:99]
 v_cvt_pk_bf16_f32 v66, v72, v73
 v_mfma_f32_16x16x32_bf16 v[100:103], v[120:123], v[20:23], v[100:103]
 s_waitcnt lgkmcnt(2)
 v_cvt_pk_bf16_f32 v67, v74, v75
 v_mfma_f32_16x16x32_bf16 v[80:83], v[124:127], v[24:27], v[80:83]
 ds_read_b128 v[40:43], v3 offset:5120
 ds_read_b128 v[44:47], v3 offset:19456
 v_cvt_pk_bf16_f32 v68, v68, v69
 v_mfma_f32_16x16x32_bf16 v[84:87], v[124:127], v[28:31], v[84:87]
 v_cvt_pk_bf16_f32 v69, v70, v71
 v_mfma_f32_16x16x32_bf16 v[88:91], v[128:131], v[24:27], v[88:91]
 v_cvt_pk_bf16_f32 v70, v76, v77
 v_mfma_f32_16x16x32_bf16 v[92:95], v[128:131], v[28:31], v[92:95]
 v_cvt_pk_bf16_f32 v71, v78, v79
 v_mfma_f32_16x16x32_bf16 v[96:99], v[132:135], v[24:27], v[96:99]
 v_mfma_f32_16x16x32_bf16 v[100:103], v[132:135], v[28:31], v[100:103]
 s_waitcnt lgkmcnt(2)
 v_mfma_f32_16x16x32_bf16 v[80:83], v[136:139], v[32:35], v[80:83]
 ds_read_b128 v[16:19], v3 offset:6144
 ds_read_b128 v[20:23], v3 offset:20480
 v_mfma_f32_16x16x32_bf16 v[84:87], v[136:139], v[36:39], v[84:87]
 v_mfma_f32_16x16x32_bf16 v[88:91], v[140:143], v[32:35], v[88:91]
 v_mfma_f32_16x16x32_bf16 v[92:95], v[140:143], v[36:39], v[92:95]
 v_mfma_f32_16x16x32_bf16 v[96:99], v[144:147], v[32:35], v[96:99]
 v_mfma_f32_16x16x32_bf16 v[100:103], v[144:147], v[36:39], v[100:103]
 s_waitcnt lgkmcnt(2)
 v_mfma_f32_16x16x32_bf16 v[80:83], v[148:151], v[40:43], v[80:83]
 ds_read_b128 v[24:27], v3 offset:7168
 ds_read_b128 v[28:31], v3 offset:21504
 v_mfma_f32_16x16x32_bf16 v[84:87], v[148:151], v[44:47], v[84:87]
 v_mfma_f32_16x16x32_bf16 v[88:91], v[152:155], v[40:43], v[88:91]
 v_mfma_f32_16x16x32_bf16 v[92:95], v[152:155], v[44:47], v[92:95]
 v_mfma_f32_16x16x32_bf16 v[96:99], v[156:159], v[40:43], v[96:99]
 v_mfma_f32_16x16x32_bf16 v[100:103], v[156:159], v[44:47], v[100:103]
 s_waitcnt lgkmcnt(2)
 v_mfma_f32_16x16x32_bf16 v[80:83], v[160:163], v[16:19], v[80:83]
 ds_read_b128 v[32:35], v3 offset:8192
 ds_read_b128 v[36:39], v3 offset:22528
 v_mfma_f32_16x16x32_bf16 v[84:87], v[160:163], v[20:23], v[84:87]
 v_mfma_f32_16x16x32_bf16 v[88:91], v[164:167], v[16:19], v[88:91]
 v_mfma_f32_16x16x32_bf16 v[92:95], v[164:167], v[20:23], v[92:95]
 v_mfma_f32_16x16x32_bf16 v[96:99], v[168:171], v[16:19], v[96:99]
 v_mfma_f32_16x16x32_bf16 v[100:103], v[168:171], v[20:23], v[100:103]
 s_waitcnt lgkmcnt(2)
 v_mfma_f32_16x16x32_bf16 v[80:83], v[172:175], v[24:27], v[80:83]
 ds_read_b128 v[40:43], v3 offset:9216
 ds_read_b128 v[44:47], v3 offset:23552
 v_mfma_f32_16x16x32_bf16 v[84:87], v[172:175], v[28:31], v[84:87]
 v_mfma_f32_16x16x32_bf16 v[88:91], v[176:179], v[24:27], v[88:91]
 v_mfma_f32_16x16x32_bf16 v[92:95], v[176:179], v[28:31], v[92:95]
 v_mfma_f32_16x16x32_bf16 v[96:99], v[180:183], v[24:27], v[96:99]
 v_mfma_f32_16x16x32_bf16 v[100:103], v[180:183], v[28:31], v[100:103]
 s_waitcnt lgkmcnt(2)
 v_mfma_f32_16x16x32_bf16 v[80:83], v[184:187], v[32:35], v[80:83]
 ds_read_b128 v[16:19], v3 offset:10240
 ds_read_b128 v[20:23], v3 offset:24576
 v_mfma_f32_16x16x32_bf16 v[84:87], v[184:187], v[36:39], v[84:87]
 v_mfma_f32_16x16x32_bf16 v[88:91], v[188:191], v[32:35], v[88:91]
 v_mfma_f32_16x16x32_bf16 v[92:95], v[188:191], v[36:39], v[92:95]
 v_mfma_f32_16x16x32_bf16 v[96:99], v[192:195], v[32:35], v[96:99]
 v_mfma_f32_16x16x32_bf16 v[100:103], v[192:195], v[36:39], v[100:103]
 s_waitcnt lgkmcnt(2)
 v_mfma_f32_16x16x32_bf16 v[80:83], v[196:199], v[40:43], v[80:83]
 ds_read_b128 v[24:27], v3 offset:11264
 ds_read_b128 v[28:31], v3 offset:25600
 v_mfma_f32_16x16x32_bf16 v[84:87], v[196:199], v[44:47], v[84:87]
 v_mfma_f32_16x16x32_bf16 v[88:91], v[200:203], v[40:43], v[88:91]
 v_mfma_f32_16x16x32_bf16 v[92:95], v[200:203], v[44:47], v[92:95]
 v_mfma_f32_16x16x32_bf16 v[96:99], v[204:207], v[40:43], v[96:99]
 v_mfma_f32_16x16x32_bf16 v[100:103], v[204:207], v[44:47], v[100:103]
 s_waitcnt lgkmcnt(2)
 v_mfma_f32_16x16x32_bf16 v[80:83], v[208:211], v[16:19], v[80:83]
 ds_read_b128 v[32:35], v3 offset:12288
 ds_read_b128 v[36:39], v3 offset:26624
 v_mfma_f32_16x16x32_bf16 v[84:87], v[208:211], v[20:23], v[84:87]
 v_mfma_f32_16x16x32_bf16 v[88:91], v[212:215], v[16:19], v[88:91]
 v_mfma_f32_16x16x32_bf16 v[92:95], v[212:215], v[20:23], v[92:95]
 v_mfma_f32_16x16x32_bf16 v[96:99], v[216:219], v[16:19], v[96:99]
 v_mfma_f32_16x16x32_bf16 v[100:103], v[216:219], v[20:23], v[100:103]
 s_waitcnt lgkmcnt(2)
 v_mfma_f32_16x16x32_bf16 v[80:83], v[220:223], v[24:27], v[80:83]
 ds_read_b128 v[40:43], v3 offset:13312
 ds_read_b128 v[44:47], v3 offset:27648
 v_mfma_f32_16x16x32_bf16 v[84:87], v[220:223], v[28:31], v[84:87]
 v_mfma_f32_16x16x32_bf16 v[88:91], v[224:227], v[24:27], v[88:91]
 v_mfma_f32_16x16x32_bf16 v[92:95], v[224:227], v[28:31], v[92:95]
 v_mfma_f32_16x16x32_bf16 v[96:99], v[228:231], v[24:27], v[96:99]
 v_mfma_f32_16x16x32_bf16 v[100:103], v[228:231], v[28:31], v[100:103]
 s_waitcnt lgkmcnt(2)
 v_mfma_f32_16x16x32_bf16 v[80:83], v[232:235], v[32:35], v[80:83]
 v_mfma_f32_16x16x32_bf16 v[84:87], v[232:235], v[36:39], v[84:87]
 v_mfma_f32_16x16x32_bf16 v[88:91], v[236:239], v[32:35], v[88:91]
 v_mfma_f32_16x16x32_bf16 v[92:95], v[236:239], v[36:39], v[92:95]
 v_mfma_f32_16x16x32_bf16 v[96:99], v[240:243], v[32:35], v[96:99]
 v_mfma_f32_16x16x32_bf16 v[100:103], v[240:243], v[36:39], v[100:103]
 s_waitcnt lgkmcnt(0)
 v_mfma_f32_16x16x32_bf16 v[80:83], v[244:247], v[40:43], v[80:83]
 v_mfma_f32_16x16x32_bf16 v[84:87], v[244:247], v[44:47], v[84:87]
 v_mfma_f32_16x16x32_bf16 v[88:91], v[248:251], v[40:43], v[88:91]
 v_mfma_f32_16x16x32_bf16 v[92:95], v[248:251], v[44:47], v[92:95]
 v_mfma_f32_16x16x32_bf16 v[96:99], v[252:255], v[40:43], v[96:99]
 v_mfma_f32_16x16x32_bf16 v[100:103], v[252:255], v[44:47], v[100:103]
 v_add_u32 v104, v3, v8
 v_add_u32 v105, v3, v9
 ds_read_b128 v[16:19], v104 offset:0
 ds_read_b128 v[20:23], v104 offset:14336
 ds_read_b128 v[24:27], v104 offset:1024
 ds_read_b128 v[28:31], v104 offset:15360
 ds_read_b128 v[32:35], v104 offset:2048
 ds_read_b128 v[36:39], v104 offset:16384
 ds_read_b128 v[40:43], v105 offset:0
 ds_read_b128 v[44:47], v105 offset:14336
 v_cvt_pk_bf16_f32 v80, v80, v81
 v_cvt_pk_bf16_f32 v81, v82, v83
 v_cvt_pk_bf16_f32 v82, v88, v89
 v_cvt_pk_bf16_f32 v83, v90, v91
 v_cvt_pk_bf16_f32 v84, v84, v85
 v_cvt_pk_bf16_f32 v85, v86, v87
 v_cvt_pk_bf16_f32 v86, v92, v93
 v_cvt_pk_bf16_f32 v87, v94, v95
 v_cvt_pk_bf16_f32 v106, v96, v97
 v_cvt_pk_bf16_f32 v107, v98, v99
 v_cndmask_b32 v96, v106, 0, s[48:49]
 v_cndmask_b32 v97, v107, 0, s[48:49]
 v_cndmask_b32 v98, 0, v106, s[48:49]
 v_cndmask_b32 v99, 0, v107, s[48:49]
 v_cvt_pk_bf16_f32 v106, v100, v101
 v_cvt_pk_bf16_f32 v107, v102, v103
 v_cndmask_b32 v100, v106, 0, s[48:49]
 v_cndmask_b32 v101, v107, 0, s[48:49]
 v_cndmask_b32 v102, 0, v106, s[48:49]
 v_cndmask_b32 v103, 0, v107, s[48:49]
 s_waitcnt lgkmcnt(6)
 v_mfma_f32_16x16x32_bf16 v[56:59], v[16:19], v[48:51], 0
 v_mfma_f32_16x16x32_bf16 v[60:63], v[16:19], v[52:55], 0
 v_mfma_f32_16x16x32_bf16 v[72:75], v[20:23], v[48:51], 0
 v_mfma_f32_16x16x32_bf16 v[76:79], v[20:23], v[52:55], 0
 s_waitcnt lgkmcnt(4)
 v_mfma_f32_16x16x32_bf16 v[56:59], v[24:27], v[64:67], v[56:59]
 v_mfma_f32_16x16x32_bf16 v[60:63], v[24:27], v[68:71], v[60:63]
 v_mfma_f32_16x16x32_bf16 v[72:75], v[28:31], v[64:67], v[72:75]
 v_mfma_f32_16x16x32_bf16 v[76:79], v[28:31], v[68:71], v[76:79]
 s_waitcnt lgkmcnt(2)
 v_mfma_f32_16x16x32_bf16 v[56:59], v[32:35], v[80:83], v[56:59]
 v_mfma_f32_16x16x32_bf16 v[60:63], v[32:35], v[84:87], v[60:63]
 v_mfma_f32_16x16x32_bf16 v[72:75], v[36:39], v[80:83], v[72:75]
 v_mfma_f32_16x16x32_bf16 v[76:79], v[36:39], v[84:87], v[76:79]
 s_waitcnt lgkmcnt(0)
 v_mfma_f32_16x16x32_bf16 v[56:59], v[40:43], v[96:99], v[56:59]
 v_mfma_f32_16x16x32_bf16 v[60:63], v[40:43], v[100:103], v[60:63]
 v_mfma_f32_16x16x32_bf16 v[72:75], v[44:47], v[96:99], v[72:75]
 v_mfma_f32_16x16x32_bf16 v[76:79], v[44:47], v[100:103], v[76:79]
 s_nop 7
ka_mp_55:
 buffer_load_dwordx4 v[32:35], v110, s[28:31], s45 offen sc0 sc1
 buffer_load_dwordx4 v[36:39], v111, s[28:31], s45 offen sc0 sc1
 s_waitcnt vmcnt(0)
 v_max3_u32 v104, v32, v33, v34
 v_max3_u32 v105, v35, v36, v37
 v_max3_u32 v104, v104, v38, v39
 v_max_u32 v104, v104, v105
 v_cmp_eq_u32 vcc, -1, v104
 s_cbranch_vccz ka_mok_56
 s_add_u32 s61, s61, 1
 s_cmp_lt_u32 s61, 400000
 s_cbranch_scc1 ka_mp_55
 s_branch ka_end
ka_mok_56:
 ds_write_b128 v110, v[32:35]
 ds_write_b128 v111, v[36:39]
 s_waitcnt lgkmcnt(0)
 s_barrier
 ds_read2_b32 v[16:17], v10 offset0:0 offset1:4
 ds_read2_b32 v[18:19], v10 offset0:1 offset1:5
 ds_read2_b32 v[20:21], v11 offset0:0 offset1:4
 ds_read2_b32 v[22:23], v11 offset0:1 offset1:5
 ds_read2_b32 v[24:25], v12 offset0:0 offset1:4
 ds_read2_b32 v[26:27], v12 offset0:1 offset1:5
 ds_read2_b32 v[28:29], v13 offset0:0 offset1:4
 ds_read2_b32 v[30:31], v13 offset0:1 offset1:5
 s_waitcnt lgkmcnt(6)
 v_mfma_f32_16x16x32_bf16 v[88:91], v[16:19], v[48:51], 0
 v_mfma_f32_16x16x32_bf16 v[92:95], v[16:19], v[52:55], 0
 s_waitcnt lgkmcnt(4)
 v_mfma_f32_16x16x32_bf16 v[88:91], v[20:23], v[64:67], v[88:91]
 v_mfma_f32_16x16x32_bf16 v[92:95], v[20:23], v[68:71], v[92:95]
 s_waitcnt lgkmcnt(2)
 v_mfma_f32_16x16x32_bf16 v[88:91], v[24:27], v[80:83], v[88:91]
 v_mfma_f32_16x16x32_bf16 v[92:95], v[24:27], v[84:87], v[92:95]
 s_waitcnt lgkmcnt(0)
 v_mfma_f32_16x16x32_bf16 v[88:91], v[28:31], v[96:99], v[88:91]
 v_mfma_f32_16x16x32_bf16 v[92:95], v[28:31], v[100:103], v[92:95]
 ds_write_b128 v14, v[56:59] offset:0
 ds_write_b128 v14, v[72:75] offset:1024
 s_nop 3
 ds_write_b128 v14, v[88:91] offset:2048
 ds_write_b128 v14, v[60:63] offset:3072
 ds_write_b128 v14, v[76:79] offset:4096
 ds_write_b128 v14, v[92:95] offset:5120
 s_waitcnt lgkmcnt(0)
 s_barrier
 s_cmp_ge_u32 s6, 2
 s_cbranch_scc1 ka_nosm_57
 ds_read_b128 v[48:51], v15 offset:0
 ds_read_b128 v[52:55], v15 offset:1024
 ds_read_b128 v[56:59], v15 offset:2048
 ds_read_b128 v[60:63], v15 offset:6144
 ds_read_b128 v[64:67], v15 offset:7168
 ds_read_b128 v[68:71], v15 offset:8192
 ds_read_b128 v[72:75], v15 offset:12288
 ds_read_b128 v[76:79], v15 offset:13312
 ds_read_b128 v[80:83], v15 offset:14336
 ds_read_b128 v[84:87], v15 offset:18432
 ds_read_b128 v[88:91], v15 offset:19456
 ds_read_b128 v[92:95], v15 offset:20480
 s_waitcnt lgkmcnt(6)
 v_add_f32 v48, v48, v60
 v_add_f32 v49, v49, v61
 v_add_f32 v50, v50, v62
 v_add_f32 v51, v51, v63
 v_add_f32 v52, v52, v64
 v_add_f32 v53, v53, v65
 v_add_f32 v54, v54, v66
 v_add_f32 v55, v55, v67
 v_add_f32 v56, v56, v68
 v_add_f32 v57, v57, v69
 v_add_f32 v58, v58, v70
 v_add_f32 v59, v59, v71
 s_waitcnt lgkmcnt(0)
 v_add_f32 v72, v72, v84
 v_add_f32 v73, v73, v85
 v_add_f32 v74, v74, v86
 v_add_f32 v75, v75, v87
 v_add_f32 v76, v76, v88
 v_add_f32 v77, v77, v89
 v_add_f32 v78, v78, v90
 v_add_f32 v79, v79, v91
 v_add_f32 v80, v80, v92
 v_add_f32 v81, v81, v93
 v_add_f32 v82, v82, v94
 v_add_f32 v83, v83, v95
 v_add_f32 v72, v72, v112
 v_add_f32 v73, v73, v113
 v_add_f32 v74, v74, v114
 v_add_f32 v75, v75, v115
 v_add_f32 v76, v76, v116
 v_add_f32 v77, v77, v117
 v_add_f32 v78, v78, v118
 v_add_f32 v79, v79, v119
 v_add_f32 v48, v48, v72
 v_add_f32 v49, v49, v73
 v_add_f32 v50, v50, v74
 v_add_f32 v51, v51, v75
 v_add_f32 v52, v52, v76
 v_add_f32 v53, v53, v77
 v_add_f32 v54, v54, v78
 v_add_f32 v55, v55, v79
 v_add_f32 v56, v56, v80
 v_add_f32 v57, v57, v81
 v_add_f32 v58, v58, v82
 v_add_f32 v59, v59, v83
 v_max3_f32 v60, v48, v49, v50
 v_max3_f32 v61, v51, v52, v53
 v_max3_f32 v60, v60, v54, v55
 v_max3_f32 v61, v61, v56, v57
 v_max3_f32 v60, v60, v58, v59
 v_max_f32 v60, v60, v61
 v_mov_b32 v61, v60
 s_nop 1
 v_permlane16_swap_b32 v60, v61
 v_max_f32 v60, v60, v61
 v_mov_b32 v61, v60
 s_nop 1
 v_permlane32_swap_b32 v60, v61
 v_max_f32 v60, v60, v61
 v_sub_f32 v48, v48, v60
 v_sub_f32 v49, v49, v60
 v_sub_f32 v50, v50, v60
 v_sub_f32 v51, v51, v60
 v_sub_f32 v52, v52, v60
 v_sub_f32 v53, v53, v60
 v_sub_f32 v54, v54, v60
 v_sub_f32 v55, v55, v60
 v_sub_f32 v56, v56, v60
 v_sub_f32 v57, v57, v60
 v_sub_f32 v58, v58, v60
 v_sub_f32 v59, v59, v60
 v_exp_f32 v48, v48
 v_exp_f32 v49, v49
 v_exp_f32 v50, v50
 v_exp_f32 v51, v51
 v_exp_f32 v52, v52
 v_exp_f32 v53, v53
 v_exp_f32 v54, v54
 v_exp_f32 v55, v55
 v_exp_f32 v56, v56
 v_exp_f32 v57, v57
 v_exp_f32 v58, v58
 v_exp_f32 v59, v59
 v_add_f32 v62, v56, v57
 v_add_f32 v61, v58, v59
 v_add_f32 v62, v62, v61
 v_mul_f32 v62, 0.5, v62
 v_add_f32 v61, v48, v49
 v_add_f32 v60, v50, v51
 v_add_f32 v62, v62, v61
 v_add_f32 v61, v52, v53
 v_add_f32 v62, v62, v60
 v_add_f32 v60, v54, v55
 v_add_f32 v62, v62, v61
 v_add_f32 v62, v62, v60
 v_mov_b32 v61, v62
 s_nop 1
 v_permlane16_swap_b32 v62, v61
 v_add_f32 v62, v62, v61
 v_mov_b32 v61, v62
 s_nop 1
 v_permlane32_swap_b32 v62, v61
 v_add_f32 v62, v62, v61
 v_rcp_f32 v62, v62
 s_nop 0
 v_mul_f32 v48, v48, v62
 v_mul_f32 v49, v49, v62
 v_mul_f32 v50, v50, v62
 v_mul_f32 v51, v51, v62
 v_mul_f32 v52, v52, v62
 v_mul_f32 v53, v53, v62
 v_mul_f32 v54, v54, v62
 v_mul_f32 v55, v55, v62
 v_mul_f32 v56, v56, v62
 v_mul_f32 v57, v57, v62
 v_mul_f32 v58, v58, v62
 v_mul_f32 v59, v59, v62
 v_cvt_pk_bf16_f32 v64, v48, v49
 v_cvt_pk_bf16_f32 v65, v50, v51
 v_cvt_pk_bf16_f32 v66, v52, v53
 v_cvt_pk_bf16_f32 v67, v54, v55
 v_cvt_pk_bf16_f32 v68, v56, v57
 v_cvt_pk_bf16_f32 v69, v58, v59
 v_min_u32 v64, -2, v64
 v_min_u32 v68, -2, v68
 buffer_store_dwordx4 v[64:67], v108, s[24:27], s46 offen sc1
 buffer_store_dwordx2 v[68:69], v109, s[32:35], s47 offen sc1
 v_mov_b32 v61, 1
 s_waitcnt vmcnt(0)
 buffer_store_dword v61, v6, s[56:59], s60 offen sc1
ka_nosm_57:
 s_mul_i32 s8, s6, 7168
 s_add_u32 s8, s8, s41
 s_mov_b32 m0, s8
 s_nop 0
 buffer_load_dwordx4 v5, s[20:23], 0 offen offset:0 lds
 buffer_load_dwordx4 v5, s[20:23], 0 offen offset:1024 lds
 buffer_load_dwordx4 v5, s[20:23], 0 offen offset:2048 lds
 buffer_load_dwordx4 v5, s[20:23], 0 offen offset:3072 lds
 s_add_u32 s8, s8, 4096
 s_mov_b32 m0, s8
 s_nop 0
 buffer_load_dwordx4 v5, s[20:23], s44 offen offset:0 lds
 buffer_load_dwordx4 v5, s[20:23], s44 offen offset:1024 lds
 buffer_load_dwordx4 v5, s[20:23], s44 offen offset:2048 lds
 v_add_u32 v5, 114688, v5
 s_mov_b32 s8, s39
 s_mov_b32 s39, s40
 s_mov_b32 s40, s41
 s_mov_b32 s41, s8
 v_mov_b32 v3, v4
 v_add_u32 v4, s40, v2
 s_add_u32 s46, s46, 131072
 s_add_u32 s47, s47, 32768
 s_add_u32 s45, s45, 28672
 s_add_u32 s60, s60, 1024
 s_sub_u32 s38, s38, 1
 s_cmp_lg_u32 s38, 0
 s_cbranch_scc1 ka_gt_loop
 s_waitcnt vmcnt(0)
 s_branch ka_done
ka_go:
 s_cmp_eq_u32 s3, 0
 s_cbranch_scc0 ka_ps_59
 s_cmp_eq_u32 s6, 0
 s_cbranch_scc0 ka_pw_58
 v_and_b32 v20, 63, v0
 v_lshlrev_b32 v20, 4, v20
 v_add_u32 v20, 24150016, v20
 global_load_dwordx4 v[22:25], v20, s[4:5] sc1
 s_waitcnt vmcnt(0)
 s_mov_b32 s61, 0
ka_pd_60:
 v_min_u32 v22, v22, v23
 v_min3_u32 v22, v22, v24, v25
 v_cmp_eq_u32 vcc, 0, v22
 s_nop 1
 s_and_b64 vcc, vcc, exec
 s_cbranch_scc0 ka_pk_61
 s_add_u32 s61, s61, 1
 s_cmp_lt_u32 s61, 400000
 s_cbranch_scc0 ka_end
 s_sleep 1
 global_load_dwordx4 v[22:25], v20, s[4:5] sc1
 s_waitcnt vmcnt(0)
 s_branch ka_pd_60
ka_pk_61:
ka_pw_58:
 s_barrier
ka_ps_59:
 s_add_u32 s56, s76, 70782976
 s_addc_u32 s57, s77, 0
 s_mov_b32 s58, 256
 s_mov_b32 s59, 0x20000
 v_and_b32 v10, 63, v0
 v_lshlrev_b32 v10, 2, v10
 s_cmp_lg_u32 s6, 0
 s_cbranch_scc1 ka_wk_63
 s_mov_b32 s50, 0
ka_wl_62:
 buffer_load_dword v11, v10, s[56:59], 0 offen sc0 sc1
 s_waitcnt vmcnt(0)
 v_cmp_eq_u32 vcc, 0, v11
 s_cbranch_vccz ka_wk_63
 s_add_u32 s50, s50, 1
 s_cmp_lt_u32 s50, 400000
 s_cbranch_scc0 ka_end
 s_mov_b64 exec, vcc
 s_sleep 4
 s_branch ka_wl_62
ka_wk_63:
 s_mov_b64 exec, -1
 s_barrier
 s_add_u32 s16, s76, 26021888
 s_addc_u32 s17, s77, 0
 s_mov_b32 s18, 29360128
 s_mov_b32 s19, 0x20000
 s_add_u32 s20, s76, 57102336
 s_addc_u32 s21, s77, 0
 s_mov_b32 s22, 7340032
 s_mov_b32 s23, 0x20000
 s_add_u32 s24, s76, 64442368
 s_addc_u32 s25, s77, 0
 s_mov_b32 s26, 2097152
 s_mov_b32 s27, 0x20000
 s_add_u32 s28, s76, 66539520
 s_addc_u32 s29, s77, 0
 s_mov_b32 s30, 524288
 s_mov_b32 s31, 0x20000
 s_load_dwordx2 s[8:9], s[0:1], 0
 s_waitcnt lgkmcnt(0)
 s_add_u32 s32, s4, 15482880
 s_addc_u32 s33, s5, 0
 s_cmp_eq_u32 s3, 0
 s_cselect_b32 s32, s8, s32
 s_cselect_b32 s33, s9, s33
 s_mov_b32 s34, 1835008
 s_mov_b32 s35, 0x20000
 s_add_u32 s8, s4, 13647872
 s_addc_u32 s9, s5, 0
 s_add_u32 s36, s4, 17317888
 s_addc_u32 s37, s5, 0
 s_cmp_eq_u32 s3, 0
 s_cselect_b32 s36, s8, s36
 s_cselect_b32 s37, s9, s37
 s_mov_b32 s38, 1835008
 s_mov_b32 s39, 0x20000
 s_add_u32 s56, s76, 70762240
 s_addc_u32 s57, s77, 0
 s_mov_b32 s58, 28928
 s_mov_b32 s59, 0x20000
 v_and_b32 v1, 63, v0
 v_lshlrev_b32 v2, 4, v1
 v_lshlrev_b32 v3, 2, v1
 s_mov_b32 s42, 8
 s_mov_b32 s61, 0
 s_mov_b32 s44, 0xffff
 s_mov_b32 s45, 0
 s_mov_b32 s46, 0xffff0000
 s_mov_b32 s47, -1
 s_mul_i32 s8, s6, 14336
 v_add_u32 v6, s8, v2
 s_lshl_b32 s8, s6, 10
 v_add_u32 v7, s8, v2
ka_go_loop:
 s_add_u32 s60, s40, 1
 s_lshl_b32 s60, s60, 8
ka_fw_64:
 buffer_load_dword v4, v3, s[56:59], s60 offen sc0 sc1
 s_waitcnt vmcnt(0)
 v_cmp_eq_u32 vcc, 0, v4
 s_nop 1
 s_and_b64 vcc, vcc, s[44:45]
 s_cbranch_scc0 ka_fok_65
 s_add_u32 s61, s61, 1
 s_cmp_lt_u32 s61, 400000
 s_cbranch_scc1 ka_fw_64
 s_branch ka_end
ka_fok_65:
 s_mul_i32 s8, s40, 458752
 s_mul_i32 s9, s6, 114688
 s_add_u32 s8, s8, s9
 s_mul_i32 s9, s41, 7168
 s_add_u32 s8, s8, s9
 s_add_u32 s9, s8, 4096
 buffer_load_dwordx4 a[0:3], v2, s[16:19], s8 offen offset:0 sc1
 buffer_load_dwordx4 a[4:7], v2, s[16:19], s8 offen offset:1024 sc1
 buffer_load_dwordx4 a[8:11], v2, s[16:19], s8 offen offset:2048 sc1
 buffer_load_dwordx4 a[12:15], v2, s[16:19], s8 offen offset:3072 sc1
 buffer_load_dwordx4 a[16:19], v2, s[16:19], s9 offen offset:0 sc1
 buffer_load_dwordx4 a[20:23], v2, s[16:19], s9 offen offset:1024 sc1
 buffer_load_dwordx4 a[24:27], v2, s[16:19], s9 offen offset:2048 sc1
 s_add_u32 s8, s8, 28672
 s_add_u32 s9, s8, 4096
 buffer_load_dwordx4 a[28:31], v2, s[16:19], s8 offen offset:0 sc1
 buffer_load_dwordx4 a[32:35], v2, s[16:19], s8 offen offset:1024 sc1
 buffer_load_dwordx4 a[36:39], v2, s[16:19], s8 offen offset:2048 sc1
 buffer_load_dwordx4 a[40:43], v2, s[16:19], s8 offen offset:3072 sc1
 buffer_load_dwordx4 a[44:47], v2, s[16:19], s9 offen offset:0 sc1
 buffer_load_dwordx4 a[48:51], v2, s[16:19], s9 offen offset:1024 sc1
 buffer_load_dwordx4 a[52:55], v2, s[16:19], s9 offen offset:2048 sc1
 s_add_u32 s8, s8, 28672
 s_add_u32 s9, s8, 4096
 buffer_load_dwordx4 a[56:59], v2, s[16:19], s8 offen offset:0 sc1
 buffer_load_dwordx4 a[60:63], v2, s[16:19], s8 offen offset:1024 sc1
 buffer_load_dwordx4 a[64:67], v2, s[16:19], s8 offen offset:2048 sc1
 buffer_load_dwordx4 a[68:71], v2, s[16:19], s8 offen offset:3072 sc1
 buffer_load_dwordx4 a[72:75], v2, s[16:19], s9 offen offset:0 sc1
 buffer_load_dwordx4 a[76:79], v2, s[16:19], s9 offen offset:1024 sc1
 buffer_load_dwordx4 a[80:83], v2, s[16:19], s9 offen offset:2048 sc1
 s_add_u32 s8, s8, 28672
 s_add_u32 s9, s8, 4096
 buffer_load_dwordx4 a[84:87], v2, s[16:19], s8 offen offset:0 sc1
 buffer_load_dwordx4 a[88:91], v2, s[16:19], s8 offen offset:1024 sc1
 buffer_load_dwordx4 a[92:95], v2, s[16:19], s8 offen offset:2048 sc1
 buffer_load_dwordx4 a[96:99], v2, s[16:19], s8 offen offset:3072 sc1
 buffer_load_dwordx4 a[100:103], v2, s[16:19], s9 offen offset:0 sc1
 buffer_load_dwordx4 a[104:107], v2, s[16:19], s9 offen offset:1024 sc1
 buffer_load_dwordx4 a[108:111], v2, s[16:19], s9 offen offset:2048 sc1
 s_add_u32 s8, s8, 28672
 v_and_b32 v8, 15, v1
 v_lshrrev_b32 v9, 4, v1
 v_lshrrev_b32 v10, 2, v8
 v_lshlrev_b32 v10, 3, v10
 v_and_b32 v11, 3, v8
 v_add_u32 v10, v10, v11
 s_and_b32 s8, s6, 1
 s_lshl_b32 s8, s8, 2
 s_lshl_b32 s9, s40, 5
 s_add_u32 s8, s8, s9
 v_add_u32 v10, s8, v10
 v_mul_u32_u24 v10, 896, v10
 s_mul_i32 s8, s41, 7
 s_lshr_b32 s9, s6, 1
 s_add_u32 s8, s8, s9
 s_lshl_b32 s8, s8, 5
 v_lshl_add_u32 v10, v9, 3, v10
 v_add_u32 v5, s8, v10
 buffer_load_dwordx2 v[120:121], v5, s[32:35], 0 offen offset:0 sc1
 buffer_load_dwordx2 v[122:123], v5, s[32:35], 0 offen offset:64 sc1
 buffer_load_dwordx2 v[124:125], v5, s[32:35], 0 offen offset:128 sc1
 buffer_load_dwordx2 v[126:127], v5, s[32:35], 0 offen offset:192 sc1

 s_lshl_b32 s8, s40, 15
 s_lshl_b32 s9, s6, 13
 s_add_u32 s8, s8, s9
 s_add_u32 s9, s8, 4096
 s_lshl_b32 s10, s40, 13
 s_lshl_b32 s11, s6, 11
 s_add_u32 s10, s10, s11
 s_mul_i32 s11, s40, 114688
 s_mul_i32 s12, s6, 28
 s_mul_i32 s13, s41, 7
 s_add_u32 s12, s12, s13
 s_lshl_b32 s12, s12, 10
 s_add_u32 s11, s11, s12
 s_add_u32 s12, s11, 4096
 s_cmp_eq_u32 s42, 1
 s_cbranch_scc1 ka_gs_66
ka_fw_68:
 buffer_load_dword v4, v3, s[56:59], s60 offen sc0 sc1
 s_waitcnt vmcnt(0)
 v_cmp_eq_u32 vcc, 0, v4
 s_nop 1
 s_and_b64 vcc, vcc, s[46:47]
 s_cbranch_scc0 ka_fok_69
 s_add_u32 s61, s61, 1
 s_cmp_lt_u32 s61, 400000
 s_cbranch_scc1 ka_fw_68
 s_branch ka_end
ka_fok_69:
 buffer_load_dwordx4 v[16:19], v2, s[24:27], s8 offen offset:0 sc1
 buffer_load_dwordx4 v[20:23], v2, s[24:27], s8 offen offset:1024 sc1
 buffer_load_dwordx4 v[24:27], v2, s[24:27], s8 offen offset:2048 sc1
 buffer_load_dwordx4 v[28:31], v2, s[24:27], s8 offen offset:3072 sc1
 buffer_load_dwordx4 v[32:35], v2, s[24:27], s9 offen offset:0 sc1
 buffer_load_dwordx4 v[36:39], v2, s[24:27], s9 offen offset:1024 sc1
 buffer_load_dwordx4 v[40:43], v2, s[24:27], s9 offen offset:2048 sc1
 buffer_load_dwordx4 v[44:47], v2, s[24:27], s9 offen offset:3072 sc1
 buffer_load_dwordx4 v[48:51], v2, s[28:31], s10 offen offset:0 sc1
 buffer_load_dwordx4 v[52:55], v2, s[28:31], s10 offen offset:1024 sc1
 buffer_load_dwordx4 v[128:131], v2, s[20:23], s11 offen offset:0 sc1
 buffer_load_dwordx4 v[132:135], v2, s[20:23], s11 offen offset:1024 sc1
 buffer_load_dwordx4 v[136:139], v2, s[20:23], s11 offen offset:2048 sc1
 buffer_load_dwordx4 v[140:143], v2, s[20:23], s11 offen offset:3072 sc1
 buffer_load_dwordx4 v[144:147], v2, s[20:23], s12 offen offset:0 sc1
 buffer_load_dwordx4 v[148:151], v2, s[20:23], s12 offen offset:1024 sc1
 buffer_load_dwordx4 v[152:155], v2, s[20:23], s12 offen offset:2048 sc1
ka_gj_67:
 s_waitcnt vmcnt(15)
 v_mfma_f32_16x16x32_bf16 v[64:67], a[0:3], v[16:19], 0
 v_mfma_f32_16x16x32_bf16 v[68:71], a[0:3], v[20:23], 0
 v_mfma_f32_16x16x32_bf16 v[72:75], a[4:7], v[16:19], 0
 v_mfma_f32_16x16x32_bf16 v[76:79], a[4:7], v[20:23], 0
 v_mfma_f32_16x16x32_bf16 v[80:83], a[8:11], v[16:19], 0
 v_mfma_f32_16x16x32_bf16 v[84:87], a[8:11], v[20:23], 0
 v_mfma_f32_16x16x32_bf16 v[88:91], a[12:15], v[16:19], 0
 v_mfma_f32_16x16x32_bf16 v[92:95], a[12:15], v[20:23], 0
 v_mfma_f32_16x16x32_bf16 v[96:99], a[16:19], v[16:19], 0
 v_mfma_f32_16x16x32_bf16 v[100:103], a[16:19], v[20:23], 0
 v_mfma_f32_16x16x32_bf16 v[104:107], a[20:23], v[16:19], 0
 v_mfma_f32_16x16x32_bf16 v[108:111], a[20:23], v[20:23], 0
 v_mfma_f32_16x16x32_bf16 v[112:115], a[24:27], v[16:19], 0
 v_mfma_f32_16x16x32_bf16 v[116:119], a[24:27], v[20:23], 0
 s_waitcnt vmcnt(13)
 v_mfma_f32_16x16x32_bf16 v[64:67], a[28:31], v[24:27], v[64:67]
 v_mfma_f32_16x16x32_bf16 v[68:71], a[28:31], v[28:31], v[68:71]
 v_mfma_f32_16x16x32_bf16 v[72:75], a[32:35], v[24:27], v[72:75]
 v_mfma_f32_16x16x32_bf16 v[76:79], a[32:35], v[28:31], v[76:79]
 v_mfma_f32_16x16x32_bf16 v[80:83], a[36:39], v[24:27], v[80:83]
 v_mfma_f32_16x16x32_bf16 v[84:87], a[36:39], v[28:31], v[84:87]
 v_mfma_f32_16x16x32_bf16 v[88:91], a[40:43], v[24:27], v[88:91]
 v_mfma_f32_16x16x32_bf16 v[92:95], a[40:43], v[28:31], v[92:95]
 v_mfma_f32_16x16x32_bf16 v[96:99], a[44:47], v[24:27], v[96:99]
 v_mfma_f32_16x16x32_bf16 v[100:103], a[44:47], v[28:31], v[100:103]
 v_mfma_f32_16x16x32_bf16 v[104:107], a[48:51], v[24:27], v[104:107]
 v_mfma_f32_16x16x32_bf16 v[108:111], a[48:51], v[28:31], v[108:111]
 v_mfma_f32_16x16x32_bf16 v[112:115], a[52:55], v[24:27], v[112:115]
 v_mfma_f32_16x16x32_bf16 v[116:119], a[52:55], v[28:31], v[116:119]
 s_waitcnt vmcnt(11)
 v_mfma_f32_16x16x32_bf16 v[64:67], a[56:59], v[32:35], v[64:67]
 v_mfma_f32_16x16x32_bf16 v[68:71], a[56:59], v[36:39], v[68:71]
 v_mfma_f32_16x16x32_bf16 v[72:75], a[60:63], v[32:35], v[72:75]
 v_mfma_f32_16x16x32_bf16 v[76:79], a[60:63], v[36:39], v[76:79]
 v_mfma_f32_16x16x32_bf16 v[80:83], a[64:67], v[32:35], v[80:83]
 v_mfma_f32_16x16x32_bf16 v[84:87], a[64:67], v[36:39], v[84:87]
 v_mfma_f32_16x16x32_bf16 v[88:91], a[68:71], v[32:35], v[88:91]
 v_mfma_f32_16x16x32_bf16 v[92:95], a[68:71], v[36:39], v[92:95]
 v_mfma_f32_16x16x32_bf16 v[96:99], a[72:75], v[32:35], v[96:99]
 v_mfma_f32_16x16x32_bf16 v[100:103], a[72:75], v[36:39], v[100:103]
 v_mfma_f32_16x16x32_bf16 v[104:107], a[76:79], v[32:35], v[104:107]
 v_mfma_f32_16x16x32_bf16 v[108:111], a[76:79], v[36:39], v[108:111]
 v_mfma_f32_16x16x32_bf16 v[112:115], a[80:83], v[32:35], v[112:115]
 v_mfma_f32_16x16x32_bf16 v[116:119], a[80:83], v[36:39], v[116:119]
 s_waitcnt vmcnt(9)
 v_mfma_f32_16x16x32_bf16 v[64:67], a[84:87], v[40:43], v[64:67]
 v_mfma_f32_16x16x32_bf16 v[68:71], a[84:87], v[44:47], v[68:71]
 v_mfma_f32_16x16x32_bf16 v[72:75], a[88:91], v[40:43], v[72:75]
 v_mfma_f32_16x16x32_bf16 v[76:79], a[88:91], v[44:47], v[76:79]
 v_mfma_f32_16x16x32_bf16 v[80:83], a[92:95], v[40:43], v[80:83]
 v_mfma_f32_16x16x32_bf16 v[84:87], a[92:95], v[44:47], v[84:87]
 v_mfma_f32_16x16x32_bf16 v[88:91], a[96:99], v[40:43], v[88:91]
 v_mfma_f32_16x16x32_bf16 v[92:95], a[96:99], v[44:47], v[92:95]
 v_mfma_f32_16x16x32_bf16 v[96:99], a[100:103], v[40:43], v[96:99]
 v_mfma_f32_16x16x32_bf16 v[100:103], a[100:103], v[44:47], v[100:103]
 v_mfma_f32_16x16x32_bf16 v[104:107], a[104:107], v[40:43], v[104:107]
 v_mfma_f32_16x16x32_bf16 v[108:111], a[104:107], v[44:47], v[108:111]
 v_mfma_f32_16x16x32_bf16 v[112:115], a[108:111], v[40:43], v[112:115]
 v_mfma_f32_16x16x32_bf16 v[116:119], a[108:111], v[44:47], v[116:119]
 s_waitcnt vmcnt(0)
ka_gk_70:
 v_mfma_f32_16x16x32_bf16 v[64:67], v[128:131], v[48:51], v[64:67]
 v_mfma_f32_16x16x32_bf16 v[68:71], v[128:131], v[52:55], v[68:71]
 v_mfma_f32_16x16x32_bf16 v[72:75], v[132:135], v[48:51], v[72:75]
 v_mfma_f32_16x16x32_bf16 v[76:79], v[132:135], v[52:55], v[76:79]
 v_mfma_f32_16x16x32_bf16 v[80:83], v[136:139], v[48:51], v[80:83]
 v_mfma_f32_16x16x32_bf16 v[84:87], v[136:139], v[52:55], v[84:87]
 v_mfma_f32_16x16x32_bf16 v[88:91], v[140:143], v[48:51], v[88:91]
 v_mfma_f32_16x16x32_bf16 v[92:95], v[140:143], v[52:55], v[92:95]
 v_mfma_f32_16x16x32_bf16 v[96:99], v[144:147], v[48:51], v[96:99]
 v_mfma_f32_16x16x32_bf16 v[100:103], v[144:147], v[52:55], v[100:103]
 v_mfma_f32_16x16x32_bf16 v[104:107], v[148:151], v[48:51], v[104:107]
 v_mfma_f32_16x16x32_bf16 v[108:111], v[148:151], v[52:55], v[108:111]
 v_mfma_f32_16x16x32_bf16 v[112:115], v[152:155], v[48:51], v[112:115]
 v_mfma_f32_16x16x32_bf16 v[116:119], v[152:155], v[52:55], v[116:119]
 ds_write_b128 v6, v[64:67] offset:0
 ds_write_b128 v6, v[68:71] offset:1024
 ds_write_b128 v6, v[72:75] offset:2048
 ds_write_b128 v6, v[76:79] offset:3072
 ds_write_b128 v6, v[80:83] offset:4096
 ds_write_b128 v6, v[84:87] offset:5120
 ds_write_b128 v6, v[88:91] offset:6144
 ds_write_b128 v6, v[92:95] offset:7168
 ds_write_b128 v6, v[96:99] offset:8192
 ds_write_b128 v6, v[100:103] offset:9216
 ds_write_b128 v6, v[104:107] offset:10240
 ds_write_b128 v6, v[108:111] offset:11264
 ds_write_b128 v6, v[112:115] offset:12288
 ds_write_b128 v6, v[116:119] offset:13312
 s_waitcnt lgkmcnt(0)
 s_barrier
 ds_read_b128 v[16:19], v7 offset:0
 ds_read_b128 v[20:23], v7 offset:14336
 ds_read_b128 v[24:27], v7 offset:28672
 ds_read_b128 v[28:31], v7 offset:43008
 ds_read_b128 v[32:35], v7 offset:4096
 ds_read_b128 v[36:39], v7 offset:18432
 ds_read_b128 v[40:43], v7 offset:32768
 ds_read_b128 v[44:47], v7 offset:47104
 ds_read_b128 v[48:51], v7 offset:8192
 ds_read_b128 v[52:55], v7 offset:22528
 ds_read_b128 v[56:59], v7 offset:36864
 ds_read_b128 v[60:63], v7 offset:51200
 s_cmp_ge_u32 s6, 2
 s_cbranch_scc1 ka_t3_71
 ds_read_b128 v[64:67], v7 offset:12288
 ds_read_b128 v[68:71], v7 offset:26624
 ds_read_b128 v[72:75], v7 offset:40960
 ds_read_b128 v[76:79], v7 offset:55296
 s_waitcnt lgkmcnt(0)
 v_add_f32 v64, v64, v68
 v_add_f32 v72, v72, v76
 v_add_f32 v65, v65, v69
 v_add_f32 v73, v73, v77
 v_add_f32 v66, v66, v70
 v_add_f32 v74, v74, v78
 v_add_f32 v67, v67, v71
 v_add_f32 v75, v75, v79
 v_lshlrev_b32 v68, 16, v126
 v_and_b32 v69, 0xffff0000, v126
 v_lshlrev_b32 v70, 16, v127
 v_and_b32 v71, 0xffff0000, v127
 v_add_f32 v64, v64, v72
 v_add_f32 v65, v65, v73
 v_add_f32 v66, v66, v74
 v_add_f32 v67, v67, v75
 v_add_f32 v64, v64, v68
 v_add_f32 v65, v65, v69
 v_add_f32 v66, v66, v70
 v_add_f32 v67, v67, v71
 v_cvt_pk_bf16_f32 v64, v64, v65
 v_cvt_pk_bf16_f32 v65, v66, v67
 v_min_u32 v64, -2, v64
 buffer_store_dwordx2 v[64:65], v5, s[36:39], 0 offen offset:192 sc1
ka_t3_71:
 s_waitcnt lgkmcnt(0)
 v_add_f32 v16, v16, v20
 v_add_f32 v24, v24, v28
 v_add_f32 v17, v17, v21
 v_add_f32 v25, v25, v29
 v_add_f32 v18, v18, v22
 v_add_f32 v26, v26, v30
 v_add_f32 v19, v19, v23
 v_add_f32 v27, v27, v31
 v_lshlrev_b32 v20, 16, v120
 v_and_b32 v21, 0xffff0000, v120
 v_lshlrev_b32 v22, 16, v121
 v_and_b32 v23, 0xffff0000, v121
 v_add_f32 v16, v16, v24
 v_add_f32 v17, v17, v25
 v_add_f32 v18, v18, v26
 v_add_f32 v19, v19, v27
 v_add_f32 v16, v16, v20
 v_add_f32 v17, v17, v21
 v_add_f32 v18, v18, v22
 v_add_f32 v19, v19, v23
 v_cvt_pk_bf16_f32 v16, v16, v17
 v_cvt_pk_bf16_f32 v17, v18, v19
 v_min_u32 v16, -2, v16
 buffer_store_dwordx2 v[16:17], v5, s[36:39], 0 offen offset:0 sc1
 v_add_f32 v32, v32, v36
 v_add_f32 v40, v40, v44
 v_add_f32 v33, v33, v37
 v_add_f32 v41, v41, v45
 v_add_f32 v34, v34, v38
 v_add_f32 v42, v42, v46
 v_add_f32 v35, v35, v39
 v_add_f32 v43, v43, v47
 v_lshlrev_b32 v36, 16, v122
 v_and_b32 v37, 0xffff0000, v122
 v_lshlrev_b32 v38, 16, v123
 v_and_b32 v39, 0xffff0000, v123
 v_add_f32 v32, v32, v40
 v_add_f32 v33, v33, v41
 v_add_f32 v34, v34, v42
 v_add_f32 v35, v35, v43
 v_add_f32 v32, v32, v36
 v_add_f32 v33, v33, v37
 v_add_f32 v34, v34, v38
 v_add_f32 v35, v35, v39
 v_cvt_pk_bf16_f32 v32, v32, v33
 v_cvt_pk_bf16_f32 v33, v34, v35
 v_min_u32 v32, -2, v32
 buffer_store_dwordx2 v[32:33], v5, s[36:39], 0 offen offset:64 sc1
 v_add_f32 v48, v48, v52
 v_add_f32 v56, v56, v60
 v_add_f32 v49, v49, v53
 v_add_f32 v57, v57, v61
 v_add_f32 v50, v50, v54
 v_add_f32 v58, v58, v62
 v_add_f32 v51, v51, v55
 v_add_f32 v59, v59, v63
 v_lshlrev_b32 v52, 16, v124
 v_and_b32 v53, 0xffff0000, v124
 v_lshlrev_b32 v54, 16, v125
 v_and_b32 v55, 0xffff0000, v125
 v_add_f32 v48, v48, v56
 v_add_f32 v49, v49, v57
 v_add_f32 v50, v50, v58
 v_add_f32 v51, v51, v59
 v_add_f32 v48, v48, v52
 v_add_f32 v49, v49, v53
 v_add_f32 v50, v50, v54
 v_add_f32 v51, v51, v55
 v_cvt_pk_bf16_f32 v48, v48, v49
 v_cvt_pk_bf16_f32 v49, v50, v51
 v_min_u32 v48, -2, v48
 buffer_store_dwordx2 v[48:49], v5, s[36:39], 0 offen offset:128 sc1
 s_barrier
 s_add_u32 s40, s40, 8
 s_sub_u32 s42, s42, 1
 s_cmp_lg_u32 s42, 0
 s_cbranch_scc1 ka_go_loop
 s_waitcnt vmcnt(0)
 s_branch ka_done
ka_gs_66:
 s_mov_b32 s50, 0
ka_dl_72:
 buffer_load_dwordx4 v[16:19], v2, s[24:27], s8 offen offset:0 sc1
 buffer_load_dwordx4 v[20:23], v2, s[24:27], s8 offen offset:1024 sc1
 buffer_load_dwordx4 v[24:27], v2, s[24:27], s8 offen offset:2048 sc1
 buffer_load_dwordx4 v[28:31], v2, s[24:27], s8 offen offset:3072 sc1
 buffer_load_dwordx4 v[32:35], v2, s[24:27], s9 offen offset:0 sc1
 buffer_load_dwordx4 v[36:39], v2, s[24:27], s9 offen offset:1024 sc1
 buffer_load_dwordx4 v[40:43], v2, s[24:27], s9 offen offset:2048 sc1
 buffer_load_dwordx4 v[44:47], v2, s[24:27], s9 offen offset:3072 sc1
 buffer_load_dwordx4 v[48:51], v2, s[28:31], s10 offen offset:0 sc1
 buffer_load_dwordx4 v[52:55], v2, s[28:31], s10 offen offset:1024 sc1
 s_waitcnt vmcnt(0)
 v_max3_u32 v160, v16, v20, v24
 v_max3_u32 v161, v28, v32, v36
 v_max3_u32 v162, v40, v44, v48
 v_max3_u32 v163, v50, v52, v54
 v_max3_u32 v164, v160, v161, v162
 v_max_u32 v165, v164, v163
 v_cmp_eq_u32 vcc, -1, v165
 s_cbranch_vccz ka_dk_73
 s_add_u32 s50, s50, 1
 s_cmp_lt_u32 s50, 400000
 s_cbranch_scc0 ka_end
 s_mov_b64 exec, vcc
 s_sleep 2
 s_branch ka_dl_72
ka_dk_73:
 s_mov_b64 exec, -1
 s_mov_b32 s50, 0
 buffer_load_dwordx4 v[128:131], v2, s[20:23], s11 offen offset:0 sc1
 buffer_load_dwordx4 v[132:135], v2, s[20:23], s11 offen offset:1024 sc1
 buffer_load_dwordx4 v[136:139], v2, s[20:23], s11 offen offset:2048 sc1
 buffer_load_dwordx4 v[140:143], v2, s[20:23], s11 offen offset:3072 sc1
 buffer_load_dwordx4 v[144:147], v2, s[20:23], s12 offen offset:0 sc1
 buffer_load_dwordx4 v[148:151], v2, s[20:23], s12 offen offset:1024 sc1
 buffer_load_dwordx4 v[152:155], v2, s[20:23], s12 offen offset:2048 sc1
 v_mfma_f32_16x16x32_bf16 v[64:67], a[0:3], v[16:19], 0
 v_mfma_f32_16x16x32_bf16 v[68:71], a[0:3], v[20:23], 0
 v_mfma_f32_16x16x32_bf16 v[72:75], a[4:7], v[16:19], 0
 v_mfma_f32_16x16x32_bf16 v[76:79], a[4:7], v[20:23], 0
 v_mfma_f32_16x16x32_bf16 v[80:83], a[8:11], v[16:19], 0
 v_mfma_f32_16x16x32_bf16 v[84:87], a[8:11], v[20:23], 0
 v_mfma_f32_16x16x32_bf16 v[88:91], a[12:15], v[16:19], 0
 v_mfma_f32_16x16x32_bf16 v[92:95], a[12:15], v[20:23], 0
 v_mfma_f32_16x16x32_bf16 v[96:99], a[16:19], v[16:19], 0
 v_mfma_f32_16x16x32_bf16 v[100:103], a[16:19], v[20:23], 0
 v_mfma_f32_16x16x32_bf16 v[104:107], a[20:23], v[16:19], 0
 v_mfma_f32_16x16x32_bf16 v[108:111], a[20:23], v[20:23], 0
 v_mfma_f32_16x16x32_bf16 v[112:115], a[24:27], v[16:19], 0
 v_mfma_f32_16x16x32_bf16 v[116:119], a[24:27], v[20:23], 0
 v_mfma_f32_16x16x32_bf16 v[64:67], a[28:31], v[24:27], v[64:67]
 v_mfma_f32_16x16x32_bf16 v[68:71], a[28:31], v[28:31], v[68:71]
 v_mfma_f32_16x16x32_bf16 v[72:75], a[32:35], v[24:27], v[72:75]
 v_mfma_f32_16x16x32_bf16 v[76:79], a[32:35], v[28:31], v[76:79]
 v_mfma_f32_16x16x32_bf16 v[80:83], a[36:39], v[24:27], v[80:83]
 v_mfma_f32_16x16x32_bf16 v[84:87], a[36:39], v[28:31], v[84:87]
 v_mfma_f32_16x16x32_bf16 v[88:91], a[40:43], v[24:27], v[88:91]
 v_mfma_f32_16x16x32_bf16 v[92:95], a[40:43], v[28:31], v[92:95]
 v_mfma_f32_16x16x32_bf16 v[96:99], a[44:47], v[24:27], v[96:99]
 v_mfma_f32_16x16x32_bf16 v[100:103], a[44:47], v[28:31], v[100:103]
 v_mfma_f32_16x16x32_bf16 v[104:107], a[48:51], v[24:27], v[104:107]
 v_mfma_f32_16x16x32_bf16 v[108:111], a[48:51], v[28:31], v[108:111]
 v_mfma_f32_16x16x32_bf16 v[112:115], a[52:55], v[24:27], v[112:115]
 v_mfma_f32_16x16x32_bf16 v[116:119], a[52:55], v[28:31], v[116:119]
 v_mfma_f32_16x16x32_bf16 v[64:67], a[56:59], v[32:35], v[64:67]
 v_mfma_f32_16x16x32_bf16 v[68:71], a[56:59], v[36:39], v[68:71]
 v_mfma_f32_16x16x32_bf16 v[72:75], a[60:63], v[32:35], v[72:75]
 v_mfma_f32_16x16x32_bf16 v[76:79], a[60:63], v[36:39], v[76:79]
 v_mfma_f32_16x16x32_bf16 v[80:83], a[64:67], v[32:35], v[80:83]
 v_mfma_f32_16x16x32_bf16 v[84:87], a[64:67], v[36:39], v[84:87]
 v_mfma_f32_16x16x32_bf16 v[88:91], a[68:71], v[32:35], v[88:91]
 v_mfma_f32_16x16x32_bf16 v[92:95], a[68:71], v[36:39], v[92:95]
 v_mfma_f32_16x16x32_bf16 v[96:99], a[72:75], v[32:35], v[96:99]
 v_mfma_f32_16x16x32_bf16 v[100:103], a[72:75], v[36:39], v[100:103]
 v_mfma_f32_16x16x32_bf16 v[104:107], a[76:79], v[32:35], v[104:107]
 v_mfma_f32_16x16x32_bf16 v[108:111], a[76:79], v[36:39], v[108:111]
 v_mfma_f32_16x16x32_bf16 v[112:115], a[80:83], v[32:35], v[112:115]
 v_mfma_f32_16x16x32_bf16 v[116:119], a[80:83], v[36:39], v[116:119]
 v_mfma_f32_16x16x32_bf16 v[64:67], a[84:87], v[40:43], v[64:67]
 v_mfma_f32_16x16x32_bf16 v[68:71], a[84:87], v[44:47], v[68:71]
 v_mfma_f32_16x16x32_bf16 v[72:75], a[88:91], v[40:43], v[72:75]
 v_mfma_f32_16x16x32_bf16 v[76:79], a[88:91], v[44:47], v[76:79]
 v_mfma_f32_16x16x32_bf16 v[80:83], a[92:95], v[40:43], v[80:83]
 v_mfma_f32_16x16x32_bf16 v[84:87], a[92:95], v[44:47], v[84:87]
 v_mfma_f32_16x16x32_bf16 v[88:91], a[96:99], v[40:43], v[88:91]
 v_mfma_f32_16x16x32_bf16 v[92:95], a[96:99], v[44:47], v[92:95]
 v_mfma_f32_16x16x32_bf16 v[96:99], a[100:103], v[40:43], v[96:99]
 v_mfma_f32_16x16x32_bf16 v[100:103], a[100:103], v[44:47], v[100:103]
 v_mfma_f32_16x16x32_bf16 v[104:107], a[104:107], v[40:43], v[104:107]
 v_mfma_f32_16x16x32_bf16 v[108:111], a[104:107], v[44:47], v[108:111]
 v_mfma_f32_16x16x32_bf16 v[112:115], a[108:111], v[40:43], v[112:115]
 v_mfma_f32_16x16x32_bf16 v[116:119], a[108:111], v[44:47], v[116:119]
 s_branch ka_d1_76
ka_dl_74:
 buffer_load_dwordx4 v[128:131], v2, s[20:23], s11 offen offset:0 sc1
 buffer_load_dwordx4 v[132:135], v2, s[20:23], s11 offen offset:1024 sc1
 buffer_load_dwordx4 v[136:139], v2, s[20:23], s11 offen offset:2048 sc1
 buffer_load_dwordx4 v[140:143], v2, s[20:23], s11 offen offset:3072 sc1
 buffer_load_dwordx4 v[144:147], v2, s[20:23], s12 offen offset:0 sc1
 buffer_load_dwordx4 v[148:151], v2, s[20:23], s12 offen offset:1024 sc1
 buffer_load_dwordx4 v[152:155], v2, s[20:23], s12 offen offset:2048 sc1
ka_d1_76:
 s_waitcnt vmcnt(0)
 v_max3_u32 v160, v128, v130, v132
 v_max3_u32 v161, v134, v136, v138
 v_max3_u32 v162, v140, v142, v144
 v_max3_u32 v163, v146, v148, v150
 v_max3_u32 v164, v160, v161, v162
 v_max3_u32 v165, v163, v152, v154
 v_max_u32 v166, v164, v165
 v_cmp_eq_u32 vcc, -1, v166
 s_cbranch_vccz ka_dk_75
 s_add_u32 s50, s50, 1
 s_cmp_lt_u32 s50, 400000
 s_cbranch_scc0 ka_end
 s_mov_b64 exec, vcc
 s_sleep 2
 s_branch ka_dl_74
ka_dk_75:
 s_mov_b64 exec, -1
 s_branch ka_gk_70
ka_pf:
 s_cmp_eq_u32 s3, 0
 s_cbranch_scc0 ka_ps_78
 s_cmp_eq_u32 s6, 0
 s_cbranch_scc0 ka_pw_77
 v_and_b32 v20, 63, v0
 v_lshlrev_b32 v20, 4, v20
 v_add_u32 v20, 24150016, v20
 global_load_dwordx4 v[22:25], v20, s[4:5] sc1
 s_waitcnt vmcnt(0)
 s_mov_b32 s61, 0
ka_pd_79:
 v_min_u32 v22, v22, v23
 v_min3_u32 v22, v22, v24, v25
 v_cmp_eq_u32 vcc, 0, v22
 s_nop 1
 s_and_b64 vcc, vcc, exec
 s_cbranch_scc0 ka_pk_80
 s_add_u32 s61, s61, 1
 s_cmp_lt_u32 s61, 400000
 s_cbranch_scc0 ka_end
 s_sleep 1
 global_load_dwordx4 v[22:25], v20, s[4:5] sc1
 s_waitcnt vmcnt(0)
 s_branch ka_pd_79
ka_pk_80:
ka_pw_77:
 s_barrier
ka_ps_78:
 s_add_u32 s28, s76, 55382016
 s_addc_u32 s29, s77, 0
 s_mov_b32 s30, 465920
 s_mov_b32 s31, 0x20000
 s_add_u32 s44, s76, 55848960
 s_addc_u32 s45, s77, 0
 s_mov_b32 s46, 465920
 s_mov_b32 s47, 0x20000
 s_sub_u32 s41, s7, 30
 s_lshl_b32 s41, s41, 2
 s_add_u32 s41, s41, s6
 s_cmp_ge_u32 s41, 7
 s_cbranch_scc1 ka_done
 v_and_b32 v1, 63, v0
 v_lshlrev_b32 v1, 4, v1
 s_lshl_b32 s8, s41, 10
 v_add_u32 v5, s8, v1
 s_mov_b32 s61, 0
 s_mov_b32 s40, 1
 s_mov_b32 s8, 7168
ka_pfm_81:
 buffer_load_dwordx4 v[16:19], v5, s[28:31], s8 offen sc0 sc1
 s_waitcnt vmcnt(0)
 v_max3_u32 v12, v16, v17, v18
 v_max_u32 v12, v12, v19
 v_cmp_eq_u32 vcc, -1, v12
 s_cbranch_vccz ka_pfk_82
 s_add_u32 s61, s61, 1
 s_cmp_lt_u32 s61, 400000
 s_cbranch_scc1 ka_pfm_81
 s_branch ka_end
ka_pfk_82:
 buffer_store_dwordx4 v[16:19], v5, s[44:47], s8 offen sc1
 s_add_u32 s8, s8, 7168
 s_add_u32 s40, s40, 1
 s_cmp_lt_u32 s40, 63
 s_cbranch_scc1 ka_pfm_81
 s_waitcnt vmcnt(0)
 s_branch ka_done
ka_rsv:
 s_cmp_eq_u32 s3, 0
 s_cbranch_scc0 ka_ps_84
 s_cmp_eq_u32 s6, 0
 s_cbranch_scc0 ka_pw_83
 v_and_b32 v20, 63, v0
 v_lshlrev_b32 v20, 4, v20
 v_add_u32 v20, 24150016, v20
 global_load_dwordx4 v[22:25], v20, s[4:5] sc1
 s_waitcnt vmcnt(0)
 s_mov_b32 s61, 0
ka_pd_85:
 v_min_u32 v22, v22, v23
 v_min3_u32 v22, v22, v24, v25
 v_cmp_eq_u32 vcc, 0, v22
 s_nop 1
 s_and_b64 vcc, vcc, exec
 s_cbranch_scc0 ka_pk_86
 s_add_u32 s61, s61, 1
 s_cmp_lt_u32 s61, 400000
 s_cbranch_scc0 ka_end
 s_sleep 1
 global_load_dwordx4 v[22:25], v20, s[4:5] sc1
 s_waitcnt vmcnt(0)
 s_branch ka_pd_85
ka_pk_86:
ka_pw_83:
 s_barrier
ka_ps_84:
 s_add_u32 s52, s76, 70762496
 s_addc_u32 s53, s77, 0
 s_mov_b32 s54, 64
 s_mov_b32 s55, 0x20000
 s_cmp_eq_u32 s3, 0
 s_cbranch_scc0 ka_xs_89
 s_cmp_eq_u32 s6, 0
 s_cbranch_scc0 ka_xo_88
 v_and_b32 v20, 15, v0
 v_lshlrev_b32 v20, 2, v20
 s_mov_b32 s61, 0
ka_xv_87:
 buffer_load_dword v21, v20, s[52:55], 0 offen sc1
 s_waitcnt vmcnt(0)
 v_cmp_eq_u32 vcc, 0, v21
 s_cbranch_vccz ka_xo_88
 s_add_u32 s61, s61, 1
 s_cmp_lt_u32 s61, 400000
 s_cbranch_scc0 ka_end
 s_sleep 8
 s_branch ka_xv_87
ka_xo_88:
 s_barrier
ka_xs_89:
 s_mov_b32 s93, s95
 s_cmp_lg_u32 s3, 0
 s_cbranch_scc1 ka_b1_90
 s_load_dwordx2 s[20:21], s[0:1], 64
 s_load_dwordx2 s[24:25], s[0:1], 72
 v_and_b32 v1, 63, v0
 v_lshlrev_b32 v2, 4, v1
 v_and_b32 v3, 15, v1
 v_lshrrev_b32 v4, 4, v1
 s_mov_b32 s22, 921600
 s_mov_b32 s23, 0x20000
 s_mov_b32 s26, 921600
 s_mov_b32 s27, 0x20000
 s_mov_b32 s48, 0
 s_waitcnt lgkmcnt(0)
ka_mil_91:
 s_lshl_b32 s49, s48, 6
 s_add_u32 s49, s49, s95
 s_lshr_b32 s8, s49, 2
 s_and_b32 s9, s49, 3
 s_lshl_b32 s10, s9, 9
 s_add_u32 s10, s10, s8
 s_mul_i32 s10, s10, 450
 v_lshlrev_b32 v10, 1, v0
 v_mov_b32 v11, 0x40000000
 v_cmp_gt_u32 vcc, 225, v0
 s_nop 1
 v_cndmask_b32 v10, v11, v10, vcc

 s_lshr_b32 s11, s8, 4
 s_lshl_b32 s11, s11, 11
 s_and_b32 s12, s8, 15
 s_lshl_b32 s13, s9, 4
 s_add_u32 s12, s12, s13
 s_lshl_b32 s12, s12, 5
 s_add_u32 s11, s11, s12
 v_lshlrev_b32 v16, 13, v0
 v_add_u32 v16, s11, v16
 v_cndmask_b32 v16, v11, v16, vcc
 buffer_load_ushort v24, v10, s[20:23], s10 offen
 buffer_load_ushort v32, v10, s[24:27], s10 offen
 s_add_u32 s10, s10, 28800
 buffer_load_ushort v25, v10, s[20:23], s10 offen
 buffer_load_ushort v33, v10, s[24:27], s10 offen
 s_add_u32 s10, s10, 28800
 buffer_load_ushort v26, v10, s[20:23], s10 offen
 buffer_load_ushort v34, v10, s[24:27], s10 offen
 s_add_u32 s10, s10, 28800
 buffer_load_ushort v27, v10, s[20:23], s10 offen
 buffer_load_ushort v35, v10, s[24:27], s10 offen
 s_add_u32 s10, s10, 28800
 buffer_load_ushort v28, v10, s[20:23], s10 offen
 buffer_load_ushort v36, v10, s[24:27], s10 offen
 s_add_u32 s10, s10, 28800
 buffer_load_ushort v29, v10, s[20:23], s10 offen
 buffer_load_ushort v37, v10, s[24:27], s10 offen
 s_add_u32 s10, s10, 28800
 buffer_load_ushort v30, v10, s[20:23], s10 offen
 buffer_load_ushort v38, v10, s[24:27], s10 offen
 s_add_u32 s10, s10, 28800
 buffer_load_ushort v31, v10, s[20:23], s10 offen
 buffer_load_ushort v39, v10, s[24:27], s10 offen
 s_lshl_b32 s44, s49, 2
 s_add_u32 s44, s44, s6
 s_mov_b32 s51, s44
 s_cmp_ge_u32 s44, 784
 s_cbranch_scc1 ka_tabend_92
 s_cmp_ge_u32 s44, 392
 s_cselect_b32 s8, 392, 0
 s_sub_u32 s8, s44, s8
 s_mul_i32 s9, s8, 4682
 s_lshr_b32 s9, s9, 16
 s_mul_i32 s10, s9, 14
 s_sub_u32 s10, s8, s10
 s_lshl_b32 s10, s10, 5
 v_lshlrev_b32 v10, 3, v4
 v_add_u32 v10, s10, v10
 s_cmp_ge_u32 s44, 392
 s_cbranch_scc1 ka_tabg_93

 s_lshl_b32 s9, s9, 4
 v_add_u32 v11, s9, v3
 v_mov_b32 v40, v11
 v_add_u32 v48, 0, v10
 v_mov_b32 v41, v11
 v_add_u32 v49, 1, v10
 v_mov_b32 v42, v11
 v_add_u32 v50, 2, v10
 v_mov_b32 v43, v11
 v_add_u32 v51, 3, v10
 v_mov_b32 v44, v11
 v_add_u32 v52, 4, v10
 v_mov_b32 v45, v11
 v_add_u32 v53, 5, v10
 v_mov_b32 v46, v11
 v_add_u32 v54, 6, v10
 v_mov_b32 v47, v11
 v_add_u32 v55, 7, v10
 s_mov_b32 s45, 0
 s_branch ka_tabst_94
ka_tabg_93:

 s_lshr_b32 s10, s9, 1
 s_lshl_b32 s10, s10, 5
 s_and_b32 s9, s9, 1
 s_lshl_b32 s9, s9, 2
 s_add_u32 s9, s9, s10
 v_lshrrev_b32 v11, 2, v3
 v_lshlrev_b32 v11, 3, v11
 v_and_b32 v12, 3, v3
 v_add_u32 v11, v11, v12
 v_add_u32 v11, s9, v11
 v_mov_b32 v48, v11
 v_add_u32 v40, 0, v10
 v_mov_b32 v49, v11
 v_add_u32 v41, 1, v10
 v_mov_b32 v50, v11
 v_add_u32 v42, 2, v10
 v_mov_b32 v51, v11
 v_add_u32 v43, 3, v10
 v_mov_b32 v52, v11
 v_add_u32 v44, 4, v10
 v_mov_b32 v53, v11
 v_add_u32 v45, 5, v10
 v_mov_b32 v54, v11
 v_add_u32 v46, 6, v10
 v_mov_b32 v55, v11
 v_add_u32 v47, 7, v10
 s_mov_b32 s45, 1
ka_tabst_94:
 s_cmp_eq_u32 s45, 0
 s_cselect_b32 s8, 0x3f800000, 0x3b924925
 s_cselect_b32 s9, 0x3f800000, 0x3b124925
 s_mov_b32 s10, 0x3b124925
 s_mov_b32 s11, 0xc3e00000
 s_movk_i32 s12, 224
 v_cmp_lt_u32 vcc, s12, v40
 v_subrev_u32 v10, s12, v40
 s_nop 0
 v_cndmask_b32 v10, v40, v10, vcc
 v_mov_b32 v11, 0x3e800000
 v_cndmask_b32 v11, 0, v11, vcc
 v_mul_u32_u24 v12, v10, v48
 v_cvt_f32_u32 v12, v12
 v_mul_f32 v13, s10, v12
 v_floor_f32 v13, v13
 v_fma_f32 v12, v13, s11, v12
 v_fma_f32 v12, v12, s10, v11
 v_cos_f32 v56, v12
 v_cmp_eq_u32 vcc, 0, v40
 v_cmp_eq_u32 s[46:47], s12, v40
 s_or_b64 vcc, vcc, s[46:47]
 v_mov_b32 v14, s8
 v_mov_b32 v15, s9
 v_cndmask_b32 v14, v14, v15, vcc
 v_mul_f32 v56, v56, v14
 v_cmp_lt_u32 vcc, s12, v41
 v_subrev_u32 v10, s12, v41
 s_nop 0
 v_cndmask_b32 v10, v41, v10, vcc
 v_mov_b32 v11, 0x3e800000
 v_cndmask_b32 v11, 0, v11, vcc
 v_mul_u32_u24 v12, v10, v49
 v_cvt_f32_u32 v12, v12
 v_mul_f32 v13, s10, v12
 v_floor_f32 v13, v13
 v_fma_f32 v12, v13, s11, v12
 v_fma_f32 v12, v12, s10, v11
 v_cos_f32 v57, v12
 v_cmp_eq_u32 vcc, 0, v41
 v_cmp_eq_u32 s[46:47], s12, v41
 s_or_b64 vcc, vcc, s[46:47]
 v_mov_b32 v14, s8
 v_mov_b32 v15, s9
 v_cndmask_b32 v14, v14, v15, vcc
 v_mul_f32 v57, v57, v14
 v_cmp_lt_u32 vcc, s12, v42
 v_subrev_u32 v10, s12, v42
 s_nop 0
 v_cndmask_b32 v10, v42, v10, vcc
 v_mov_b32 v11, 0x3e800000
 v_cndmask_b32 v11, 0, v11, vcc
 v_mul_u32_u24 v12, v10, v50
 v_cvt_f32_u32 v12, v12
 v_mul_f32 v13, s10, v12
 v_floor_f32 v13, v13
 v_fma_f32 v12, v13, s11, v12
 v_fma_f32 v12, v12, s10, v11
 v_cos_f32 v58, v12
 v_cmp_eq_u32 vcc, 0, v42
 v_cmp_eq_u32 s[46:47], s12, v42
 s_or_b64 vcc, vcc, s[46:47]
 v_mov_b32 v14, s8
 v_mov_b32 v15, s9
 v_cndmask_b32 v14, v14, v15, vcc
 v_mul_f32 v58, v58, v14
 v_cmp_lt_u32 vcc, s12, v43
 v_subrev_u32 v10, s12, v43
 s_nop 0
 v_cndmask_b32 v10, v43, v10, vcc
 v_mov_b32 v11, 0x3e800000
 v_cndmask_b32 v11, 0, v11, vcc
 v_mul_u32_u24 v12, v10, v51
 v_cvt_f32_u32 v12, v12
 v_mul_f32 v13, s10, v12
 v_floor_f32 v13, v13
 v_fma_f32 v12, v13, s11, v12
 v_fma_f32 v12, v12, s10, v11
 v_cos_f32 v59, v12
 v_cmp_eq_u32 vcc, 0, v43
 v_cmp_eq_u32 s[46:47], s12, v43
 s_or_b64 vcc, vcc, s[46:47]
 v_mov_b32 v14, s8
 v_mov_b32 v15, s9
 v_cndmask_b32 v14, v14, v15, vcc
 v_mul_f32 v59, v59, v14
 v_cmp_lt_u32 vcc, s12, v44
 v_subrev_u32 v10, s12, v44
 s_nop 0
 v_cndmask_b32 v10, v44, v10, vcc
 v_mov_b32 v11, 0x3e800000
 v_cndmask_b32 v11, 0, v11, vcc
 v_mul_u32_u24 v12, v10, v52
 v_cvt_f32_u32 v12, v12
 v_mul_f32 v13, s10, v12
 v_floor_f32 v13, v13
 v_fma_f32 v12, v13, s11, v12
 v_fma_f32 v12, v12, s10, v11
 v_cos_f32 v60, v12
 v_cmp_eq_u32 vcc, 0, v44
 v_cmp_eq_u32 s[46:47], s12, v44
 s_or_b64 vcc, vcc, s[46:47]
 v_mov_b32 v14, s8
 v_mov_b32 v15, s9
 v_cndmask_b32 v14, v14, v15, vcc
 v_mul_f32 v60, v60, v14
 v_cmp_lt_u32 vcc, s12, v45
 v_subrev_u32 v10, s12, v45
 s_nop 0
 v_cndmask_b32 v10, v45, v10, vcc
 v_mov_b32 v11, 0x3e800000
 v_cndmask_b32 v11, 0, v11, vcc
 v_mul_u32_u24 v12, v10, v53
 v_cvt_f32_u32 v12, v12
 v_mul_f32 v13, s10, v12
 v_floor_f32 v13, v13
 v_fma_f32 v12, v13, s11, v12
 v_fma_f32 v12, v12, s10, v11
 v_cos_f32 v61, v12
 v_cmp_eq_u32 vcc, 0, v45
 v_cmp_eq_u32 s[46:47], s12, v45
 s_or_b64 vcc, vcc, s[46:47]
 v_mov_b32 v14, s8
 v_mov_b32 v15, s9
 v_cndmask_b32 v14, v14, v15, vcc
 v_mul_f32 v61, v61, v14
 v_cmp_lt_u32 vcc, s12, v46
 v_subrev_u32 v10, s12, v46
 s_nop 0
 v_cndmask_b32 v10, v46, v10, vcc
 v_mov_b32 v11, 0x3e800000
 v_cndmask_b32 v11, 0, v11, vcc
 v_mul_u32_u24 v12, v10, v54
 v_cvt_f32_u32 v12, v12
 v_mul_f32 v13, s10, v12
 v_floor_f32 v13, v13
 v_fma_f32 v12, v13, s11, v12
 v_fma_f32 v12, v12, s10, v11
 v_cos_f32 v62, v12
 v_cmp_eq_u32 vcc, 0, v46
 v_cmp_eq_u32 s[46:47], s12, v46
 s_or_b64 vcc, vcc, s[46:47]
 v_mov_b32 v14, s8
 v_mov_b32 v15, s9
 v_cndmask_b32 v14, v14, v15, vcc
 v_mul_f32 v62, v62, v14
 v_cmp_lt_u32 vcc, s12, v47
 v_subrev_u32 v10, s12, v47
 s_nop 0
 v_cndmask_b32 v10, v47, v10, vcc
 v_mov_b32 v11, 0x3e800000
 v_cndmask_b32 v11, 0, v11, vcc
 v_mul_u32_u24 v12, v10, v55
 v_cvt_f32_u32 v12, v12
 v_mul_f32 v13, s10, v12
 v_floor_f32 v13, v13
 v_fma_f32 v12, v13, s11, v12
 v_fma_f32 v12, v12, s10, v11
 v_cos_f32 v63, v12
 v_cmp_eq_u32 vcc, 0, v47
 v_cmp_eq_u32 s[46:47], s12, v47
 s_or_b64 vcc, vcc, s[46:47]
 v_mov_b32 v14, s8
 v_mov_b32 v15, s9
 v_cndmask_b32 v14, v14, v15, vcc
 v_mul_f32 v63, v63, v14
 v_cvt_pk_bf16_f32 v64, v56, v57
 v_cvt_pk_bf16_f32 v65, v58, v59
 v_cvt_pk_bf16_f32 v66, v60, v61
 v_cvt_pk_bf16_f32 v67, v62, v63
ka_tabend_92:
 s_add_u32 s28, s4, 12845056
 s_addc_u32 s29, s5, 0
 s_mov_b32 s30, 802816
 s_mov_b32 s31, 0x20000
 s_lshl_b32 s8, s51, 10
 buffer_store_dwordx4 v[64:67], v2, s[28:31], s8 offen sc1
 s_waitcnt vmcnt(1)
 v_lshlrev_b32 v24, 16, v24
 v_lshlrev_b32 v32, 16, v32
 v_mul_f32 v24, 0x3a000000, v24
 v_mul_f32 v32, 0x3a000000, v32
 v_cvt_pk_bf16_f32 v24, v24, v32
 v_lshlrev_b32 v25, 16, v25
 v_lshlrev_b32 v33, 16, v33
 v_mul_f32 v25, 0x3a000000, v25
 v_mul_f32 v33, 0x3a000000, v33
 v_cvt_pk_bf16_f32 v25, v25, v33
 v_lshlrev_b32 v26, 16, v26
 v_lshlrev_b32 v34, 16, v34
 v_mul_f32 v26, 0x3a000000, v26
 v_mul_f32 v34, 0x3a000000, v34
 v_cvt_pk_bf16_f32 v26, v26, v34
 v_lshlrev_b32 v27, 16, v27
 v_lshlrev_b32 v35, 16, v35
 v_mul_f32 v27, 0x3a000000, v27
 v_mul_f32 v35, 0x3a000000, v35
 v_cvt_pk_bf16_f32 v27, v27, v35
 v_lshlrev_b32 v28, 16, v28
 v_lshlrev_b32 v36, 16, v36
 v_mul_f32 v28, 0x3a000000, v28
 v_mul_f32 v36, 0x3a000000, v36
 v_cvt_pk_bf16_f32 v28, v28, v36
 v_lshlrev_b32 v29, 16, v29
 v_lshlrev_b32 v37, 16, v37
 v_mul_f32 v29, 0x3a000000, v29
 v_mul_f32 v37, 0x3a000000, v37
 v_cvt_pk_bf16_f32 v29, v29, v37
 v_lshlrev_b32 v30, 16, v30
 v_lshlrev_b32 v38, 16, v38
 v_mul_f32 v30, 0x3a000000, v30
 v_mul_f32 v38, 0x3a000000, v38
 v_cvt_pk_bf16_f32 v30, v30, v38
 v_lshlrev_b32 v31, 16, v31
 v_lshlrev_b32 v39, 16, v39
 v_mul_f32 v31, 0x3a000000, v31
 v_mul_f32 v39, 0x3a000000, v39
 v_cvt_pk_bf16_f32 v31, v31, v39
 s_add_u32 s28, s4, 19152896
 s_addc_u32 s29, s5, 0
 s_mov_b32 s30, 1843200
 s_mov_b32 s31, 0x20000
 buffer_store_dwordx4 v[24:27], v16, s[28:31], 0 offen sc1
 buffer_store_dwordx4 v[28:31], v16, s[28:31], 0 offen offset:16 sc1
 s_add_u32 s48, s48, 1
 s_cmp_lt_u32 s48, 4
 s_cbranch_scc1 ka_mil_91
 v_mov_b32 v64, -1
 v_mov_b32 v65, -1
 v_mov_b32 v66, -1
 v_mov_b32 v67, -1
 s_add_u32 s32, s4, 102050816
 s_addc_u32 s33, s5, 0
 s_mov_b32 s34, 458752
 s_mov_b32 s35, 0x20000
 s_mul_i32 s8, s95, 7168
 v_lshlrev_b32 v10, 4, v0
 v_add_u32 v10, s8, v10
 buffer_store_dwordx4 v[64:67], v10, s[32:35], 0 offen sc1
 v_add_u32 v10, 4096, v10
 v_mov_b32 v11, 0x40000000
 v_cmp_gt_u32 vcc, 192, v0
 s_nop 1
 v_cndmask_b32 v10, v11, v10, vcc
 buffer_store_dwordx4 v[64:67], v10, s[32:35], 0 offen sc1
 s_add_u32 s32, s4, 102517760
 s_addc_u32 s33, s5, 0
 s_mov_b32 s34, 458752
 s_mov_b32 s35, 0x20000
 s_mul_i32 s8, s95, 7168
 v_lshlrev_b32 v10, 4, v0
 v_add_u32 v10, s8, v10
 buffer_store_dwordx4 v[64:67], v10, s[32:35], 0 offen sc1
 v_add_u32 v10, 4096, v10
 v_mov_b32 v11, 0x40000000
 v_cmp_gt_u32 vcc, 192, v0
 s_nop 1
 v_cndmask_b32 v10, v11, v10, vcc
 buffer_store_dwordx4 v[64:67], v10, s[32:35], 0 offen sc1
 s_add_u32 s32, s4, 102977536
 s_addc_u32 s33, s5, 0
 s_mov_b32 s34, 786432
 s_mov_b32 s35, 0x20000
 s_mul_i32 s8, s95, 12288
 v_lshlrev_b32 v10, 4, v0
 v_add_u32 v10, s8, v10
 buffer_store_dwordx4 v[64:67], v10, s[32:35], 0 offen sc1
 v_add_u32 v10, 4096, v10
 buffer_store_dwordx4 v[64:67], v10, s[32:35], 0 offen sc1
 v_add_u32 v10, 4096, v10
 buffer_store_dwordx4 v[64:67], v10, s[32:35], 0 offen sc1
 s_add_u32 s32, s4, 23887872
 s_addc_u32 s33, s5, 0
 s_mov_b32 s34, 262144
 s_mov_b32 s35, 0x20000
 s_mul_i32 s8, s95, 4096
 v_lshlrev_b32 v10, 4, v0
 v_add_u32 v10, s8, v10
 buffer_store_dwordx4 v[64:67], v10, s[32:35], 0 offen sc1
 s_waitcnt vmcnt(0)
 s_nop 0
 v_mov_b32 v64, -1
 v_mov_b32 v65, -1
 v_mov_b32 v66, -1
 v_mov_b32 v67, -1
 s_add_u32 s32, s4, 13647872
 s_addc_u32 s33, s5, 0
 s_mov_b32 s34, 1835008
 s_mov_b32 s35, 0x20000
 s_mul_i32 s8, s95, 28672
 v_lshlrev_b32 v10, 4, v0
 v_add_u32 v10, s8, v10
 buffer_store_dwordx4 v[64:67], v10, s[32:35], 0 offen sc1
 v_add_u32 v10, 4096, v10
 buffer_store_dwordx4 v[64:67], v10, s[32:35], 0 offen sc1
 v_add_u32 v10, 4096, v10
 buffer_store_dwordx4 v[64:67], v10, s[32:35], 0 offen sc1
 v_add_u32 v10, 4096, v10
 buffer_store_dwordx4 v[64:67], v10, s[32:35], 0 offen sc1
 v_add_u32 v10, 4096, v10
 buffer_store_dwordx4 v[64:67], v10, s[32:35], 0 offen sc1
 v_add_u32 v10, 4096, v10
 buffer_store_dwordx4 v[64:67], v10, s[32:35], 0 offen sc1
 v_add_u32 v10, 4096, v10
 buffer_store_dwordx4 v[64:67], v10, s[32:35], 0 offen sc1
 s_add_u32 s32, s4, 67063808
 s_addc_u32 s33, s5, 0
 s_mov_b32 s34, 1835008
 s_mov_b32 s35, 0x20000
 s_mul_i32 s8, s95, 28672
 v_lshlrev_b32 v10, 4, v0
 v_add_u32 v10, s8, v10
 buffer_store_dwordx4 v[64:67], v10, s[32:35], 0 offen sc1
 v_add_u32 v10, 4096, v10
 buffer_store_dwordx4 v[64:67], v10, s[32:35], 0 offen sc1
 v_add_u32 v10, 4096, v10
 buffer_store_dwordx4 v[64:67], v10, s[32:35], 0 offen sc1
 v_add_u32 v10, 4096, v10
 buffer_store_dwordx4 v[64:67], v10, s[32:35], 0 offen sc1
 v_add_u32 v10, 4096, v10
 buffer_store_dwordx4 v[64:67], v10, s[32:35], 0 offen sc1
 v_add_u32 v10, 4096, v10
 buffer_store_dwordx4 v[64:67], v10, s[32:35], 0 offen sc1
 v_add_u32 v10, 4096, v10
 buffer_store_dwordx4 v[64:67], v10, s[32:35], 0 offen sc1
 s_add_u32 s32, s4, 68911104
 s_addc_u32 s33, s5, 0
 s_mov_b32 s34, 1835008
 s_mov_b32 s35, 0x20000
 s_mul_i32 s8, s95, 28672
 v_lshlrev_b32 v10, 4, v0
 v_add_u32 v10, s8, v10
 buffer_store_dwordx4 v[64:67], v10, s[32:35], 0 offen sc1
 v_add_u32 v10, 4096, v10
 buffer_store_dwordx4 v[64:67], v10, s[32:35], 0 offen sc1
 v_add_u32 v10, 4096, v10
 buffer_store_dwordx4 v[64:67], v10, s[32:35], 0 offen sc1
 v_add_u32 v10, 4096, v10
 buffer_store_dwordx4 v[64:67], v10, s[32:35], 0 offen sc1
 v_add_u32 v10, 4096, v10
 buffer_store_dwordx4 v[64:67], v10, s[32:35], 0 offen sc1
 v_add_u32 v10, 4096, v10
 buffer_store_dwordx4 v[64:67], v10, s[32:35], 0 offen sc1
 v_add_u32 v10, 4096, v10
 buffer_store_dwordx4 v[64:67], v10, s[32:35], 0 offen sc1
 s_add_u32 s32, s4, 66277376
 s_addc_u32 s33, s5, 0
 s_mov_b32 s34, 262144
 s_mov_b32 s35, 0x20000
 s_mul_i32 s8, s95, 4096
 v_lshlrev_b32 v10, 4, v0
 v_add_u32 v10, s8, v10
 buffer_store_dwordx4 v[64:67], v10, s[32:35], 0 offen sc1
 s_add_u32 s32, s4, 66998272
 s_addc_u32 s33, s5, 0
 s_mov_b32 s34, 65536
 s_mov_b32 s35, 0x20000
 s_mul_i32 s8, s95, 1024
 v_lshlrev_b32 v10, 4, v0
 v_add_u32 v10, s8, v10
 v_mov_b32 v11, 1073741824
 v_cmp_gt_u32 vcc, 64, v0
 s_nop 1
 v_cndmask_b32 v10, v11, v10, vcc
 buffer_store_dwordx4 v[64:67], v10, s[32:35], 0 offen sc1
 s_add_u32 s32, s4, 63524864
 s_addc_u32 s33, s5, 0
 s_mov_b32 s34, 917504
 s_mov_b32 s35, 0x20000
 s_mul_i32 s8, s95, 14336
 v_lshlrev_b32 v10, 4, v0
 v_add_u32 v10, s8, v10
 buffer_store_dwordx4 v[64:67], v10, s[32:35], 0 offen sc1
 v_add_u32 v10, 4096, v10
 buffer_store_dwordx4 v[64:67], v10, s[32:35], 0 offen sc1
 v_add_u32 v10, 4096, v10
 buffer_store_dwordx4 v[64:67], v10, s[32:35], 0 offen sc1
 v_add_u32 v10, 4096, v10
 v_mov_b32 v11, 1073741824
 v_cmp_gt_u32 vcc, 128, v0
 s_nop 1
 v_cndmask_b32 v10, v11, v10, vcc
 buffer_store_dwordx4 v[64:67], v10, s[32:35], 0 offen sc1
 s_nop 1
 v_mov_b32 v64, -1
 v_mov_b32 v65, -1
 v_mov_b32 v66, -1
 v_mov_b32 v67, -1
 s_add_u32 s32, s4, 17317888
 s_addc_u32 s33, s5, 0
 s_mov_b32 s34, 1835008
 s_mov_b32 s35, 0x20000
 s_mul_i32 s8, s95, 28672
 v_lshlrev_b32 v10, 4, v0
 v_add_u32 v10, s8, v10
 buffer_store_dwordx4 v[64:67], v10, s[32:35], 0 offen sc1
 v_add_u32 v10, 4096, v10
 buffer_store_dwordx4 v[64:67], v10, s[32:35], 0 offen sc1
 v_add_u32 v10, 4096, v10
 buffer_store_dwordx4 v[64:67], v10, s[32:35], 0 offen sc1
 v_add_u32 v10, 4096, v10
 buffer_store_dwordx4 v[64:67], v10, s[32:35], 0 offen sc1
 v_add_u32 v10, 4096, v10
 buffer_store_dwordx4 v[64:67], v10, s[32:35], 0 offen sc1
 v_add_u32 v10, 4096, v10
 buffer_store_dwordx4 v[64:67], v10, s[32:35], 0 offen sc1
 v_add_u32 v10, 4096, v10
 buffer_store_dwordx4 v[64:67], v10, s[32:35], 0 offen sc1
 s_add_u32 s32, s4, 113725440
 s_addc_u32 s33, s5, 0
 s_mov_b32 s34, 1835008
 s_mov_b32 s35, 0x20000
 s_mul_i32 s8, s95, 28672
 v_lshlrev_b32 v10, 4, v0
 v_add_u32 v10, s8, v10
 buffer_store_dwordx4 v[64:67], v10, s[32:35], 0 offen sc1
 v_add_u32 v10, 4096, v10
 buffer_store_dwordx4 v[64:67], v10, s[32:35], 0 offen sc1
 v_add_u32 v10, 4096, v10
 buffer_store_dwordx4 v[64:67], v10, s[32:35], 0 offen sc1
 v_add_u32 v10, 4096, v10
 buffer_store_dwordx4 v[64:67], v10, s[32:35], 0 offen sc1
 v_add_u32 v10, 4096, v10
 buffer_store_dwordx4 v[64:67], v10, s[32:35], 0 offen sc1
 v_add_u32 v10, 4096, v10
 buffer_store_dwordx4 v[64:67], v10, s[32:35], 0 offen sc1
 v_add_u32 v10, 4096, v10
 buffer_store_dwordx4 v[64:67], v10, s[32:35], 0 offen sc1
 s_add_u32 s32, s4, 115572736
 s_addc_u32 s33, s5, 0
 s_mov_b32 s34, 1835008
 s_mov_b32 s35, 0x20000
 s_mul_i32 s8, s95, 28672
 v_lshlrev_b32 v10, 4, v0
 v_add_u32 v10, s8, v10
 buffer_store_dwordx4 v[64:67], v10, s[32:35], 0 offen sc1
 v_add_u32 v10, 4096, v10
 buffer_store_dwordx4 v[64:67], v10, s[32:35], 0 offen sc1
 v_add_u32 v10, 4096, v10
 buffer_store_dwordx4 v[64:67], v10, s[32:35], 0 offen sc1
 v_add_u32 v10, 4096, v10
 buffer_store_dwordx4 v[64:67], v10, s[32:35], 0 offen sc1
 v_add_u32 v10, 4096, v10
 buffer_store_dwordx4 v[64:67], v10, s[32:35], 0 offen sc1
 v_add_u32 v10, 4096, v10
 buffer_store_dwordx4 v[64:67], v10, s[32:35], 0 offen sc1
 v_add_u32 v10, 4096, v10
 buffer_store_dwordx4 v[64:67], v10, s[32:35], 0 offen sc1
 s_add_u32 s32, s4, 70844416
 s_addc_u32 s33, s5, 0
 s_mov_b32 s34, 229376
 s_mov_b32 s35, 0x20000
 s_mul_i32 s8, s95, 3584
 v_lshlrev_b32 v10, 4, v0
 v_add_u32 v10, s8, v10
 v_mov_b32 v11, 1073741824
 v_cmp_gt_u32 vcc, 224, v0
 s_nop 1
 v_cndmask_b32 v10, v11, v10, vcc
 buffer_store_dwordx4 v[64:67], v10, s[32:35], 0 offen sc1
 s_add_u32 s32, s4, 72683520
 s_addc_u32 s33, s5, 0
 s_mov_b32 s34, 1835008
 s_mov_b32 s35, 0x20000
 s_mul_i32 s8, s95, 28672
 v_lshlrev_b32 v10, 4, v0
 v_add_u32 v10, s8, v10
 buffer_store_dwordx4 v[64:67], v10, s[32:35], 0 offen sc1
 v_add_u32 v10, 4096, v10
 buffer_store_dwordx4 v[64:67], v10, s[32:35], 0 offen sc1
 v_add_u32 v10, 4096, v10
 buffer_store_dwordx4 v[64:67], v10, s[32:35], 0 offen sc1
 v_add_u32 v10, 4096, v10
 buffer_store_dwordx4 v[64:67], v10, s[32:35], 0 offen sc1
 v_add_u32 v10, 4096, v10
 buffer_store_dwordx4 v[64:67], v10, s[32:35], 0 offen sc1
 v_add_u32 v10, 4096, v10
 buffer_store_dwordx4 v[64:67], v10, s[32:35], 0 offen sc1
 v_add_u32 v10, 4096, v10
 buffer_store_dwordx4 v[64:67], v10, s[32:35], 0 offen sc1
 v_add_u32 v10, 4096, v10
 s_add_u32 s32, s4, 112939008
 s_addc_u32 s33, s5, 0
 s_mov_b32 s34, 262144
 s_mov_b32 s35, 0x20000
 s_mul_i32 s8, s95, 4096
 v_lshlrev_b32 v10, 4, v0
 v_add_u32 v10, s8, v10
 buffer_store_dwordx4 v[64:67], v10, s[32:35], 0 offen sc1
 s_add_u32 s32, s4, 113659904
 s_addc_u32 s33, s5, 0
 s_mov_b32 s34, 65536
 s_mov_b32 s35, 0x20000
 s_mul_i32 s8, s95, 1024
 v_lshlrev_b32 v10, 4, v0
 v_add_u32 v10, s8, v10
 v_mov_b32 v11, 1073741824
 v_cmp_gt_u32 vcc, 64, v0
 s_nop 1
 v_cndmask_b32 v10, v11, v10, vcc
 buffer_store_dwordx4 v[64:67], v10, s[32:35], 0 offen sc1
 s_add_u32 s32, s4, 110186496
 s_addc_u32 s33, s5, 0
 s_mov_b32 s34, 917504
 s_mov_b32 s35, 0x20000
 s_mul_i32 s8, s95, 14336
 v_lshlrev_b32 v10, 4, v0
 v_add_u32 v10, s8, v10
 buffer_store_dwordx4 v[64:67], v10, s[32:35], 0 offen sc1
 v_add_u32 v10, 4096, v10
 buffer_store_dwordx4 v[64:67], v10, s[32:35], 0 offen sc1
 v_add_u32 v10, 4096, v10
 buffer_store_dwordx4 v[64:67], v10, s[32:35], 0 offen sc1
 v_add_u32 v10, 4096, v10
 v_mov_b32 v11, 1073741824
 v_cmp_gt_u32 vcc, 128, v0
 s_nop 1
 v_cndmask_b32 v10, v11, v10, vcc
 buffer_store_dwordx4 v[64:67], v10, s[32:35], 0 offen sc1
 s_add_u32 s52, s76, 70782976
 s_addc_u32 s53, s77, 0
 s_mov_b32 s54, 256
 s_mov_b32 s55, 0x20000
 s_lshl_b32 s8, s95, 2
 s_waitcnt vmcnt(0)
 s_barrier
 s_cmp_lg_u32 s6, 0
 s_cbranch_scc1 pf_95
 v_and_b32 v10, 63, v0
 v_lshlrev_b32 v10, 2, v10
 v_mov_b32 v11, 1
 s_mov_b64 exec, 1
 buffer_store_dword v11, v10, s[52:55], s8 offen sc1
 s_mov_b64 exec, -1
pf_95:
 s_add_u32 s52, s4, 117444608
 s_addc_u32 s53, s5, 0
 s_mov_b32 s54, 256
 s_mov_b32 s55, 0x20000
 s_cmp_lg_u32 s6, 0
 s_cbranch_scc1 pf2_96
 s_mov_b64 exec, 1
 buffer_store_dword v11, v10, s[52:55], s8 offen sc1
 s_mov_b64 exec, -1
pf2_96:
ka_b1_90:
 s_add_u32 s8, s4, 13647872
 s_addc_u32 s9, s5, 0
 s_add_u32 s16, s4, 17317888
 s_addc_u32 s17, s5, 0
 s_cmp_eq_u32 s3, 0
 s_cselect_b32 s16, s8, s16
 s_cselect_b32 s17, s9, s17
 s_mov_b32 s18, 1835008
 s_mov_b32 s19, 0x20000
 s_add_u32 s20, s4, 12845056
 s_addc_u32 s21, s5, 0
 s_mov_b32 s22, 401408
 s_mov_b32 s23, 0x20000
 s_add_u32 s24, s76, 67063808
 s_addc_u32 s25, s77, 0
 s_mov_b32 s26, 1835008
 s_mov_b32 s27, 0x20000
 s_add_u32 s52, s76, 70758400
 s_addc_u32 s53, s77, 0
 s_mov_b32 s54, 32768
 s_mov_b32 s55, 0x20000
 s_lshr_b32 s28, s95, 2
 s_and_b32 s29, s95, 3
 s_mov_b32 s30, 4
 v_and_b32 v1, 63, v0
 v_lshlrev_b32 v2, 4, v1
 s_add_u32 s56, s76, 70782976
 s_addc_u32 s57, s77, 0
 s_mov_b32 s58, 256
 s_mov_b32 s59, 0x20000
 v_and_b32 v10, 63, v0
 v_lshlrev_b32 v10, 2, v10
 s_cmp_lg_u32 s6, 0
 s_cbranch_scc1 ka_wk_98
 s_mov_b32 s50, 0
ka_wl_97:
 buffer_load_dword v11, v10, s[56:59], 0 offen sc0 sc1
 s_waitcnt vmcnt(0)
 v_cmp_eq_u32 vcc, 0, v11
 s_cbranch_vccz ka_wk_98
 s_add_u32 s50, s50, 1
 s_cmp_lt_u32 s50, 400000
 s_cbranch_scc0 ka_end
 s_mov_b64 exec, vcc
 s_sleep 4
 s_branch ka_wl_97
ka_wk_98:
 s_mov_b64 exec, -1
 s_barrier
 s_add_u32 s56, s4, 13246464
 s_addc_u32 s57, s5, 0
 s_mov_b32 s58, 401408
 s_mov_b32 s59, 0x20000
 s_cmp_eq_u32 s3, 0
 s_cselect_b32 s91, s93, s94
 s_cmp_eq_u32 s91, -1
 s_cbranch_scc1 b3t_skip_99
 s_lshr_b32 s43, s91, 2
 s_and_b32 s44, s91, 3
 v_and_b32 v1, 63, v0
 v_lshlrev_b32 v2, 4, v1
 v_and_b32 v7, 15, v1
 v_lshrrev_b32 v8, 4, v1
 s_mul_i32 s40, s44, 7
 s_add_u32 s40, s40, 1
 s_lshr_b32 s40, s40, 1
 s_add_u32 s40, s40, s6
 s_lshr_b32 s41, s44, 1
 s_mul_i32 s41, s41, 7
 s_add_u32 s41, s41, 3
 s_and_b32 s42, s44, 1
 s_cmp_eq_u32 s6, 3
 s_cselect_b32 s45, s41, s40
 s_cselect_b32 s42, s42, 0
 s_cselect_b64 vcc, -1, 0
 s_mul_i32 s8, s45, 28672
 v_add_u32 v9, s8, v2
 v_add_u32 v10, 14336, v9

 v_bfe_u32 v11, v7, 2, 1
 v_mul_u32_u24 v11, 14336, v11
 v_lshrrev_b32 v12, 3, v7
 s_lshl_b32 s9, s42, 1
 v_add_u32 v12, s9, v12
 v_lshlrev_b32 v12, 2, v12
 v_and_b32 v13, 3, v7
 v_add_u32 v12, v12, v13
 v_lshl_add_u32 v12, v8, 4, v12
 v_lshl_add_u32 v11, v12, 4, v11
 v_add_u32 v11, s8, v11
 v_cndmask_b32 v9, v9, v11, vcc
 v_mov_b32 v11, 1073741824
 v_cndmask_b32 v10, v10, v11, vcc
 s_mov_b32 s12, 0
 buffer_load_dwordx4 a[112:115], v9, s[56:59], s12 offen offset:0 sc1
 buffer_load_dwordx4 a[116:119], v10, s[56:59], s12 offen offset:0 sc1
 buffer_load_dwordx4 a[120:123], v9, s[56:59], s12 offen offset:1024 sc1
 buffer_load_dwordx4 a[124:127], v10, s[56:59], s12 offen offset:1024 sc1
 buffer_load_dwordx4 a[128:131], v9, s[56:59], s12 offen offset:2048 sc1
 buffer_load_dwordx4 a[132:135], v10, s[56:59], s12 offen offset:2048 sc1
 buffer_load_dwordx4 a[136:139], v9, s[56:59], s12 offen offset:3072 sc1
 buffer_load_dwordx4 a[140:143], v10, s[56:59], s12 offen offset:3072 sc1
 s_mov_b32 s12, 4096
 buffer_load_dwordx4 a[144:147], v9, s[56:59], s12 offen offset:0 sc1
 buffer_load_dwordx4 a[148:151], v10, s[56:59], s12 offen offset:0 sc1
 buffer_load_dwordx4 a[152:155], v9, s[56:59], s12 offen offset:1024 sc1
 buffer_load_dwordx4 a[156:159], v10, s[56:59], s12 offen offset:1024 sc1
 buffer_load_dwordx4 a[160:163], v9, s[56:59], s12 offen offset:2048 sc1
 buffer_load_dwordx4 a[164:167], v10, s[56:59], s12 offen offset:2048 sc1
 buffer_load_dwordx4 a[168:171], v9, s[56:59], s12 offen offset:3072 sc1
 buffer_load_dwordx4 a[172:175], v10, s[56:59], s12 offen offset:3072 sc1
 s_mov_b32 s12, 8192
 buffer_load_dwordx4 a[176:179], v9, s[56:59], s12 offen offset:0 sc1
 buffer_load_dwordx4 a[180:183], v10, s[56:59], s12 offen offset:0 sc1
 buffer_load_dwordx4 a[184:187], v9, s[56:59], s12 offen offset:1024 sc1
 buffer_load_dwordx4 a[188:191], v10, s[56:59], s12 offen offset:1024 sc1
 buffer_load_dwordx4 a[192:195], v9, s[56:59], s12 offen offset:2048 sc1
 buffer_load_dwordx4 a[196:199], v10, s[56:59], s12 offen offset:2048 sc1
 buffer_load_dwordx4 a[200:203], v9, s[56:59], s12 offen offset:3072 sc1
 buffer_load_dwordx4 a[204:207], v10, s[56:59], s12 offen offset:3072 sc1
 s_mov_b32 s12, 12288
 buffer_load_dwordx4 a[208:211], v9, s[56:59], s12 offen offset:0 sc1
 buffer_load_dwordx4 a[212:215], v10, s[56:59], s12 offen offset:0 sc1
 buffer_load_dwordx4 a[216:219], v9, s[56:59], s12 offen offset:1024 sc1
 buffer_load_dwordx4 a[220:223], v10, s[56:59], s12 offen offset:1024 sc1
b3t_skip_99:
 v_and_b32 v232, 15, v0
 v_bfe_u32 v233, v0, 4, 2
 s_lshl_b32 s8, s6, 4
 v_add_u32 v234, s8, v232
 v_lshlrev_b32 v236, 3, v233
 v_mul_u32_u24 v236, v236, v234
 v_and_b32 v240, 63, v236
 v_add_u32 v236, v236, v234
 v_cvt_f32_u32 v240, v240
 v_mul_f32 v240, 0x3c800000, v240
 v_cos_f32 v242, v240
 v_sin_f32 v244, v240
 v_and_b32 v241, 63, v236
 v_add_u32 v236, v236, v234
 v_cvt_f32_u32 v241, v241
 v_mul_f32 v241, 0x3c800000, v241
 v_cos_f32 v243, v241
 v_sin_f32 v245, v241
 s_nop 0
 v_cvt_pk_bf16_f32 v168, v242, v243
 v_cvt_pk_bf16_f32 v176, -v244, -v245
 v_cvt_pk_bf16_f32 v184, v244, v245
 v_and_b32 v240, 63, v236
 v_add_u32 v236, v236, v234
 v_cvt_f32_u32 v240, v240
 v_mul_f32 v240, 0x3c800000, v240
 v_cos_f32 v242, v240
 v_sin_f32 v244, v240
 v_and_b32 v241, 63, v236
 v_add_u32 v236, v236, v234
 v_cvt_f32_u32 v241, v241
 v_mul_f32 v241, 0x3c800000, v241
 v_cos_f32 v243, v241
 v_sin_f32 v245, v241
 s_nop 0
 v_cvt_pk_bf16_f32 v169, v242, v243
 v_cvt_pk_bf16_f32 v177, -v244, -v245
 v_cvt_pk_bf16_f32 v185, v244, v245
 v_and_b32 v240, 63, v236
 v_add_u32 v236, v236, v234
 v_cvt_f32_u32 v240, v240
 v_mul_f32 v240, 0x3c800000, v240
 v_cos_f32 v242, v240
 v_sin_f32 v244, v240
 v_and_b32 v241, 63, v236
 v_add_u32 v236, v236, v234
 v_cvt_f32_u32 v241, v241
 v_mul_f32 v241, 0x3c800000, v241
 v_cos_f32 v243, v241
 v_sin_f32 v245, v241
 s_nop 0
 v_cvt_pk_bf16_f32 v170, v242, v243
 v_cvt_pk_bf16_f32 v178, -v244, -v245
 v_cvt_pk_bf16_f32 v186, v244, v245
 v_and_b32 v240, 63, v236
 v_add_u32 v236, v236, v234
 v_cvt_f32_u32 v240, v240
 v_mul_f32 v240, 0x3c800000, v240
 v_cos_f32 v242, v240
 v_sin_f32 v244, v240
 v_and_b32 v241, 63, v236
 v_add_u32 v236, v236, v234
 v_cvt_f32_u32 v241, v241
 v_mul_f32 v241, 0x3c800000, v241
 v_cos_f32 v243, v241
 v_sin_f32 v245, v241
 s_nop 0
 v_cvt_pk_bf16_f32 v171, v242, v243
 v_cvt_pk_bf16_f32 v179, -v244, -v245
 v_cvt_pk_bf16_f32 v187, v244, v245
 v_mul_u32_u24 v237, 24, v234
 v_add_u32 v236, v236, v237
 v_and_b32 v240, 63, v236
 v_add_u32 v236, v236, v234
 v_cvt_f32_u32 v240, v240
 v_mul_f32 v240, 0x3c800000, v240
 v_cos_f32 v242, v240
 v_sin_f32 v244, v240
 v_and_b32 v241, 63, v236
 v_add_u32 v236, v236, v234
 v_cvt_f32_u32 v241, v241
 v_mul_f32 v241, 0x3c800000, v241
 v_cos_f32 v243, v241
 v_sin_f32 v245, v241
 s_nop 0
 v_cvt_pk_bf16_f32 v172, v242, v243
 v_cvt_pk_bf16_f32 v180, -v244, -v245
 v_cvt_pk_bf16_f32 v188, v244, v245
 v_and_b32 v240, 63, v236
 v_add_u32 v236, v236, v234
 v_cvt_f32_u32 v240, v240
 v_mul_f32 v240, 0x3c800000, v240
 v_cos_f32 v242, v240
 v_sin_f32 v244, v240
 v_and_b32 v241, 63, v236
 v_add_u32 v236, v236, v234
 v_cvt_f32_u32 v241, v241
 v_mul_f32 v241, 0x3c800000, v241
 v_cos_f32 v243, v241
 v_sin_f32 v245, v241
 s_nop 0
 v_cvt_pk_bf16_f32 v173, v242, v243
 v_cvt_pk_bf16_f32 v181, -v244, -v245
 v_cvt_pk_bf16_f32 v189, v244, v245
 v_and_b32 v240, 63, v236
 v_add_u32 v236, v236, v234
 v_cvt_f32_u32 v240, v240
 v_mul_f32 v240, 0x3c800000, v240
 v_cos_f32 v242, v240
 v_sin_f32 v244, v240
 v_and_b32 v241, 63, v236
 v_add_u32 v236, v236, v234
 v_cvt_f32_u32 v241, v241
 v_mul_f32 v241, 0x3c800000, v241
 v_cos_f32 v243, v241
 v_sin_f32 v245, v241
 s_nop 0
 v_cvt_pk_bf16_f32 v174, v242, v243
 v_cvt_pk_bf16_f32 v182, -v244, -v245
 v_cvt_pk_bf16_f32 v190, v244, v245
 v_and_b32 v240, 63, v236
 v_add_u32 v236, v236, v234
 v_cvt_f32_u32 v240, v240
 v_mul_f32 v240, 0x3c800000, v240
 v_cos_f32 v242, v240
 v_sin_f32 v244, v240
 v_and_b32 v241, 63, v236
 v_add_u32 v236, v236, v234
 v_cvt_f32_u32 v241, v241
 v_mul_f32 v241, 0x3c800000, v241
 v_cos_f32 v243, v241
 v_sin_f32 v245, v241
 s_nop 0
 v_cvt_pk_bf16_f32 v175, v242, v243
 v_cvt_pk_bf16_f32 v183, -v244, -v245
 v_cvt_pk_bf16_f32 v191, v244, v245
 v_lshrrev_b32 v237, 2, v232
 v_lshlrev_b32 v237, 3, v237
 v_and_b32 v236, 3, v232
 v_add_u32 v237, v237, v236
 v_add_u32 v237, 0, v237
 v_lshlrev_b32 v236, 3, v233
 v_mul_u32_u24 v236, v236, v237
 v_and_b32 v240, 31, v236
 v_add_u32 v236, v236, v237
 v_cvt_f32_u32 v240, v240
 v_mul_f32 v240, 0x3d000000, v240
 v_cos_f32 v242, v240
 v_sin_f32 v244, v240
 v_and_b32 v241, 31, v236
 v_add_u32 v236, v236, v237
 v_cvt_f32_u32 v241, v241
 v_mul_f32 v241, 0x3d000000, v241
 v_cos_f32 v243, v241
 v_sin_f32 v245, v241
 s_nop 0
 v_cvt_pk_bf16_f32 v192, v242, v243
 v_cvt_pk_bf16_f32 v200, -v244, -v245
 v_cvt_pk_bf16_f32 v208, v244, v245
 v_and_b32 v240, 31, v236
 v_add_u32 v236, v236, v237
 v_cvt_f32_u32 v240, v240
 v_mul_f32 v240, 0x3d000000, v240
 v_cos_f32 v242, v240
 v_sin_f32 v244, v240
 v_and_b32 v241, 31, v236
 v_add_u32 v236, v236, v237
 v_cvt_f32_u32 v241, v241
 v_mul_f32 v241, 0x3d000000, v241
 v_cos_f32 v243, v241
 v_sin_f32 v245, v241
 s_nop 0
 v_cvt_pk_bf16_f32 v193, v242, v243
 v_cvt_pk_bf16_f32 v201, -v244, -v245
 v_cvt_pk_bf16_f32 v209, v244, v245
 v_and_b32 v240, 31, v236
 v_add_u32 v236, v236, v237
 v_cvt_f32_u32 v240, v240
 v_mul_f32 v240, 0x3d000000, v240
 v_cos_f32 v242, v240
 v_sin_f32 v244, v240
 v_and_b32 v241, 31, v236
 v_add_u32 v236, v236, v237
 v_cvt_f32_u32 v241, v241
 v_mul_f32 v241, 0x3d000000, v241
 v_cos_f32 v243, v241
 v_sin_f32 v245, v241
 s_nop 0
 v_cvt_pk_bf16_f32 v194, v242, v243
 v_cvt_pk_bf16_f32 v202, -v244, -v245
 v_cvt_pk_bf16_f32 v210, v244, v245
 v_and_b32 v240, 31, v236
 v_add_u32 v236, v236, v237
 v_cvt_f32_u32 v240, v240
 v_mul_f32 v240, 0x3d000000, v240
 v_cos_f32 v242, v240
 v_sin_f32 v244, v240
 v_and_b32 v241, 31, v236
 v_add_u32 v236, v236, v237
 v_cvt_f32_u32 v241, v241
 v_mul_f32 v241, 0x3d000000, v241
 v_cos_f32 v243, v241
 v_sin_f32 v245, v241
 s_nop 0
 v_cvt_pk_bf16_f32 v195, v242, v243
 v_cvt_pk_bf16_f32 v203, -v244, -v245
 v_cvt_pk_bf16_f32 v211, v244, v245
 v_lshrrev_b32 v237, 2, v232
 v_lshlrev_b32 v237, 3, v237
 v_and_b32 v236, 3, v232
 v_add_u32 v237, v237, v236
 v_add_u32 v237, 4, v237
 v_lshlrev_b32 v236, 3, v233
 v_mul_u32_u24 v236, v236, v237
 v_and_b32 v240, 31, v236
 v_add_u32 v236, v236, v237
 v_cvt_f32_u32 v240, v240
 v_mul_f32 v240, 0x3d000000, v240
 v_cos_f32 v242, v240
 v_sin_f32 v244, v240
 v_and_b32 v241, 31, v236
 v_add_u32 v236, v236, v237
 v_cvt_f32_u32 v241, v241
 v_mul_f32 v241, 0x3d000000, v241
 v_cos_f32 v243, v241
 v_sin_f32 v245, v241
 s_nop 0
 v_cvt_pk_bf16_f32 v196, v242, v243
 v_cvt_pk_bf16_f32 v204, -v244, -v245
 v_cvt_pk_bf16_f32 v212, v244, v245
 v_and_b32 v240, 31, v236
 v_add_u32 v236, v236, v237
 v_cvt_f32_u32 v240, v240
 v_mul_f32 v240, 0x3d000000, v240
 v_cos_f32 v242, v240
 v_sin_f32 v244, v240
 v_and_b32 v241, 31, v236
 v_add_u32 v236, v236, v237
 v_cvt_f32_u32 v241, v241
 v_mul_f32 v241, 0x3d000000, v241
 v_cos_f32 v243, v241
 v_sin_f32 v245, v241
 s_nop 0
 v_cvt_pk_bf16_f32 v197, v242, v243
 v_cvt_pk_bf16_f32 v205, -v244, -v245
 v_cvt_pk_bf16_f32 v213, v244, v245
 v_and_b32 v240, 31, v236
 v_add_u32 v236, v236, v237
 v_cvt_f32_u32 v240, v240
 v_mul_f32 v240, 0x3d000000, v240
 v_cos_f32 v242, v240
 v_sin_f32 v244, v240
 v_and_b32 v241, 31, v236
 v_add_u32 v236, v236, v237
 v_cvt_f32_u32 v241, v241
 v_mul_f32 v241, 0x3d000000, v241
 v_cos_f32 v243, v241
 v_sin_f32 v245, v241
 s_nop 0
 v_cvt_pk_bf16_f32 v198, v242, v243
 v_cvt_pk_bf16_f32 v206, -v244, -v245
 v_cvt_pk_bf16_f32 v214, v244, v245
 v_and_b32 v240, 31, v236
 v_add_u32 v236, v236, v237
 v_cvt_f32_u32 v240, v240
 v_mul_f32 v240, 0x3d000000, v240
 v_cos_f32 v242, v240
 v_sin_f32 v244, v240
 v_and_b32 v241, 31, v236
 v_add_u32 v236, v236, v237
 v_cvt_f32_u32 v241, v241
 v_mul_f32 v241, 0x3d000000, v241
 v_cos_f32 v243, v241
 v_sin_f32 v245, v241
 s_nop 0
 v_cvt_pk_bf16_f32 v199, v242, v243
 v_cvt_pk_bf16_f32 v207, -v244, -v245
 v_cvt_pk_bf16_f32 v215, v244, v245
 v_lshlrev_b32 v236, 3, v233
 v_mul_u32_u24 v236, v236, v234
 v_cvt_f32_u32 v240, v236
 v_add_u32 v236, v236, v234
 v_mul_f32 v240, 0x3a000000, v240
 v_cos_f32 v216, v240
 v_sin_f32 v224, v240
 v_cvt_f32_u32 v240, v236
 v_add_u32 v236, v236, v234
 v_mul_f32 v240, 0x3a000000, v240
 v_cos_f32 v217, v240
 v_sin_f32 v225, v240
 v_cvt_f32_u32 v240, v236
 v_add_u32 v236, v236, v234
 v_mul_f32 v240, 0x3a000000, v240
 v_cos_f32 v218, v240
 v_sin_f32 v226, v240
 v_cvt_f32_u32 v240, v236
 v_add_u32 v236, v236, v234
 v_mul_f32 v240, 0x3a000000, v240
 v_cos_f32 v219, v240
 v_sin_f32 v227, v240
 v_cvt_f32_u32 v240, v236
 v_add_u32 v236, v236, v234
 v_mul_f32 v240, 0x3a000000, v240
 v_cos_f32 v220, v240
 v_sin_f32 v228, v240
 v_cvt_f32_u32 v240, v236
 v_add_u32 v236, v236, v234
 v_mul_f32 v240, 0x3a000000, v240
 v_cos_f32 v221, v240
 v_sin_f32 v229, v240
 v_cvt_f32_u32 v240, v236
 v_add_u32 v236, v236, v234
 v_mul_f32 v240, 0x3a000000, v240
 v_cos_f32 v222, v240
 v_sin_f32 v230, v240
 v_cvt_f32_u32 v240, v236
 v_add_u32 v236, v236, v234
 v_mul_f32 v240, 0x3a000000, v240
 v_cos_f32 v223, v240
 v_sin_f32 v231, v240
 v_and_b32 v1, 63, v0
 v_lshlrev_b32 v2, 4, v1

 s_mul_i32 s8, s29, 7
 s_lshl_b32 s9, s6, 1
 s_add_u32 s8, s8, s9
 s_mul_i32 s9, s8, 14336
 v_add_u32 v7, s9, v2
 v_add_u32 v8, 14336, v7
 s_mov_b32 s10, 0
 buffer_load_dwordx4 a[0:3], v7, s[20:23], s10 offen offset:0 sc1
 buffer_load_dwordx4 a[4:7], v8, s[20:23], s10 offen offset:0 sc1
 buffer_load_dwordx4 a[8:11], v7, s[20:23], s10 offen offset:1024 sc1
 buffer_load_dwordx4 a[12:15], v8, s[20:23], s10 offen offset:1024 sc1
 buffer_load_dwordx4 a[16:19], v7, s[20:23], s10 offen offset:2048 sc1
 buffer_load_dwordx4 a[20:23], v8, s[20:23], s10 offen offset:2048 sc1
 buffer_load_dwordx4 a[24:27], v7, s[20:23], s10 offen offset:3072 sc1
 buffer_load_dwordx4 a[28:31], v8, s[20:23], s10 offen offset:3072 sc1
 s_mov_b32 s10, 4096
 buffer_load_dwordx4 a[32:35], v7, s[20:23], s10 offen offset:0 sc1
 buffer_load_dwordx4 a[36:39], v8, s[20:23], s10 offen offset:0 sc1
 buffer_load_dwordx4 a[40:43], v7, s[20:23], s10 offen offset:1024 sc1
 buffer_load_dwordx4 a[44:47], v8, s[20:23], s10 offen offset:1024 sc1
 buffer_load_dwordx4 a[48:51], v7, s[20:23], s10 offen offset:2048 sc1
 buffer_load_dwordx4 a[52:55], v8, s[20:23], s10 offen offset:2048 sc1
 buffer_load_dwordx4 a[56:59], v7, s[20:23], s10 offen offset:3072 sc1
 buffer_load_dwordx4 a[60:63], v8, s[20:23], s10 offen offset:3072 sc1
 s_mov_b32 s10, 8192
 buffer_load_dwordx4 a[64:67], v7, s[20:23], s10 offen offset:0 sc1
 buffer_load_dwordx4 a[68:71], v8, s[20:23], s10 offen offset:0 sc1
 buffer_load_dwordx4 a[72:75], v7, s[20:23], s10 offen offset:1024 sc1
 buffer_load_dwordx4 a[76:79], v8, s[20:23], s10 offen offset:1024 sc1
 buffer_load_dwordx4 a[80:83], v7, s[20:23], s10 offen offset:2048 sc1
 buffer_load_dwordx4 a[84:87], v8, s[20:23], s10 offen offset:2048 sc1
 buffer_load_dwordx4 a[88:91], v7, s[20:23], s10 offen offset:3072 sc1
 buffer_load_dwordx4 a[92:95], v8, s[20:23], s10 offen offset:3072 sc1
 s_mov_b32 s10, 12288
 buffer_load_dwordx4 a[96:99], v7, s[20:23], s10 offen offset:0 sc1
 buffer_load_dwordx4 a[100:103], v8, s[20:23], s10 offen offset:0 sc1
 buffer_load_dwordx4 a[104:107], v7, s[20:23], s10 offen offset:1024 sc1
 buffer_load_dwordx4 a[108:111], v8, s[20:23], s10 offen offset:1024 sc1

 v_and_b32 v10, 15, v1
 v_lshlrev_b32 v10, 6, v10
 v_lshrrev_b32 v11, 4, v1
 v_lshl_add_u32 v10, v11, 4, v10
 s_lshl_b32 s8, s8, 10
 v_add_u32 v7, s8, v10
 v_add_u32 v8, 1024, v7
 v_mov_b32 v10, 1073741824
 s_cmp_eq_u32 s6, 3
 s_cselect_b64 vcc, -1, 0
 v_cndmask_b32 v8, v8, v10, vcc
 v_and_b32 v10, 15, v1
 v_lshrrev_b32 v11, 4, v1
 v_xor_b32 v10, v10, v11
 v_lshlrev_b32 v12, 4, v10
 v_lshl_add_u32 v5, v11, 8, v12
 v_xor_b32 v6, 64, v5
ka_b1_loop:
 s_lshl_b32 s31, s28, 8
 s_add_u32 s31, s31, 4096
 v_lshlrev_b32 v3, 2, v1
 s_cmp_lg_u32 s6, 0
 s_cbranch_scc1 ka_wk_101
 s_mov_b32 s50, 0
ka_wl_100:
 buffer_load_dword v100, v3, s[52:55], s31 offen sc1
 s_waitcnt vmcnt(0)
 v_cmp_eq_u32 vcc, 0, v100
 s_cbranch_vccz ka_wk_101
 s_add_u32 s50, s50, 1
 s_cmp_lt_u32 s50, 400000
 s_cbranch_scc0 ka_end
 s_mov_b64 exec, vcc
 s_sleep 4
 s_branch ka_wl_100
ka_wk_101:
 s_mov_b64 exec, -1
 s_barrier
 s_lshl_b32 s8, s28, 5
 s_lshl_b32 s9, s6, 3
 s_add_u32 s8, s8, s9
 v_lshrrev_b32 v3, 3, v1
 v_add_u32 v3, s8, v3
 v_mul_u32_u24 v3, 896, v3
 v_and_b32 v4, 7, v1
 v_lshl_add_u32 v3, v4, 4, v3
 s_mul_i32 s31, s28, 28672
 s_mov_b32 s50, 0
ka_dl_102:
 buffer_load_dwordx4 v[16:19], v3, s[16:19], 0 offen offset:0 sc1
 buffer_load_dwordx4 v[20:23], v3, s[16:19], 0 offen offset:128 sc1
 buffer_load_dwordx4 v[24:27], v3, s[16:19], 0 offen offset:256 sc1
 buffer_load_dwordx4 v[28:31], v3, s[16:19], 0 offen offset:384 sc1
 buffer_load_dwordx4 v[32:35], v3, s[16:19], 0 offen offset:512 sc1
 buffer_load_dwordx4 v[36:39], v3, s[16:19], 0 offen offset:640 sc1
 buffer_load_dwordx4 v[40:43], v3, s[16:19], 0 offen offset:768 sc1
 s_waitcnt vmcnt(0)
 v_max3_u32 v44, v16, v18, v20
 v_max3_u32 v45, v22, v24, v26
 v_max3_u32 v46, v28, v30, v32
 v_max3_u32 v47, v34, v36, v38
 v_max3_u32 v48, v44, v45, v46
 v_max3_u32 v49, v47, v40, v42
 v_max_u32 v50, v48, v49
 v_cmp_eq_u32 vcc, -1, v50
 s_cbranch_vccz ka_dk_103
 s_add_u32 s50, s50, 1
 s_cmp_lt_u32 s50, 400000
 s_cbranch_scc0 ka_end
 s_mov_b64 exec, vcc
 s_sleep 2
 s_branch ka_dl_102
ka_dk_103:
 s_mov_b64 exec, -1
 v_lshlrev_b32 v44, 16, v16
 v_and_b32 v45, 0xffff0000, v16
 v_lshlrev_b32 v46, 16, v17
 v_and_b32 v47, 0xffff0000, v17
 v_lshlrev_b32 v48, 16, v18
 v_and_b32 v49, 0xffff0000, v18
 v_lshlrev_b32 v50, 16, v19
 v_and_b32 v51, 0xffff0000, v19
 v_lshlrev_b32 v52, 16, v20
 v_and_b32 v53, 0xffff0000, v20
 v_lshlrev_b32 v54, 16, v21
 v_and_b32 v55, 0xffff0000, v21
 v_lshlrev_b32 v56, 16, v22
 v_and_b32 v57, 0xffff0000, v22
 v_lshlrev_b32 v58, 16, v23
 v_and_b32 v59, 0xffff0000, v23
 v_lshlrev_b32 v60, 16, v24
 v_and_b32 v61, 0xffff0000, v24
 v_lshlrev_b32 v62, 16, v25
 v_and_b32 v63, 0xffff0000, v25
 v_lshlrev_b32 v64, 16, v26
 v_and_b32 v65, 0xffff0000, v26
 v_lshlrev_b32 v66, 16, v27
 v_and_b32 v67, 0xffff0000, v27
 v_lshlrev_b32 v68, 16, v28
 v_and_b32 v69, 0xffff0000, v28
 v_lshlrev_b32 v70, 16, v29
 v_and_b32 v71, 0xffff0000, v29
 v_lshlrev_b32 v72, 16, v30
 v_and_b32 v73, 0xffff0000, v30
 v_lshlrev_b32 v74, 16, v31
 v_and_b32 v75, 0xffff0000, v31
 v_lshlrev_b32 v76, 16, v32
 v_and_b32 v77, 0xffff0000, v32
 v_lshlrev_b32 v78, 16, v33
 v_and_b32 v79, 0xffff0000, v33
 v_lshlrev_b32 v80, 16, v34
 v_and_b32 v81, 0xffff0000, v34
 v_lshlrev_b32 v82, 16, v35
 v_and_b32 v83, 0xffff0000, v35
 v_lshlrev_b32 v84, 16, v36
 v_and_b32 v85, 0xffff0000, v36
 v_lshlrev_b32 v86, 16, v37
 v_and_b32 v87, 0xffff0000, v37
 v_lshlrev_b32 v88, 16, v38
 v_and_b32 v89, 0xffff0000, v38
 v_lshlrev_b32 v90, 16, v39
 v_and_b32 v91, 0xffff0000, v39
 v_lshlrev_b32 v92, 16, v40
 v_and_b32 v93, 0xffff0000, v40
 v_lshlrev_b32 v94, 16, v41
 v_and_b32 v95, 0xffff0000, v41
 v_lshlrev_b32 v96, 16, v42
 v_and_b32 v97, 0xffff0000, v42
 v_lshlrev_b32 v98, 16, v43
 v_and_b32 v99, 0xffff0000, v43
 v_pk_add_f32 v[10:11], v[44:45], v[46:47]
 v_pk_add_f32 v[12:13], v[48:49], v[50:51]
 v_pk_add_f32 v[10:11], v[10:11], v[52:53]
 v_pk_add_f32 v[12:13], v[12:13], v[54:55]
 v_pk_add_f32 v[10:11], v[10:11], v[56:57]
 v_pk_add_f32 v[12:13], v[12:13], v[58:59]
 v_pk_add_f32 v[10:11], v[10:11], v[60:61]
 v_pk_add_f32 v[12:13], v[12:13], v[62:63]
 v_pk_add_f32 v[10:11], v[10:11], v[64:65]
 v_pk_add_f32 v[12:13], v[12:13], v[66:67]
 v_pk_add_f32 v[10:11], v[10:11], v[68:69]
 v_pk_add_f32 v[12:13], v[12:13], v[70:71]
 v_pk_add_f32 v[10:11], v[10:11], v[72:73]
 v_pk_add_f32 v[12:13], v[12:13], v[74:75]
 v_pk_add_f32 v[10:11], v[10:11], v[76:77]
 v_pk_add_f32 v[12:13], v[12:13], v[78:79]
 v_pk_add_f32 v[10:11], v[10:11], v[80:81]
 v_pk_add_f32 v[12:13], v[12:13], v[82:83]
 v_pk_add_f32 v[10:11], v[10:11], v[84:85]
 v_pk_add_f32 v[12:13], v[12:13], v[86:87]
 v_pk_add_f32 v[10:11], v[10:11], v[88:89]
 v_pk_add_f32 v[12:13], v[12:13], v[90:91]
 v_pk_add_f32 v[10:11], v[10:11], v[92:93]
 v_pk_add_f32 v[12:13], v[12:13], v[94:95]
 v_pk_add_f32 v[10:11], v[10:11], v[96:97]
 v_pk_add_f32 v[12:13], v[12:13], v[98:99]
 v_pk_add_f32 v[10:11], v[10:11], v[12:13]
 v_add_f32 v10, v10, v11
 s_nop 1
 v_add_f32 v10, v10, v10 quad_perm:[1,0,3,2] row_mask:0xf bank_mask:0xf
 s_nop 1
 v_add_f32 v10, v10, v10 quad_perm:[2,3,0,1] row_mask:0xf bank_mask:0xf
 s_nop 1
 v_add_f32 v10, v10, v10 row_half_mirror row_mask:0xf bank_mask:0xf
 v_mul_f32 v10, 0xbb124925, v10
 v_mov_b32 v11, v10
 v_pk_add_f32 v[44:45], v[44:45], v[10:11]
 v_pk_add_f32 v[46:47], v[46:47], v[10:11]
 v_pk_add_f32 v[48:49], v[48:49], v[10:11]
 v_pk_add_f32 v[50:51], v[50:51], v[10:11]
 v_pk_add_f32 v[52:53], v[52:53], v[10:11]
 v_pk_add_f32 v[54:55], v[54:55], v[10:11]
 v_pk_add_f32 v[56:57], v[56:57], v[10:11]
 v_pk_add_f32 v[58:59], v[58:59], v[10:11]
 v_pk_add_f32 v[60:61], v[60:61], v[10:11]
 v_pk_add_f32 v[62:63], v[62:63], v[10:11]
 v_pk_add_f32 v[64:65], v[64:65], v[10:11]
 v_pk_add_f32 v[66:67], v[66:67], v[10:11]
 v_pk_add_f32 v[68:69], v[68:69], v[10:11]
 v_pk_add_f32 v[70:71], v[70:71], v[10:11]
 v_pk_add_f32 v[72:73], v[72:73], v[10:11]
 v_pk_add_f32 v[74:75], v[74:75], v[10:11]
 v_pk_add_f32 v[76:77], v[76:77], v[10:11]
 v_pk_add_f32 v[78:79], v[78:79], v[10:11]
 v_pk_add_f32 v[80:81], v[80:81], v[10:11]
 v_pk_add_f32 v[82:83], v[82:83], v[10:11]
 v_pk_add_f32 v[84:85], v[84:85], v[10:11]
 v_pk_add_f32 v[86:87], v[86:87], v[10:11]
 v_pk_add_f32 v[88:89], v[88:89], v[10:11]
 v_pk_add_f32 v[90:91], v[90:91], v[10:11]
 v_pk_add_f32 v[92:93], v[92:93], v[10:11]
 v_pk_add_f32 v[94:95], v[94:95], v[10:11]
 v_pk_add_f32 v[96:97], v[96:97], v[10:11]
 v_pk_add_f32 v[98:99], v[98:99], v[10:11]
 v_pk_mul_f32 v[12:13], v[44:45], v[44:45]
 v_pk_mul_f32 v[14:15], v[46:47], v[46:47]
 v_pk_fma_f32 v[12:13], v[48:49], v[48:49], v[12:13]
 v_pk_fma_f32 v[14:15], v[50:51], v[50:51], v[14:15]
 v_pk_fma_f32 v[12:13], v[52:53], v[52:53], v[12:13]
 v_pk_fma_f32 v[14:15], v[54:55], v[54:55], v[14:15]
 v_pk_fma_f32 v[12:13], v[56:57], v[56:57], v[12:13]
 v_pk_fma_f32 v[14:15], v[58:59], v[58:59], v[14:15]
 v_pk_fma_f32 v[12:13], v[60:61], v[60:61], v[12:13]
 v_pk_fma_f32 v[14:15], v[62:63], v[62:63], v[14:15]
 v_pk_fma_f32 v[12:13], v[64:65], v[64:65], v[12:13]
 v_pk_fma_f32 v[14:15], v[66:67], v[66:67], v[14:15]
 v_pk_fma_f32 v[12:13], v[68:69], v[68:69], v[12:13]
 v_pk_fma_f32 v[14:15], v[70:71], v[70:71], v[14:15]
 v_pk_fma_f32 v[12:13], v[72:73], v[72:73], v[12:13]
 v_pk_fma_f32 v[14:15], v[74:75], v[74:75], v[14:15]
 v_pk_fma_f32 v[12:13], v[76:77], v[76:77], v[12:13]
 v_pk_fma_f32 v[14:15], v[78:79], v[78:79], v[14:15]
 v_pk_fma_f32 v[12:13], v[80:81], v[80:81], v[12:13]
 v_pk_fma_f32 v[14:15], v[82:83], v[82:83], v[14:15]
 v_pk_fma_f32 v[12:13], v[84:85], v[84:85], v[12:13]
 v_pk_fma_f32 v[14:15], v[86:87], v[86:87], v[14:15]
 v_pk_fma_f32 v[12:13], v[88:89], v[88:89], v[12:13]
 v_pk_fma_f32 v[14:15], v[90:91], v[90:91], v[14:15]
 v_pk_fma_f32 v[12:13], v[92:93], v[92:93], v[12:13]
 v_pk_fma_f32 v[14:15], v[94:95], v[94:95], v[14:15]
 v_pk_fma_f32 v[12:13], v[96:97], v[96:97], v[12:13]
 v_pk_fma_f32 v[14:15], v[98:99], v[98:99], v[14:15]
 v_pk_add_f32 v[12:13], v[12:13], v[14:15]
 v_add_f32 v10, v12, v13
 s_nop 1
 v_add_f32 v10, v10, v10 quad_perm:[1,0,3,2] row_mask:0xf bank_mask:0xf
 s_nop 1
 v_add_f32 v10, v10, v10 quad_perm:[2,3,0,1] row_mask:0xf bank_mask:0xf
 s_nop 1
 v_add_f32 v10, v10, v10 row_half_mirror row_mask:0xf bank_mask:0xf
 v_mov_b32 v11, 0x3727c5ac
 v_fmac_f32 v11, 0x3b124925, v10
 v_rsq_f32 v10, v11
 s_nop 0
 v_mov_b32 v11, v10
 v_pk_mul_f32 v[44:45], v[44:45], v[10:11]
 v_pk_mul_f32 v[46:47], v[46:47], v[10:11]
 v_pk_mul_f32 v[48:49], v[48:49], v[10:11]
 v_pk_mul_f32 v[50:51], v[50:51], v[10:11]
 v_pk_mul_f32 v[52:53], v[52:53], v[10:11]
 v_pk_mul_f32 v[54:55], v[54:55], v[10:11]
 v_pk_mul_f32 v[56:57], v[56:57], v[10:11]
 v_pk_mul_f32 v[58:59], v[58:59], v[10:11]
 v_pk_mul_f32 v[60:61], v[60:61], v[10:11]
 v_pk_mul_f32 v[62:63], v[62:63], v[10:11]
 v_pk_mul_f32 v[64:65], v[64:65], v[10:11]
 v_pk_mul_f32 v[66:67], v[66:67], v[10:11]
 v_pk_mul_f32 v[68:69], v[68:69], v[10:11]
 v_pk_mul_f32 v[70:71], v[70:71], v[10:11]
 v_pk_mul_f32 v[72:73], v[72:73], v[10:11]
 v_pk_mul_f32 v[74:75], v[74:75], v[10:11]
 v_pk_mul_f32 v[76:77], v[76:77], v[10:11]
 v_pk_mul_f32 v[78:79], v[78:79], v[10:11]
 v_pk_mul_f32 v[80:81], v[80:81], v[10:11]
 v_pk_mul_f32 v[82:83], v[82:83], v[10:11]
 v_pk_mul_f32 v[84:85], v[84:85], v[10:11]
 v_pk_mul_f32 v[86:87], v[86:87], v[10:11]
 v_pk_mul_f32 v[88:89], v[88:89], v[10:11]
 v_pk_mul_f32 v[90:91], v[90:91], v[10:11]
 v_pk_mul_f32 v[92:93], v[92:93], v[10:11]
 v_pk_mul_f32 v[94:95], v[94:95], v[10:11]
 v_pk_mul_f32 v[96:97], v[96:97], v[10:11]
 v_pk_mul_f32 v[98:99], v[98:99], v[10:11]
 v_cvt_pk_bf16_f32 v16, v44, v45
 v_cvt_pk_bf16_f32 v17, v46, v47
 v_cvt_pk_bf16_f32 v18, v48, v49
 v_cvt_pk_bf16_f32 v19, v50, v51
 v_cvt_pk_bf16_f32 v20, v52, v53
 v_cvt_pk_bf16_f32 v21, v54, v55
 v_cvt_pk_bf16_f32 v22, v56, v57
 v_cvt_pk_bf16_f32 v23, v58, v59
 v_cvt_pk_bf16_f32 v24, v60, v61
 v_cvt_pk_bf16_f32 v25, v62, v63
 v_cvt_pk_bf16_f32 v26, v64, v65
 v_cvt_pk_bf16_f32 v27, v66, v67
 v_cvt_pk_bf16_f32 v28, v68, v69
 v_cvt_pk_bf16_f32 v29, v70, v71
 v_cvt_pk_bf16_f32 v30, v72, v73
 v_cvt_pk_bf16_f32 v31, v74, v75
 v_cvt_pk_bf16_f32 v32, v76, v77
 v_cvt_pk_bf16_f32 v33, v78, v79
 v_cvt_pk_bf16_f32 v34, v80, v81
 v_cvt_pk_bf16_f32 v35, v82, v83
 v_cvt_pk_bf16_f32 v36, v84, v85
 v_cvt_pk_bf16_f32 v37, v86, v87
 v_cvt_pk_bf16_f32 v38, v88, v89
 v_cvt_pk_bf16_f32 v39, v90, v91
 v_cvt_pk_bf16_f32 v40, v92, v93
 v_cvt_pk_bf16_f32 v41, v94, v95
 v_cvt_pk_bf16_f32 v42, v96, v97
 v_cvt_pk_bf16_f32 v43, v98, v99
 v_and_b32 v10, 7, v1
 v_bfe_u32 v11, v1, 3, 2
 s_lshl_b32 s8, s6, 2
 v_add_u32 v11, s8, v11
 v_xor_b32 v11, v11, v10
 v_lshlrev_b32 v11, 4, v11
 v_and_b32 v12, 3, v10
 v_lshl_add_u32 v11, v12, 8, v11
 v_lshrrev_b32 v12, 2, v10
 v_lshl_add_u32 v11, v12, 10, v11
 v_lshrrev_b32 v12, 5, v1
 v_mul_u32_u24 v12, 14336, v12
 v_add_u32 v11, v11, v12
 ds_write_b128 v11, v[16:19] offset:0
 ds_write_b128 v11, v[20:23] offset:2048
 ds_write_b128 v11, v[24:27] offset:4096
 ds_write_b128 v11, v[28:31] offset:6144
 ds_write_b128 v11, v[32:35] offset:8192
 ds_write_b128 v11, v[36:39] offset:10240
 ds_write_b128 v11, v[40:43] offset:12288
 s_waitcnt lgkmcnt(0)
 s_barrier
 ds_read_b128 v[100:103], v5 offset:0
 ds_read_b128 v[104:107], v5 offset:14336
 ds_read_b128 v[108:111], v6 offset:1024
 ds_read_b128 v[112:115], v6 offset:15360
 s_waitcnt lgkmcnt(2)
 v_mfma_f32_16x16x32_bf16 v[116:119], v[100:103], a[0:3], 0
 v_mfma_f32_16x16x32_bf16 v[120:123], v[104:107], a[0:3], 0
 v_mfma_f32_16x16x32_bf16 v[124:127], v[100:103], a[4:7], 0
 v_mfma_f32_16x16x32_bf16 v[128:131], v[104:107], a[4:7], 0
 ds_read_b128 v[100:103], v5 offset:2048
 ds_read_b128 v[104:107], v5 offset:16384
 s_waitcnt lgkmcnt(2)
 v_mfma_f32_16x16x32_bf16 v[116:119], v[108:111], a[8:11], v[116:119]
 v_mfma_f32_16x16x32_bf16 v[120:123], v[112:115], a[8:11], v[120:123]
 v_mfma_f32_16x16x32_bf16 v[124:127], v[108:111], a[12:15], v[124:127]
 v_mfma_f32_16x16x32_bf16 v[128:131], v[112:115], a[12:15], v[128:131]
 ds_read_b128 v[108:111], v6 offset:3072
 ds_read_b128 v[112:115], v6 offset:17408
 s_waitcnt lgkmcnt(2)
 v_mfma_f32_16x16x32_bf16 v[116:119], v[100:103], a[16:19], v[116:119]
 v_mfma_f32_16x16x32_bf16 v[120:123], v[104:107], a[16:19], v[120:123]
 v_mfma_f32_16x16x32_bf16 v[124:127], v[100:103], a[20:23], v[124:127]
 v_mfma_f32_16x16x32_bf16 v[128:131], v[104:107], a[20:23], v[128:131]
 ds_read_b128 v[100:103], v5 offset:4096
 ds_read_b128 v[104:107], v5 offset:18432
 s_waitcnt lgkmcnt(2)
 v_mfma_f32_16x16x32_bf16 v[116:119], v[108:111], a[24:27], v[116:119]
 v_mfma_f32_16x16x32_bf16 v[120:123], v[112:115], a[24:27], v[120:123]
 v_mfma_f32_16x16x32_bf16 v[124:127], v[108:111], a[28:31], v[124:127]
 v_mfma_f32_16x16x32_bf16 v[128:131], v[112:115], a[28:31], v[128:131]
 ds_read_b128 v[108:111], v6 offset:5120
 ds_read_b128 v[112:115], v6 offset:19456
 s_waitcnt lgkmcnt(2)
 v_mfma_f32_16x16x32_bf16 v[116:119], v[100:103], a[32:35], v[116:119]
 v_mfma_f32_16x16x32_bf16 v[120:123], v[104:107], a[32:35], v[120:123]
 v_mfma_f32_16x16x32_bf16 v[124:127], v[100:103], a[36:39], v[124:127]
 v_mfma_f32_16x16x32_bf16 v[128:131], v[104:107], a[36:39], v[128:131]
 ds_read_b128 v[100:103], v5 offset:6144
 ds_read_b128 v[104:107], v5 offset:20480
 s_waitcnt lgkmcnt(2)
 v_mfma_f32_16x16x32_bf16 v[116:119], v[108:111], a[40:43], v[116:119]
 v_mfma_f32_16x16x32_bf16 v[120:123], v[112:115], a[40:43], v[120:123]
 v_mfma_f32_16x16x32_bf16 v[124:127], v[108:111], a[44:47], v[124:127]
 v_mfma_f32_16x16x32_bf16 v[128:131], v[112:115], a[44:47], v[128:131]
 ds_read_b128 v[108:111], v6 offset:7168
 ds_read_b128 v[112:115], v6 offset:21504
 s_waitcnt lgkmcnt(2)
 v_mfma_f32_16x16x32_bf16 v[116:119], v[100:103], a[48:51], v[116:119]
 v_mfma_f32_16x16x32_bf16 v[120:123], v[104:107], a[48:51], v[120:123]
 v_mfma_f32_16x16x32_bf16 v[124:127], v[100:103], a[52:55], v[124:127]
 v_mfma_f32_16x16x32_bf16 v[128:131], v[104:107], a[52:55], v[128:131]
 ds_read_b128 v[100:103], v5 offset:8192
 ds_read_b128 v[104:107], v5 offset:22528
 s_waitcnt lgkmcnt(2)
 v_mfma_f32_16x16x32_bf16 v[116:119], v[108:111], a[56:59], v[116:119]
 v_mfma_f32_16x16x32_bf16 v[120:123], v[112:115], a[56:59], v[120:123]
 v_mfma_f32_16x16x32_bf16 v[124:127], v[108:111], a[60:63], v[124:127]
 v_mfma_f32_16x16x32_bf16 v[128:131], v[112:115], a[60:63], v[128:131]
 ds_read_b128 v[108:111], v6 offset:9216
 ds_read_b128 v[112:115], v6 offset:23552
 s_waitcnt lgkmcnt(2)
 v_mfma_f32_16x16x32_bf16 v[116:119], v[100:103], a[64:67], v[116:119]
 v_mfma_f32_16x16x32_bf16 v[120:123], v[104:107], a[64:67], v[120:123]
 v_mfma_f32_16x16x32_bf16 v[124:127], v[100:103], a[68:71], v[124:127]
 v_mfma_f32_16x16x32_bf16 v[128:131], v[104:107], a[68:71], v[128:131]
 ds_read_b128 v[100:103], v5 offset:10240
 ds_read_b128 v[104:107], v5 offset:24576
 s_waitcnt lgkmcnt(2)
 v_mfma_f32_16x16x32_bf16 v[116:119], v[108:111], a[72:75], v[116:119]
 v_mfma_f32_16x16x32_bf16 v[120:123], v[112:115], a[72:75], v[120:123]
 v_mfma_f32_16x16x32_bf16 v[124:127], v[108:111], a[76:79], v[124:127]
 v_mfma_f32_16x16x32_bf16 v[128:131], v[112:115], a[76:79], v[128:131]
 ds_read_b128 v[108:111], v6 offset:11264
 ds_read_b128 v[112:115], v6 offset:25600
 s_waitcnt lgkmcnt(2)
 v_mfma_f32_16x16x32_bf16 v[116:119], v[100:103], a[80:83], v[116:119]
 v_mfma_f32_16x16x32_bf16 v[120:123], v[104:107], a[80:83], v[120:123]
 v_mfma_f32_16x16x32_bf16 v[124:127], v[100:103], a[84:87], v[124:127]
 v_mfma_f32_16x16x32_bf16 v[128:131], v[104:107], a[84:87], v[128:131]
 ds_read_b128 v[100:103], v5 offset:12288
 ds_read_b128 v[104:107], v5 offset:26624
 s_waitcnt lgkmcnt(2)
 v_mfma_f32_16x16x32_bf16 v[116:119], v[108:111], a[88:91], v[116:119]
 v_mfma_f32_16x16x32_bf16 v[120:123], v[112:115], a[88:91], v[120:123]
 v_mfma_f32_16x16x32_bf16 v[124:127], v[108:111], a[92:95], v[124:127]
 v_mfma_f32_16x16x32_bf16 v[128:131], v[112:115], a[92:95], v[128:131]
 ds_read_b128 v[108:111], v6 offset:13312
 ds_read_b128 v[112:115], v6 offset:27648
 s_waitcnt lgkmcnt(2)
 v_mfma_f32_16x16x32_bf16 v[116:119], v[100:103], a[96:99], v[116:119]
 v_mfma_f32_16x16x32_bf16 v[120:123], v[104:107], a[96:99], v[120:123]
 v_mfma_f32_16x16x32_bf16 v[124:127], v[100:103], a[100:103], v[124:127]
 v_mfma_f32_16x16x32_bf16 v[128:131], v[104:107], a[100:103], v[128:131]
 s_waitcnt lgkmcnt(0)
 v_mfma_f32_16x16x32_bf16 v[116:119], v[108:111], a[104:107], v[116:119]
 v_mfma_f32_16x16x32_bf16 v[120:123], v[112:115], a[104:107], v[120:123]
 v_mfma_f32_16x16x32_bf16 v[124:127], v[108:111], a[108:111], v[124:127]
 v_mfma_f32_16x16x32_bf16 v[128:131], v[112:115], a[108:111], v[128:131]
 v_cvt_pk_bf16_f32 v116, v116, v117
 v_cvt_pk_bf16_f32 v117, v118, v119
 v_cvt_pk_bf16_f32 v118, v120, v121
 v_cvt_pk_bf16_f32 v119, v122, v123
 v_min_u32 v116, -2, v116
 buffer_store_dwordx4 v[116:119], v7, s[24:27], s31 offen sc1
 v_cvt_pk_bf16_f32 v124, v124, v125
 v_cvt_pk_bf16_f32 v125, v126, v127
 v_cvt_pk_bf16_f32 v126, v128, v129
 v_cvt_pk_bf16_f32 v127, v130, v131
 v_min_u32 v124, -2, v124
 buffer_store_dwordx4 v[124:127], v8, s[24:27], s31 offen sc1
 s_lshl_b32 s31, s28, 2
 s_add_u32 s31, s31, s29
 s_lshl_b32 s31, s31, 2
 s_add_u32 s31, s31, 21504
 s_waitcnt vmcnt(0)
 s_barrier
 s_cmp_lg_u32 s6, 0
 s_cbranch_scc1 pf_104
 v_and_b32 v10, 63, v0
 v_lshlrev_b32 v10, 2, v10
 v_mov_b32 v11, 1
 s_mov_b64 exec, 1
 buffer_store_dword v11, v10, s[52:55], s31 offen sc1
 s_mov_b64 exec, -1
pf_104:
 s_add_u32 s28, s28, 16
 s_sub_u32 s30, s30, 1
 s_cmp_lg_u32 s30, 0
 s_cbranch_scc1 ka_b1_loop
 s_branch ka_bp_ready
 s_branch ka_done
ka_team:
 s_add_u32 s12, s76, 55382016
 s_addc_u32 s13, s77, 0
 s_mov_b32 s14, 465920
 s_mov_b32 s15, 0x20000
 s_add_u32 s16, s76, 56315904
 s_addc_u32 s17, s77, 0
 s_mov_b32 s18, 786432
 s_mov_b32 s19, 0x20000
 s_mov_b32 s30, 0
 s_mov_b32 s31, 0
 s_mov_b32 s32, 0
 s_mov_b32 s34, 0
 s_cmp_lt_u32 s35, 16
 s_cbranch_scc0 ka_vo
ka_qk:
 s_add_u32 s8, s4, 0
 s_addc_u32 s9, s5, 0
 s_mov_b32 s10, 6422528
 s_mov_b32 s11, 0x20000
 s_add_u32 s20, s76, 24182784
 s_addc_u32 s21, s77, 0
 s_mov_b32 s22, 1835008
 s_mov_b32 s23, 0x20000
 v_and_b32 v1, 63, v0
 v_lshlrev_b32 v19, 4, v1
 s_mul_i32 s38, s35, 401408
 s_mul_i32 s39, s36, 100352
 s_add_u32 s38, s38, s39
 s_add_u32 s39, s36, 0
 s_sub_u32 s40, s39, 7
 s_cmp_ge_u32 s39, 7
 s_cselect_b32 s39, s40, s39
 s_lshl_b32 s64, s39, 11
 s_add_u32 s39, s36, 4
 s_sub_u32 s40, s39, 7
 s_cmp_ge_u32 s39, 7
 s_cselect_b32 s39, s40, s39
 s_lshl_b32 s65, s39, 11
 s_add_u32 s39, s36, 1
 s_sub_u32 s40, s39, 7
 s_cmp_ge_u32 s39, 7
 s_cselect_b32 s39, s40, s39
 s_lshl_b32 s66, s39, 11
 s_add_u32 s39, s36, 2
 s_sub_u32 s40, s39, 7
 s_cmp_ge_u32 s39, 7
 s_cselect_b32 s39, s40, s39
 s_lshl_b32 s67, s39, 11
 s_add_u32 s39, s36, 3
 s_sub_u32 s40, s39, 7
 s_cmp_ge_u32 s39, 7
 s_cselect_b32 s39, s40, s39
 s_lshl_b32 s68, s39, 11
 s_add_u32 s39, s36, 5
 s_sub_u32 s40, s39, 7
 s_cmp_ge_u32 s39, 7
 s_cselect_b32 s39, s40, s39
 s_lshl_b32 s69, s39, 11
 s_add_u32 s39, s36, 6
 s_sub_u32 s40, s39, 7
 s_cmp_ge_u32 s39, 7
 s_cselect_b32 s39, s40, s39
 s_lshl_b32 s70, s39, 11
 s_add_u32 s39, s38, s64
 buffer_load_dwordx4 a[0:3], v19, s[8:11], s39 offen offset:0
 buffer_load_dwordx4 a[4:7], v19, s[8:11], s39 offen offset:1024
 s_add_u32 s39, s38, s65
 buffer_load_dwordx4 a[8:11], v19, s[8:11], s39 offen offset:0
 buffer_load_dwordx4 a[12:15], v19, s[8:11], s39 offen offset:1024
 s_add_u32 s39, s38, s66
 buffer_load_dwordx4 a[16:19], v19, s[8:11], s39 offen offset:0
 buffer_load_dwordx4 a[20:23], v19, s[8:11], s39 offen offset:1024
 s_add_u32 s39, s38, s67
 buffer_load_dwordx4 a[24:27], v19, s[8:11], s39 offen offset:0
 buffer_load_dwordx4 a[28:31], v19, s[8:11], s39 offen offset:1024
 s_add_u32 s39, s38, s68
 buffer_load_dwordx4 a[32:35], v19, s[8:11], s39 offen offset:0
 buffer_load_dwordx4 a[36:39], v19, s[8:11], s39 offen offset:1024
 s_add_u32 s39, s38, s69
 buffer_load_dwordx4 a[40:43], v19, s[8:11], s39 offen offset:0
 buffer_load_dwordx4 a[44:47], v19, s[8:11], s39 offen offset:1024
 s_add_u32 s39, s38, s70
 buffer_load_dwordx4 a[48:51], v19, s[8:11], s39 offen offset:0
 buffer_load_dwordx4 a[52:55], v19, s[8:11], s39 offen offset:1024
 s_add_u32 s38, s38, 14336
 s_add_u32 s39, s38, s64
 buffer_load_dwordx4 a[56:59], v19, s[8:11], s39 offen offset:0
 buffer_load_dwordx4 a[60:63], v19, s[8:11], s39 offen offset:1024
 s_add_u32 s39, s38, s65
 buffer_load_dwordx4 a[64:67], v19, s[8:11], s39 offen offset:0
 buffer_load_dwordx4 a[68:71], v19, s[8:11], s39 offen offset:1024
 s_add_u32 s39, s38, s66
 buffer_load_dwordx4 a[72:75], v19, s[8:11], s39 offen offset:0
 buffer_load_dwordx4 a[76:79], v19, s[8:11], s39 offen offset:1024
 s_add_u32 s39, s38, s67
 buffer_load_dwordx4 a[80:83], v19, s[8:11], s39 offen offset:0
 buffer_load_dwordx4 a[84:87], v19, s[8:11], s39 offen offset:1024
 s_add_u32 s39, s38, s68
 buffer_load_dwordx4 a[88:91], v19, s[8:11], s39 offen offset:0
 buffer_load_dwordx4 a[92:95], v19, s[8:11], s39 offen offset:1024
 s_add_u32 s39, s38, s69
 buffer_load_dwordx4 a[96:99], v19, s[8:11], s39 offen offset:0
 buffer_load_dwordx4 a[100:103], v19, s[8:11], s39 offen offset:1024
 s_add_u32 s39, s38, s70
 buffer_load_dwordx4 a[104:107], v19, s[8:11], s39 offen offset:0
 buffer_load_dwordx4 a[108:111], v19, s[8:11], s39 offen offset:1024
 s_add_u32 s38, s38, 14336
 s_add_u32 s39, s38, s64
 buffer_load_dwordx4 a[112:115], v19, s[8:11], s39 offen offset:0
 buffer_load_dwordx4 a[116:119], v19, s[8:11], s39 offen offset:1024
 s_add_u32 s39, s38, s65
 buffer_load_dwordx4 a[120:123], v19, s[8:11], s39 offen offset:0
 buffer_load_dwordx4 a[124:127], v19, s[8:11], s39 offen offset:1024
 s_add_u32 s39, s38, s66
 buffer_load_dwordx4 a[128:131], v19, s[8:11], s39 offen offset:0
 buffer_load_dwordx4 a[132:135], v19, s[8:11], s39 offen offset:1024
 s_add_u32 s39, s38, s67
 buffer_load_dwordx4 a[136:139], v19, s[8:11], s39 offen offset:0
 buffer_load_dwordx4 a[140:143], v19, s[8:11], s39 offen offset:1024
 s_add_u32 s39, s38, s68
 buffer_load_dwordx4 a[144:147], v19, s[8:11], s39 offen offset:0
 buffer_load_dwordx4 a[148:151], v19, s[8:11], s39 offen offset:1024
 s_add_u32 s39, s38, s69
 buffer_load_dwordx4 a[152:155], v19, s[8:11], s39 offen offset:0
 buffer_load_dwordx4 a[156:159], v19, s[8:11], s39 offen offset:1024
 s_add_u32 s39, s38, s70
 buffer_load_dwordx4 a[160:163], v19, s[8:11], s39 offen offset:0
 buffer_load_dwordx4 a[164:167], v19, s[8:11], s39 offen offset:1024
 s_add_u32 s38, s38, 14336
 s_add_u32 s39, s38, s64
 buffer_load_dwordx4 a[168:171], v19, s[8:11], s39 offen offset:0
 buffer_load_dwordx4 a[172:175], v19, s[8:11], s39 offen offset:1024
 s_add_u32 s39, s38, s65
 buffer_load_dwordx4 a[176:179], v19, s[8:11], s39 offen offset:0
 buffer_load_dwordx4 a[180:183], v19, s[8:11], s39 offen offset:1024
 s_add_u32 s39, s38, s66
 buffer_load_dwordx4 a[184:187], v19, s[8:11], s39 offen offset:0
 buffer_load_dwordx4 a[188:191], v19, s[8:11], s39 offen offset:1024
 s_add_u32 s39, s38, s67
 buffer_load_dwordx4 a[192:195], v19, s[8:11], s39 offen offset:0
 buffer_load_dwordx4 a[196:199], v19, s[8:11], s39 offen offset:1024
 s_waitcnt vmcnt(48)
 s_add_u32 s39, s38, s68
 buffer_load_dwordx4 a[200:203], v19, s[8:11], s39 offen offset:0
 buffer_load_dwordx4 a[204:207], v19, s[8:11], s39 offen offset:1024
 s_waitcnt vmcnt(48)
 s_add_u32 s39, s38, s69
 buffer_load_dwordx4 a[208:211], v19, s[8:11], s39 offen offset:0
 buffer_load_dwordx4 a[212:215], v19, s[8:11], s39 offen offset:1024
 s_waitcnt vmcnt(48)
 s_add_u32 s39, s38, s70
 buffer_load_dwordx4 a[216:219], v19, s[8:11], s39 offen offset:0
 buffer_load_dwordx4 a[220:223], v19, s[8:11], s39 offen offset:1024
 s_waitcnt vmcnt(48)
 s_add_u32 s38, s38, 14336
 s_add_u32 s39, s38, s64
 buffer_load_dwordx4 a[224:227], v19, s[8:11], s39 offen offset:0
 buffer_load_dwordx4 a[228:231], v19, s[8:11], s39 offen offset:1024
 s_waitcnt vmcnt(48)
 s_add_u32 s39, s38, s65
 buffer_load_dwordx4 a[232:235], v19, s[8:11], s39 offen offset:0
 buffer_load_dwordx4 a[236:239], v19, s[8:11], s39 offen offset:1024
 s_waitcnt vmcnt(48)
 s_add_u32 s39, s38, s66
 buffer_load_dwordx4 a[240:243], v19, s[8:11], s39 offen offset:0
 buffer_load_dwordx4 a[244:247], v19, s[8:11], s39 offen offset:1024
 s_waitcnt vmcnt(48)
 s_add_u32 s39, s38, s67
 buffer_load_dwordx4 a[248:251], v19, s[8:11], s39 offen offset:0
 buffer_load_dwordx4 a[252:255], v19, s[8:11], s39 offen offset:1024
 s_waitcnt vmcnt(48)
 s_add_u32 s39, s38, s68
 buffer_load_dwordx4 v[120:123], v19, s[8:11], s39 offen offset:0
 buffer_load_dwordx4 v[124:127], v19, s[8:11], s39 offen offset:1024
 s_waitcnt vmcnt(48)
 s_add_u32 s39, s38, s69
 buffer_load_dwordx4 v[128:131], v19, s[8:11], s39 offen offset:0
 buffer_load_dwordx4 v[132:135], v19, s[8:11], s39 offen offset:1024
 s_waitcnt vmcnt(48)
 s_add_u32 s39, s38, s70
 buffer_load_dwordx4 v[136:139], v19, s[8:11], s39 offen offset:0
 buffer_load_dwordx4 v[140:143], v19, s[8:11], s39 offen offset:1024
 s_waitcnt vmcnt(48)
 s_add_u32 s38, s38, 14336
 s_add_u32 s39, s38, s64
 buffer_load_dwordx4 v[144:147], v19, s[8:11], s39 offen offset:0
 buffer_load_dwordx4 v[148:151], v19, s[8:11], s39 offen offset:1024
 s_waitcnt vmcnt(48)
 s_add_u32 s39, s38, s65
 buffer_load_dwordx4 v[152:155], v19, s[8:11], s39 offen offset:0
 buffer_load_dwordx4 v[156:159], v19, s[8:11], s39 offen offset:1024
 s_waitcnt vmcnt(48)
 s_add_u32 s39, s38, s66
 buffer_load_dwordx4 v[160:163], v19, s[8:11], s39 offen offset:0
 buffer_load_dwordx4 v[164:167], v19, s[8:11], s39 offen offset:1024
 s_waitcnt vmcnt(48)
 s_add_u32 s39, s38, s67
 buffer_load_dwordx4 v[168:171], v19, s[8:11], s39 offen offset:0
 buffer_load_dwordx4 v[172:175], v19, s[8:11], s39 offen offset:1024
 s_waitcnt vmcnt(48)
 s_add_u32 s39, s38, s68
 buffer_load_dwordx4 v[176:179], v19, s[8:11], s39 offen offset:0
 buffer_load_dwordx4 v[180:183], v19, s[8:11], s39 offen offset:1024
 s_waitcnt vmcnt(48)
 s_add_u32 s39, s38, s69
 buffer_load_dwordx4 v[184:187], v19, s[8:11], s39 offen offset:0
 buffer_load_dwordx4 v[188:191], v19, s[8:11], s39 offen offset:1024
 s_waitcnt vmcnt(48)
 s_add_u32 s39, s38, s70
 buffer_load_dwordx4 v[192:195], v19, s[8:11], s39 offen offset:0
 buffer_load_dwordx4 v[196:199], v19, s[8:11], s39 offen offset:1024
 s_waitcnt vmcnt(48)
 s_add_u32 s38, s38, 14336
 s_add_u32 s39, s38, s64
 buffer_load_dwordx4 v[200:203], v19, s[8:11], s39 offen offset:0
 buffer_load_dwordx4 v[204:207], v19, s[8:11], s39 offen offset:1024
 s_waitcnt vmcnt(48)
 s_add_u32 s39, s38, s65
 buffer_load_dwordx4 v[208:211], v19, s[8:11], s39 offen offset:0
 buffer_load_dwordx4 v[212:215], v19, s[8:11], s39 offen offset:1024
 s_waitcnt vmcnt(48)
 s_add_u32 s39, s38, s66
 buffer_load_dwordx4 v[216:219], v19, s[8:11], s39 offen offset:0
 buffer_load_dwordx4 v[220:223], v19, s[8:11], s39 offen offset:1024
 s_waitcnt vmcnt(48)
 s_add_u32 s39, s38, s67
 buffer_load_dwordx4 v[224:227], v19, s[8:11], s39 offen offset:0
 buffer_load_dwordx4 v[228:231], v19, s[8:11], s39 offen offset:1024
 s_waitcnt vmcnt(48)
 s_add_u32 s39, s38, s68
 buffer_load_dwordx4 v[232:235], v19, s[8:11], s39 offen offset:0
 buffer_load_dwordx4 v[236:239], v19, s[8:11], s39 offen offset:1024
 s_waitcnt vmcnt(48)
 s_add_u32 s39, s38, s69
 buffer_load_dwordx4 v[240:243], v19, s[8:11], s39 offen offset:0
 buffer_load_dwordx4 v[244:247], v19, s[8:11], s39 offen offset:1024
 s_waitcnt vmcnt(48)
 s_add_u32 s39, s38, s70
 buffer_load_dwordx4 v[248:251], v19, s[8:11], s39 offen offset:0
 buffer_load_dwordx4 v[252:255], v19, s[8:11], s39 offen offset:1024
 s_waitcnt vmcnt(48)
 s_add_u32 s38, s38, 14336

 s_lshr_b32 s38, s64, 1
 v_add_u32 v2, s38, v19
 s_lshr_b32 s38, s65, 1
 v_add_u32 v3, s38, v19
 s_lshr_b32 s38, s69, 1
 v_add_u32 v4, s38, v19
 s_lshr_b32 s38, s70, 1
 v_add_u32 v18, s38, v19
 v_and_b32 v5, 1, v1
 v_cmp_eq_u32 vcc, 0, v5
 v_mov_b32 v5, 0xeeee
 v_mov_b32 v22, 0x4444
 v_cndmask_b32 v5, v5, v22, vcc
 v_and_b32 v20, 15, v1
 v_lshrrev_b32 v21, 4, v1
 s_mul_i32 s38, s36, 3072
 s_add_u32 s38, s38, 8192

 v_lshrrev_b32 v22, 2, v20
 v_lshlrev_b32 v22, 6, v22
 v_and_b32 v23, 1, v20
 v_lshl_add_u32 v22, v23, 5, v22
 v_lshl_add_u32 v22, v21, 3, v22
 v_bfe_u32 v23, v20, 1, 1
 v_lshl_add_u32 v22, v23, 1, v22
 v_add_u32 v6, s38, v22

 v_lshrrev_b32 v22, 2, v20
 v_lshlrev_b32 v22, 5, v22
 v_and_b32 v23, 3, v20
 v_lshl_add_u32 v22, v23, 3, v22
 v_mul_u32_u24 v23, 384, v21
 v_add_u32 v22, v22, v23
 v_add_u32 v7, s38, v22
 s_mul_i32 s39, s36, 112
 v_lshlrev_b32 v22, 3, v21
 v_add_u32 v22, s39, v22
 v_add_u32 v22, 0, v22
 v_min_u32 v22, 440, v22
 v_lshrrev_b32 v23, 6, v22
 v_lshlrev_b32 v23, 10, v23
 v_bfe_u32 v24, v22, 4, 2
 v_lshl_add_u32 v23, v24, 8, v23
 v_bfe_u32 v24, v22, 2, 2
 v_lshl_add_u32 v23, v24, 2, v23
 v_lshrrev_b32 v24, 1, v20
 v_lshl_add_u32 v8, v24, 5, v23
 v_lshlrev_b32 v22, 3, v21
 v_add_u32 v22, s39, v22
 v_add_u32 v22, 32, v22
 v_min_u32 v22, 440, v22
 v_lshrrev_b32 v23, 6, v22
 v_lshlrev_b32 v23, 10, v23
 v_bfe_u32 v24, v22, 4, 2
 v_lshl_add_u32 v23, v24, 8, v23
 v_bfe_u32 v24, v22, 2, 2
 v_lshl_add_u32 v23, v24, 2, v23
 v_lshrrev_b32 v24, 1, v20
 v_lshl_add_u32 v9, v24, 5, v23
 v_lshlrev_b32 v22, 3, v21
 v_add_u32 v22, s39, v22
 v_add_u32 v22, 64, v22
 v_min_u32 v22, 440, v22
 v_lshrrev_b32 v23, 6, v22
 v_lshlrev_b32 v23, 10, v23
 v_bfe_u32 v24, v22, 4, 2
 v_lshl_add_u32 v23, v24, 8, v23
 v_bfe_u32 v24, v22, 2, 2
 v_lshl_add_u32 v23, v24, 2, v23
 v_lshrrev_b32 v24, 1, v20
 v_lshl_add_u32 v10, v24, 5, v23
 v_lshlrev_b32 v22, 3, v21
 v_add_u32 v22, s39, v22
 v_add_u32 v22, 96, v22
 v_min_u32 v22, 440, v22
 v_lshrrev_b32 v23, 6, v22
 v_lshlrev_b32 v23, 10, v23
 v_bfe_u32 v24, v22, 4, 2
 v_lshl_add_u32 v23, v24, 8, v23
 v_bfe_u32 v24, v22, 2, 2
 v_lshl_add_u32 v23, v24, 2, v23
 v_lshrrev_b32 v24, 1, v20
 v_lshl_add_u32 v11, v24, 5, v23

 s_mul_i32 s39, s36, 14
 v_add_u32 v22, s39, v21
 v_lshrrev_b32 v23, 2, v22
 v_lshlrev_b32 v23, 10, v23
 v_and_b32 v22, 3, v22
 v_lshl_add_u32 v23, v22, 8, v23
 v_lshl_add_u32 v12, v20, 4, v23

 s_lshl_b32 s39, s35, 2
 s_add_u32 s39, s39, s36
 s_lshl_b32 s39, s39, 2
 v_add_u32 v22, s39, v1
 v_lshlrev_b32 v22, 7, v22
 v_add_u32 v22, 57344, v22
 v_mov_b32 v23, 0x40000000
 v_cmp_gt_u32 vcc, 4, v1
 s_nop 1
 v_cndmask_b32 v13, v23, v22, vcc

 v_mul_u32_u24 v22, 576, v21
 v_lshl_add_u32 v22, v20, 2, v22
 s_mul_i32 s39, s36, 2304
 s_add_u32 s39, s39, 20480
 v_add_u32 v14, s39, v22

 v_and_b32 v22, 1, v21
 v_mul_u32_u24 v23, 384, v22
 s_mul_i32 s39, s36, 576
 s_add_u32 s39, s39, 20480
 v_add_u32 v23, s39, v23
 v_lshlrev_b32 v24, 3, v20
 v_and_b32 v25, 7, v20
 v_lshlrev_b32 v25, 3, v25
 v_add_u32 v25, 128, v25
 v_cmp_gt_u32 vcc, 2, v21
 s_nop 1
 v_cndmask_b32 v24, v25, v24, vcc
 v_add_u32 v15, v23, v24

 s_lshl_b32 s40, s35, 9
 s_lshl_b32 s41, s36, 7
 s_add_u32 s40, s40, s41
 v_and_b32 v22, 1, v21
 v_lshlrev_b32 v22, 5, v22
 v_bfe_u32 v23, v20, 2, 1
 v_lshl_add_u32 v23, v23, 6, v22
 v_and_b32 v24, 1, v20
 v_lshl_add_u32 v23, v24, 4, v23
 v_bfe_u32 v24, v20, 1, 1
 v_lshl_add_u32 v23, v24, 3, v23
 v_bfe_u32 v24, v20, 3, 1
 v_lshl_add_u32 v23, v24, 2, v23
 v_add_u32 v23, s40, v23

 s_lshr_b32 s40, s35, 1
 s_lshl_b32 s40, s40, 9
 s_and_b32 s41, s35, 1
 s_lshl_b32 s41, s41, 4
 s_add_u32 s40, s40, s41
 s_lshl_b32 s41, s36, 6
 s_add_u32 s40, s40, s41
 s_add_u32 s40, s40, 8192
 v_lshrrev_b32 v24, 2, v20
 v_lshl_add_u32 v24, v24, 8, v22
 v_and_b32 v25, 3, v20
 v_lshl_add_u32 v24, v25, 2, v24
 v_add_u32 v24, s40, v24
 v_cmp_gt_u32 vcc, 2, v21
 s_nop 1
 v_cndmask_b32 v16, v24, v23, vcc
 v_cmp_gt_u32 s[42:43], 8, v20
 s_or_b64 s[54:55], vcc, s[42:43]
 v_mov_b32 v24, 0x40000000
 v_cndmask_b32 v16, v24, v16, s[54:55]

 v_lshlrev_b32 v22, 2, v1
 v_add_u32 v22, s38, v22
 v_mov_b32 v24, 0
 ds_write_b32 v22, v24 offset:2688
 s_mov_b32 s33, 0
 s_lshl_b32 s38, s35, 2
 s_add_u32 s38, s38, s36
 s_lshl_b32 s38, s38, 7
 s_lshl_b32 s39, s35, 1
 s_add_u32 s39, s39, s36
 s_add_u32 s39, s39, 64
 s_lshl_b32 s39, s39, 7
 s_cmp_lt_u32 s36, 2
 s_cselect_b32 s39, s39, 0x40000000
 v_mov_b32 v23, 0x40000000
 v_mov_b32 v24, s38
 v_cmp_eq_u32 vcc, 0, v1
 s_nop 1
 v_cndmask_b32 v23, v23, v24, vcc
 v_mov_b32 v24, s39
 v_cmp_eq_u32 vcc, 1, v1
 s_nop 1
 v_cndmask_b32 v1, v23, v24, vcc
 s_load_dwordx2 s[60:61], s[0:1], 88
 v_mov_b32 v20, 0
 s_waitcnt lgkmcnt(0)
 global_load_dword v17, v20, s[60:61] sc0 sc1
 v_and_b32 v22, 63, v0
 v_lshlrev_b32 v22, 4, v22
 v_add_u32 v22, 24150016, v22
 global_load_dwordx4 v[24:27], v22, s[4:5] sc1
 s_waitcnt vmcnt(0) lgkmcnt(0)
ka_tm_105:
 v_readfirstlane_b32 s37, v17
 s_and_b32 s38, s37, 0xffff
 s_cmp_ge_u32 s38, 32
 s_cbranch_scc1 ka_tk_106
 s_add_u32 s34, s34, 1
 s_cmp_lt_u32 s34, 400000
 s_cbranch_scc0 ka_end
 global_load_dword v17, v20, s[60:61] sc0 sc1
 s_waitcnt vmcnt(0)
 s_branch ka_tm_105
ka_tk_106:
 s_lshr_b32 s37, s37, 16
 s_mov_b32 s49, 0
ka_pd_107:
 v_min_u32 v24, v24, v25
 v_min3_u32 v24, v24, v26, v27
 v_cmp_eq_u32 vcc, 0, v24
 s_nop 1
 s_and_b64 vcc, vcc, exec
 s_cbranch_scc0 ka_pk_108
 s_add_u32 s49, s49, 1
 s_cmp_lt_u32 s49, 400000
 s_cbranch_scc0 ka_end
 s_sleep 1
 global_load_dwordx4 v[24:27], v22, s[4:5] sc1
 s_waitcnt vmcnt(0)
 s_branch ka_pd_107
ka_pk_108:
ka_qk_layer:
 s_add_u32 s20, s76, 24182784
 s_addc_u32 s21, s77, 0
 s_mov_b32 s22, 1835008
 s_mov_b32 s23, 0x20000
 s_add_u32 s24, s76, 70787072
 s_addc_u32 s25, s77, 0
 s_mov_b32 s26, 4096
 s_mov_b32 s27, 0x20000
 s_mov_b32 s33, 0
 s_cmp_eq_u32 s3, 0
 s_cbranch_scc1 ka_xk_110
 v_mbcnt_lo_u32_b32 v20, -1, 0
 v_mbcnt_hi_u32_b32 v20, -1, v20
 v_lshrrev_b32 v21, 2, v20
 v_lshlrev_b32 v21, 6, v21
 v_and_b32 v20, 3, v20
 v_lshl_add_u32 v20, v20, 2, v21
 v_min_u32 v20, 204, v20
ka_xf_109:
 buffer_load_dword v21, v20, s[24:27], 0 offen sc1
 s_waitcnt vmcnt(0)
 v_cmp_eq_u32 vcc, 0, v21
 s_cbranch_vccz ka_xk_110
 s_add_u32 s34, s34, 1
 s_cmp_lt_u32 s34, 400000
 s_cbranch_scc0 ka_end
 s_sleep 2
 s_branch ka_xf_109
ka_xk_110:
 s_add_u32 s63, s33, 0
 buffer_load_dwordx4 v[68:71], v12, s[20:23], s63 offen offset:0 sc1
 buffer_load_dwordx4 v[72:75], v12, s[20:23], s63 offen offset:1024 sc1
 buffer_load_dwordx4 v[84:87], v12, s[20:23], s63 offen offset:2048 sc1
 buffer_load_dwordx4 v[88:91], v12, s[20:23], s63 offen offset:3072 sc1
 s_add_u32 s63, s33, 14336
 buffer_load_dwordx4 v[76:79], v12, s[20:23], s63 offen offset:0 sc1
 buffer_load_dwordx4 v[80:83], v12, s[20:23], s63 offen offset:1024 sc1
 buffer_load_dwordx4 v[92:95], v12, s[20:23], s63 offen offset:2048 sc1
 buffer_load_dwordx4 v[96:99], v12, s[20:23], s63 offen offset:3072 sc1
ka_qk_loop:
 buffer_load_dwordx4 v[100:103], v2, s[12:15], s31 offen sc1
 buffer_load_dwordx4 v[104:107], v3, s[12:15], s31 offen sc1
 v_mov_b32 v40, 0
 v_mov_b32 v41, 0
 v_mov_b32 v42, 0
 v_mov_b32 v43, 0
 v_mov_b32 v44, 0
 v_mov_b32 v45, 0
 v_mov_b32 v46, 0
 v_mov_b32 v47, 0
 v_mov_b32 v48, 0
 v_mov_b32 v49, 0
 v_mov_b32 v50, 0
 v_mov_b32 v51, 0
 v_mov_b32 v52, 0
 v_mov_b32 v53, 0
 v_mov_b32 v54, 0
 v_mov_b32 v55, 0
 v_mov_b32 v56, 0
 v_mov_b32 v57, 0
 v_mov_b32 v58, 0
 v_mov_b32 v59, 0
 v_mov_b32 v60, 0
 v_mov_b32 v61, 0
 v_mov_b32 v62, 0
 v_mov_b32 v63, 0
 v_mov_b32 v64, 0
 v_mov_b32 v65, 0
 v_mov_b32 v66, 0
 v_mov_b32 v67, 0
 buffer_load_dwordx4 v[108:111], v2, s[12:15], s31 offen sc1
 buffer_load_dwordx4 v[112:115], v3, s[12:15], s31 offen sc1
ka_pl_111:
 s_waitcnt vmcnt(2)
 v_max_u32 v20, v100, v104
 v_cmp_eq_u32 vcc, -1, v20
 s_cbranch_vccz ka_ok_112
 buffer_load_dwordx4 v[100:103], v2, s[12:15], s31 offen sc1
 buffer_load_dwordx4 v[104:107], v3, s[12:15], s31 offen sc1
 s_waitcnt vmcnt(2)
 v_max_u32 v20, v108, v112
 v_cmp_eq_u32 vcc, -1, v20
 s_cbranch_vccz ka_ok_113
 buffer_load_dwordx4 v[108:111], v2, s[12:15], s31 offen sc1
 buffer_load_dwordx4 v[112:115], v3, s[12:15], s31 offen sc1
 s_add_u32 s34, s34, 1
 s_cmp_lt_u32 s34, 400000
 s_cbranch_scc1 ka_pl_111
 s_branch ka_end
ka_ok_113:
 ds_write_b128 v2, v[108:111]
 ds_write_b128 v2, v[112:115] offset:4096
 v_smfmac_f32_16x16x64_bf16 v[40:43], v[108:111], a[0:7], v5
 v_smfmac_f32_16x16x64_bf16 v[44:47], v[108:111], a[56:63], v5
 v_smfmac_f32_16x16x64_bf16 v[48:51], v[108:111], a[112:119], v5
 v_smfmac_f32_16x16x64_bf16 v[52:55], v[108:111], a[168:175], v5
 buffer_load_dword v17, v13, s[20:23], s33 offen
 v_smfmac_f32_16x16x64_bf16 v[56:59], v[108:111], a[224:231], v5
 v_smfmac_f32_16x16x64_bf16 v[60:63], v[108:111], v[144:151], v5
 v_smfmac_f32_16x16x64_bf16 v[64:67], v[108:111], v[200:207], v5
 buffer_load_dword v17, v1, s[16:19], s32 offen
 v_smfmac_f32_16x16x64_bf16 v[40:43], v[112:115], a[8:15], v5
 s_waitcnt lgkmcnt(0)
 s_barrier
 ds_read_b128 v[20:23], v2 offset:1024
 v_smfmac_f32_16x16x64_bf16 v[44:47], v[112:115], a[64:71], v5
 ds_read_b128 v[24:27], v2 offset:2048
 v_smfmac_f32_16x16x64_bf16 v[48:51], v[112:115], a[120:127], v5
 ds_read_b128 v[28:31], v2 offset:3072
 v_smfmac_f32_16x16x64_bf16 v[52:55], v[112:115], a[176:183], v5
 ds_read_b128 v[32:35], v4
 v_smfmac_f32_16x16x64_bf16 v[56:59], v[112:115], a[232:239], v5
 ds_read_b128 v[36:39], v18
 v_smfmac_f32_16x16x64_bf16 v[60:63], v[112:115], v[152:159], v5
 v_smfmac_f32_16x16x64_bf16 v[64:67], v[112:115], v[208:215], v5
 s_branch ka_pj_114
ka_ok_112:
 ds_write_b128 v2, v[100:103]
 ds_write_b128 v2, v[104:107] offset:4096
 v_smfmac_f32_16x16x64_bf16 v[40:43], v[100:103], a[0:7], v5
 v_smfmac_f32_16x16x64_bf16 v[44:47], v[100:103], a[56:63], v5
 v_smfmac_f32_16x16x64_bf16 v[48:51], v[100:103], a[112:119], v5
 v_smfmac_f32_16x16x64_bf16 v[52:55], v[100:103], a[168:175], v5
 buffer_load_dword v17, v13, s[20:23], s33 offen
 v_smfmac_f32_16x16x64_bf16 v[56:59], v[100:103], a[224:231], v5
 v_smfmac_f32_16x16x64_bf16 v[60:63], v[100:103], v[144:151], v5
 v_smfmac_f32_16x16x64_bf16 v[64:67], v[100:103], v[200:207], v5
 buffer_load_dword v17, v1, s[16:19], s32 offen
 v_smfmac_f32_16x16x64_bf16 v[40:43], v[104:107], a[8:15], v5
 s_waitcnt lgkmcnt(0)
 s_barrier
 ds_read_b128 v[20:23], v2 offset:1024
 v_smfmac_f32_16x16x64_bf16 v[44:47], v[104:107], a[64:71], v5
 ds_read_b128 v[24:27], v2 offset:2048
 v_smfmac_f32_16x16x64_bf16 v[48:51], v[104:107], a[120:127], v5
 ds_read_b128 v[28:31], v2 offset:3072
 v_smfmac_f32_16x16x64_bf16 v[52:55], v[104:107], a[176:183], v5
 ds_read_b128 v[32:35], v4
 v_smfmac_f32_16x16x64_bf16 v[56:59], v[104:107], a[232:239], v5
 ds_read_b128 v[36:39], v18
 v_smfmac_f32_16x16x64_bf16 v[60:63], v[104:107], v[152:159], v5
 v_smfmac_f32_16x16x64_bf16 v[64:67], v[104:107], v[208:215], v5
ka_pj_114:
 s_waitcnt lgkmcnt(4)
 v_smfmac_f32_16x16x64_bf16 v[40:43], v[20:23], a[16:23], v5
 s_waitcnt lgkmcnt(3)
 v_smfmac_f32_16x16x64_bf16 v[40:43], v[24:27], a[24:31], v5
 s_waitcnt lgkmcnt(2)
 v_smfmac_f32_16x16x64_bf16 v[40:43], v[28:31], a[32:39], v5
 s_waitcnt lgkmcnt(1)
 v_smfmac_f32_16x16x64_bf16 v[40:43], v[32:35], a[40:47], v5
 s_waitcnt lgkmcnt(0)
 v_smfmac_f32_16x16x64_bf16 v[40:43], v[36:39], a[48:55], v5
 v_smfmac_f32_16x16x64_bf16 v[44:47], v[20:23], a[72:79], v5
 v_smfmac_f32_16x16x64_bf16 v[44:47], v[24:27], a[80:87], v5
 v_add_f32 v40, v40, v41
 v_smfmac_f32_16x16x64_bf16 v[44:47], v[28:31], a[88:95], v5
 v_add_f32 v42, v42, v43
 v_smfmac_f32_16x16x64_bf16 v[44:47], v[32:35], a[96:103], v5
 s_waitcnt vmcnt(2)
 v_cvt_pk_bf16_f32 v40, v40, v42
 v_smfmac_f32_16x16x64_bf16 v[44:47], v[36:39], a[104:111], v5
 ds_write_b16 v6, v40 offset:0
 v_mov_b64 v[100:101], 0
 v_smfmac_f32_16x16x64_bf16 v[48:51], v[20:23], a[128:135], v5
 ds_write_b16_d16_hi v6, v40 offset:4
 v_mov_b64 v[102:103], 0
 v_smfmac_f32_16x16x64_bf16 v[48:51], v[24:27], a[136:143], v5
 v_add_f32 v44, v44, v45
 v_smfmac_f32_16x16x64_bf16 v[48:51], v[28:31], a[144:151], v5
 v_add_f32 v46, v46, v47
 v_smfmac_f32_16x16x64_bf16 v[48:51], v[32:35], a[152:159], v5
 v_cvt_pk_bf16_f32 v44, v44, v46
 v_smfmac_f32_16x16x64_bf16 v[48:51], v[36:39], a[160:167], v5
 ds_write_b16 v6, v44 offset:384
 v_mov_b64 v[104:105], 0
 v_smfmac_f32_16x16x64_bf16 v[52:55], v[20:23], a[184:191], v5
 ds_write_b16_d16_hi v6, v44 offset:388
 v_mov_b64 v[106:107], 0
 v_smfmac_f32_16x16x64_bf16 v[52:55], v[24:27], a[192:199], v5
 ds_read2_b32 v[40:41], v8 offset0:0 offset1:4
 v_add_f32 v48, v48, v49
 v_smfmac_f32_16x16x64_bf16 v[52:55], v[28:31], a[200:207], v5
 ds_read2_b32 v[42:43], v8 offset0:1 offset1:5
 v_add_f32 v50, v50, v51
 v_smfmac_f32_16x16x64_bf16 v[52:55], v[32:35], a[208:215], v5
 ds_read2_b32 v[44:45], v9 offset0:0 offset1:4
 v_cvt_pk_bf16_f32 v48, v48, v50
 v_smfmac_f32_16x16x64_bf16 v[52:55], v[36:39], a[216:223], v5
 ds_write_b16 v6, v48 offset:768
 v_smfmac_f32_16x16x64_bf16 v[56:59], v[20:23], a[240:247], v5
 ds_write_b16_d16_hi v6, v48 offset:772
 v_smfmac_f32_16x16x64_bf16 v[56:59], v[24:27], a[248:255], v5
 ds_read2_b32 v[46:47], v9 offset0:1 offset1:5
 v_add_f32 v52, v52, v53
 v_smfmac_f32_16x16x64_bf16 v[56:59], v[28:31], v[120:127], v5
 v_add_f32 v54, v54, v55
 v_smfmac_f32_16x16x64_bf16 v[56:59], v[32:35], v[128:135], v5
 v_cvt_pk_bf16_f32 v52, v52, v54
 v_smfmac_f32_16x16x64_bf16 v[56:59], v[36:39], v[136:143], v5
 ds_write_b16 v6, v52 offset:1152
 v_smfmac_f32_16x16x64_bf16 v[60:63], v[20:23], v[160:167], v5
 ds_write_b16_d16_hi v6, v52 offset:1156
 v_smfmac_f32_16x16x64_bf16 v[60:63], v[24:27], v[168:175], v5
 ds_read_b64_tr_b16 v[112:113], v7 offset:0
 v_add_f32 v56, v56, v57
 v_smfmac_f32_16x16x64_bf16 v[60:63], v[28:31], v[176:183], v5
 ds_read_b64_tr_b16 v[114:115], v7 offset:128
 v_add_f32 v58, v58, v59
 v_smfmac_f32_16x16x64_bf16 v[60:63], v[32:35], v[184:191], v5
 ds_read2_b32 v[48:49], v10 offset0:0 offset1:4
 v_cvt_pk_bf16_f32 v56, v56, v58
 v_smfmac_f32_16x16x64_bf16 v[60:63], v[36:39], v[192:199], v5
 ds_write_b16 v6, v56 offset:1536
 v_smfmac_f32_16x16x64_bf16 v[64:67], v[20:23], v[216:223], v5
 ds_write_b16_d16_hi v6, v56 offset:1540
 v_smfmac_f32_16x16x64_bf16 v[64:67], v[24:27], v[224:231], v5
 ds_read2_b32 v[50:51], v10 offset0:1 offset1:5
 v_add_f32 v60, v60, v61
 v_smfmac_f32_16x16x64_bf16 v[64:67], v[28:31], v[232:239], v5
 ds_read2_b32 v[52:53], v11 offset0:0 offset1:4
 v_add_f32 v62, v62, v63
 v_smfmac_f32_16x16x64_bf16 v[64:67], v[32:35], v[240:247], v5
 ds_read2_b32 v[54:55], v11 offset0:1 offset1:5
 v_cvt_pk_bf16_f32 v60, v60, v62
 v_smfmac_f32_16x16x64_bf16 v[64:67], v[36:39], v[248:255], v5
 ds_write_b16 v6, v60 offset:1920
 s_waitcnt lgkmcnt(7)
 v_mov_b64 v[108:109], 0
 v_smfmac_f32_16x16x64_bf16 v[100:103], v[112:115], v[68:75], v5
 ds_write_b16_d16_hi v6, v60 offset:1924
 v_mov_b64 v[110:111], 0
 v_smfmac_f32_16x16x64_bf16 v[104:107], v[112:115], v[76:83], v5
 v_add_f32 v64, v64, v65
 v_add_f32 v66, v66, v67
 v_cvt_pk_bf16_f32 v64, v64, v66
 ds_write_b16 v6, v64 offset:2304
 ds_write_b16_d16_hi v6, v64 offset:2308
 ds_read_b64_tr_b16 v[20:21], v7 offset:1536
 ds_read_b64_tr_b16 v[22:23], v7 offset:1664
 v_smfmac_f32_16x16x64_bf16 v[108:111], v[112:115], v[40:47], v5
 s_waitcnt lgkmcnt(0)
 v_smfmac_f32_16x16x64_bf16 v[100:103], v[20:23], v[84:91], v5
 v_smfmac_f32_16x16x64_bf16 v[104:107], v[20:23], v[92:99], v5
 v_smfmac_f32_16x16x64_bf16 v[108:111], v[20:23], v[48:55], v5
 v_add_f32 v100, v100, v101
 v_add_f32 v102, v102, v103
 ds_write2_b32 v14, v100, v102 offset0:0 offset1:96
 s_nop 2
 v_add_f32 v104, v104, v105
 v_add_f32 v106, v106, v107
 ds_write2_b32 v14, v104, v106 offset0:16 offset1:112
 v_add_f32 v108, v108, v109
 v_add_f32 v110, v110, v111
 ds_write2_b32 v14, v108, v110 offset0:32 offset1:128
 s_waitcnt lgkmcnt(0)
 s_barrier
 ds_read_b64 v[20:21], v15 offset:0
 ds_read_b64 v[22:23], v15 offset:2304
 ds_read_b64 v[24:25], v15 offset:4608
 ds_read_b64 v[26:27], v15 offset:6912
 s_waitcnt lgkmcnt(2)
 v_add_f32 v20, v20, v22
 v_add_f32 v21, v21, v23
 s_waitcnt lgkmcnt(0)
 v_add_f32 v24, v24, v26
 v_add_f32 v25, v25, v27
 v_add_f32 v28, v20, v24
 v_add_f32 v29, v21, v25
 v_max_f32 v30, |v28|, |v29|
 v_cmp_lt_f32 vcc, 0x42400000, v30
 v_exp_f32 v32, v28
 v_exp_f32 v33, v29
 s_cbranch_vccnz ka_mx_115
ka_mxb_116:
 v_add_f32 v30, v32, v33
 s_nop 1
 v_add_f32 v30, v30, v30 row_ror:8 row_mask:0xf bank_mask:0xf
 s_nop 1
 v_add_f32 v30, v30, v30 row_ror:4 row_mask:0xf bank_mask:0xf
 s_nop 1
 v_add_f32 v30, v30, v30 row_ror:2 row_mask:0xf bank_mask:0xf
 s_nop 1
 v_add_f32 v30, v30, v30 row_ror:1 row_mask:0xf bank_mask:0xf
 v_mov_b32 v31, v30
 s_nop 1
 v_permlane32_swap_b32 v30, v31
 v_fmac_f32 v30, 0x3e800000, v31
 v_rcp_f32 v30, v30
 s_cmp_lg_u32 s37, 0
 s_cbranch_scc1 ka_slow_117
 v_mul_f32 v32, v32, v30
 v_mul_f32 v33, v33, v30
 v_cvt_pk_bf16_f32 v32, v32, v33 clamp
 buffer_store_dword v32, v16, s[16:19], s32 offen
ka_sd_118:
 s_add_u32 s33, s33, 28672
 s_waitcnt vmcnt(0)
 s_add_u32 s63, s33, 0
 buffer_load_dwordx4 v[68:71], v12, s[20:23], s63 offen offset:0 sc1
 buffer_load_dwordx4 v[72:75], v12, s[20:23], s63 offen offset:1024 sc1
 buffer_load_dwordx4 v[84:87], v12, s[20:23], s63 offen offset:2048 sc1
 buffer_load_dwordx4 v[88:91], v12, s[20:23], s63 offen offset:3072 sc1
 s_add_u32 s63, s33, 14336
 buffer_load_dwordx4 v[76:79], v12, s[20:23], s63 offen offset:0 sc1
 buffer_load_dwordx4 v[80:83], v12, s[20:23], s63 offen offset:1024 sc1
 buffer_load_dwordx4 v[92:95], v12, s[20:23], s63 offen offset:2048 sc1
 buffer_load_dwordx4 v[96:99], v12, s[20:23], s63 offen offset:3072 sc1
 s_add_u32 s31, s31, 7168
 s_add_u32 s32, s32, 12288
 s_add_u32 s30, s30, 1
 s_cmp_lt_u32 s30, 63
 s_cbranch_scc1 ka_qk_loop
 s_cmp_eq_u32 s3, 0
 s_cbranch_scc0 ka_last_119
 s_waitcnt vmcnt(0) lgkmcnt(0)
 s_mov_b32 s3, 1
 s_add_u32 s76, s76, 46661632
 s_addc_u32 s77, s77, 0
 s_add_u32 s12, s76, 55382016
 s_addc_u32 s13, s77, 0
 s_mov_b32 s14, 465920
 s_mov_b32 s15, 0x20000
 s_add_u32 s16, s76, 56315904
 s_addc_u32 s17, s77, 0
 s_mov_b32 s18, 786432
 s_mov_b32 s19, 0x20000
 s_mov_b32 s30, 0
 s_mov_b32 s31, 0
 s_mov_b32 s32, 0
 s_mov_b32 s34, 0
 s_branch ka_qk_layer
ka_last_119:
 s_branch ka_done
ka_slow_117:
 s_nop 0
 v_mul_f32 v32, v32, v30
 v_mul_f32 v33, v33, v30
 v_cvt_pk_bf16_f32 v32, v32, v33 clamp
 buffer_store_dword v32, v16, s[16:19], s32 offen sc1
 s_branch ka_sd_118
ka_mx_115:
 v_max_f32 v30, v28, v29
 s_nop 1
 v_max_f32 v30, v30, v30 row_ror:8 row_mask:0xf bank_mask:0xf
 s_nop 1
 v_max_f32 v30, v30, v30 row_ror:4 row_mask:0xf bank_mask:0xf
 s_nop 1
 v_max_f32 v30, v30, v30 row_ror:2 row_mask:0xf bank_mask:0xf
 s_nop 1
 v_max_f32 v30, v30, v30 row_ror:1 row_mask:0xf bank_mask:0xf
 v_mov_b32 v31, v30
 s_nop 1
 v_permlane32_swap_b32 v30, v31
 v_max_f32 v30, v30, v31
 v_sub_f32 v28, v28, v30
 v_sub_f32 v29, v29, v30
 v_exp_f32 v32, v28
 v_exp_f32 v33, v29
 s_branch ka_mxb_116
ka_vo:
 s_add_u32 s8, s4, 6422528
 s_addc_u32 s9, s5, 0
 s_mov_b32 s10, 6422528
 s_mov_b32 s11, 0x20000
 s_add_u32 s20, s76, 26021888
 s_addc_u32 s21, s77, 0
 s_mov_b32 s22, 29360128
 s_mov_b32 s23, 0x20000
 s_add_u32 s84, s76, 70761984
 s_addc_u32 s85, s77, 0
 s_mov_b32 s86, 29184
 s_mov_b32 s87, 0x20000
 s_add_u32 s80, s76, 55848960
 s_addc_u32 s81, s77, 0
 s_mov_b32 s82, 465920
 s_mov_b32 s83, 0x20000
 s_sub_u32 s35, s35, 16
 v_and_b32 v1, 63, v0
 v_lshlrev_b32 v4, 4, v1
 s_mul_i32 s40, s36, 24576
 s_add_u32 s40, s40, 16384
 v_add_u32 v13, s40, v4
 s_lshl_b32 s38, s36, 2
 s_add_u32 s38, s38, 0
 s_mul_i32 s38, s38, 28
 s_lshl_b32 s39, s35, 1
 s_add_u32 s38, s38, s39
 s_add_u32 s38, s38, 0
 s_mul_i32 s38, s38, 14336
 buffer_load_dwordx4 a[0:3], v4, s[8:11], s38 offen offset:0
 buffer_load_dwordx4 a[4:7], v4, s[8:11], s38 offen offset:1024
 s_add_u32 s38, s38, 2048
 buffer_load_dwordx4 a[8:11], v4, s[8:11], s38 offen offset:0
 buffer_load_dwordx4 a[12:15], v4, s[8:11], s38 offen offset:1024
 s_add_u32 s38, s38, 2048
 buffer_load_dwordx4 a[16:19], v4, s[8:11], s38 offen offset:0
 buffer_load_dwordx4 a[20:23], v4, s[8:11], s38 offen offset:1024
 s_add_u32 s38, s38, 2048
 buffer_load_dwordx4 a[24:27], v4, s[8:11], s38 offen offset:0
 buffer_load_dwordx4 a[28:31], v4, s[8:11], s38 offen offset:1024
 s_add_u32 s38, s38, 2048
 buffer_load_dwordx4 a[32:35], v4, s[8:11], s38 offen offset:0
 buffer_load_dwordx4 a[36:39], v4, s[8:11], s38 offen offset:1024
 s_add_u32 s38, s38, 2048
 buffer_load_dwordx4 a[40:43], v4, s[8:11], s38 offen offset:0
 buffer_load_dwordx4 a[44:47], v4, s[8:11], s38 offen offset:1024
 s_add_u32 s38, s38, 2048
 s_add_u32 s41, s40, 0
 s_mov_b32 m0, s41
 s_nop 0
 buffer_load_dwordx4 v4, s[8:11], s38 offen lds
 buffer_load_dwordx4 v4, s[8:11], s38 offen offset:1024 lds
 s_add_u32 s38, s38, 2048
 s_lshl_b32 s38, s36, 2
 s_add_u32 s38, s38, 0
 s_mul_i32 s38, s38, 28
 s_lshl_b32 s39, s35, 1
 s_add_u32 s38, s38, s39
 s_add_u32 s38, s38, 1
 s_mul_i32 s38, s38, 14336
 buffer_load_dwordx4 a[48:51], v4, s[8:11], s38 offen offset:0
 buffer_load_dwordx4 a[52:55], v4, s[8:11], s38 offen offset:1024
 s_add_u32 s38, s38, 2048
 buffer_load_dwordx4 a[56:59], v4, s[8:11], s38 offen offset:0
 buffer_load_dwordx4 a[60:63], v4, s[8:11], s38 offen offset:1024
 s_add_u32 s38, s38, 2048
 buffer_load_dwordx4 a[64:67], v4, s[8:11], s38 offen offset:0
 buffer_load_dwordx4 a[68:71], v4, s[8:11], s38 offen offset:1024
 s_add_u32 s38, s38, 2048
 s_add_u32 s41, s40, 2048
 s_mov_b32 m0, s41
 s_nop 0
 buffer_load_dwordx4 v4, s[8:11], s38 offen lds
 buffer_load_dwordx4 v4, s[8:11], s38 offen offset:1024 lds
 s_add_u32 s38, s38, 2048
 buffer_load_dwordx4 a[72:75], v4, s[8:11], s38 offen offset:0
 buffer_load_dwordx4 a[76:79], v4, s[8:11], s38 offen offset:1024
 s_add_u32 s38, s38, 2048
 buffer_load_dwordx4 a[80:83], v4, s[8:11], s38 offen offset:0
 buffer_load_dwordx4 a[84:87], v4, s[8:11], s38 offen offset:1024
 s_add_u32 s38, s38, 2048
 s_add_u32 s41, s40, 4096
 s_mov_b32 m0, s41
 s_nop 0
 buffer_load_dwordx4 v4, s[8:11], s38 offen lds
 buffer_load_dwordx4 v4, s[8:11], s38 offen offset:1024 lds
 s_add_u32 s38, s38, 2048
 s_lshl_b32 s38, s36, 2
 s_add_u32 s38, s38, 1
 s_mul_i32 s38, s38, 28
 s_lshl_b32 s39, s35, 1
 s_add_u32 s38, s38, s39
 s_add_u32 s38, s38, 0
 s_mul_i32 s38, s38, 14336
 buffer_load_dwordx4 a[88:91], v4, s[8:11], s38 offen offset:0
 buffer_load_dwordx4 a[92:95], v4, s[8:11], s38 offen offset:1024
 s_add_u32 s38, s38, 2048
 buffer_load_dwordx4 a[96:99], v4, s[8:11], s38 offen offset:0
 buffer_load_dwordx4 a[100:103], v4, s[8:11], s38 offen offset:1024
 s_add_u32 s38, s38, 2048
 buffer_load_dwordx4 a[104:107], v4, s[8:11], s38 offen offset:0
 buffer_load_dwordx4 a[108:111], v4, s[8:11], s38 offen offset:1024
 s_add_u32 s38, s38, 2048
 buffer_load_dwordx4 a[112:115], v4, s[8:11], s38 offen offset:0
 buffer_load_dwordx4 a[116:119], v4, s[8:11], s38 offen offset:1024
 s_add_u32 s38, s38, 2048
 buffer_load_dwordx4 a[120:123], v4, s[8:11], s38 offen offset:0
 buffer_load_dwordx4 a[124:127], v4, s[8:11], s38 offen offset:1024
 s_add_u32 s38, s38, 2048
 buffer_load_dwordx4 a[128:131], v4, s[8:11], s38 offen offset:0
 buffer_load_dwordx4 a[132:135], v4, s[8:11], s38 offen offset:1024
 s_add_u32 s38, s38, 2048
 s_add_u32 s41, s40, 6144
 s_mov_b32 m0, s41
 s_nop 0
 buffer_load_dwordx4 v4, s[8:11], s38 offen lds
 buffer_load_dwordx4 v4, s[8:11], s38 offen offset:1024 lds
 s_add_u32 s38, s38, 2048
 s_lshl_b32 s38, s36, 2
 s_add_u32 s38, s38, 1
 s_mul_i32 s38, s38, 28
 s_lshl_b32 s39, s35, 1
 s_add_u32 s38, s38, s39
 s_add_u32 s38, s38, 1
 s_mul_i32 s38, s38, 14336
 buffer_load_dwordx4 a[136:139], v4, s[8:11], s38 offen offset:0
 buffer_load_dwordx4 a[140:143], v4, s[8:11], s38 offen offset:1024
 s_add_u32 s38, s38, 2048
 buffer_load_dwordx4 a[144:147], v4, s[8:11], s38 offen offset:0
 buffer_load_dwordx4 a[148:151], v4, s[8:11], s38 offen offset:1024
 s_add_u32 s38, s38, 2048
 buffer_load_dwordx4 a[152:155], v4, s[8:11], s38 offen offset:0
 buffer_load_dwordx4 a[156:159], v4, s[8:11], s38 offen offset:1024
 s_add_u32 s38, s38, 2048
 s_add_u32 s41, s40, 8192
 s_mov_b32 m0, s41
 s_nop 0
 buffer_load_dwordx4 v4, s[8:11], s38 offen lds
 buffer_load_dwordx4 v4, s[8:11], s38 offen offset:1024 lds
 s_waitcnt vmcnt(48)
 s_add_u32 s38, s38, 2048
 buffer_load_dwordx4 a[160:163], v4, s[8:11], s38 offen offset:0
 buffer_load_dwordx4 a[164:167], v4, s[8:11], s38 offen offset:1024
 s_waitcnt vmcnt(48)
 s_add_u32 s38, s38, 2048
 buffer_load_dwordx4 a[168:171], v4, s[8:11], s38 offen offset:0
 buffer_load_dwordx4 a[172:175], v4, s[8:11], s38 offen offset:1024
 s_waitcnt vmcnt(48)
 s_add_u32 s38, s38, 2048
 s_add_u32 s41, s40, 10240
 s_mov_b32 m0, s41
 s_nop 0
 buffer_load_dwordx4 v4, s[8:11], s38 offen lds
 buffer_load_dwordx4 v4, s[8:11], s38 offen offset:1024 lds
 s_waitcnt vmcnt(48)
 s_add_u32 s38, s38, 2048
 s_lshl_b32 s38, s36, 2
 s_add_u32 s38, s38, 2
 s_mul_i32 s38, s38, 28
 s_lshl_b32 s39, s35, 1
 s_add_u32 s38, s38, s39
 s_add_u32 s38, s38, 0
 s_mul_i32 s38, s38, 14336
 buffer_load_dwordx4 a[176:179], v4, s[8:11], s38 offen offset:0
 buffer_load_dwordx4 a[180:183], v4, s[8:11], s38 offen offset:1024
 s_waitcnt vmcnt(48)
 s_add_u32 s38, s38, 2048
 buffer_load_dwordx4 a[184:187], v4, s[8:11], s38 offen offset:0
 buffer_load_dwordx4 a[188:191], v4, s[8:11], s38 offen offset:1024
 s_waitcnt vmcnt(48)
 s_add_u32 s38, s38, 2048
 buffer_load_dwordx4 a[192:195], v4, s[8:11], s38 offen offset:0
 buffer_load_dwordx4 a[196:199], v4, s[8:11], s38 offen offset:1024
 s_waitcnt vmcnt(48)
 s_add_u32 s38, s38, 2048
 buffer_load_dwordx4 a[200:203], v4, s[8:11], s38 offen offset:0
 buffer_load_dwordx4 a[204:207], v4, s[8:11], s38 offen offset:1024
 s_waitcnt vmcnt(48)
 s_add_u32 s38, s38, 2048
 buffer_load_dwordx4 a[208:211], v4, s[8:11], s38 offen offset:0
 buffer_load_dwordx4 a[212:215], v4, s[8:11], s38 offen offset:1024
 s_waitcnt vmcnt(48)
 s_add_u32 s38, s38, 2048
 buffer_load_dwordx4 a[216:219], v4, s[8:11], s38 offen offset:0
 buffer_load_dwordx4 a[220:223], v4, s[8:11], s38 offen offset:1024
 s_waitcnt vmcnt(48)
 s_add_u32 s38, s38, 2048
 s_add_u32 s41, s40, 12288
 s_mov_b32 m0, s41
 s_nop 0
 buffer_load_dwordx4 v4, s[8:11], s38 offen lds
 buffer_load_dwordx4 v4, s[8:11], s38 offen offset:1024 lds
 s_waitcnt vmcnt(48)
 s_add_u32 s38, s38, 2048
 s_lshl_b32 s38, s36, 2
 s_add_u32 s38, s38, 2
 s_mul_i32 s38, s38, 28
 s_lshl_b32 s39, s35, 1
 s_add_u32 s38, s38, s39
 s_add_u32 s38, s38, 1
 s_mul_i32 s38, s38, 14336
 buffer_load_dwordx4 a[224:227], v4, s[8:11], s38 offen offset:0
 buffer_load_dwordx4 a[228:231], v4, s[8:11], s38 offen offset:1024
 s_waitcnt vmcnt(48)
 s_add_u32 s38, s38, 2048
 buffer_load_dwordx4 a[232:235], v4, s[8:11], s38 offen offset:0
 buffer_load_dwordx4 a[236:239], v4, s[8:11], s38 offen offset:1024
 s_waitcnt vmcnt(48)
 s_add_u32 s38, s38, 2048
 buffer_load_dwordx4 a[240:243], v4, s[8:11], s38 offen offset:0
 buffer_load_dwordx4 a[244:247], v4, s[8:11], s38 offen offset:1024
 s_waitcnt vmcnt(48)
 s_add_u32 s38, s38, 2048
 s_add_u32 s41, s40, 14336
 s_mov_b32 m0, s41
 s_nop 0
 buffer_load_dwordx4 v4, s[8:11], s38 offen lds
 buffer_load_dwordx4 v4, s[8:11], s38 offen offset:1024 lds
 s_waitcnt vmcnt(48)
 s_add_u32 s38, s38, 2048
 buffer_load_dwordx4 a[248:251], v4, s[8:11], s38 offen offset:0
 buffer_load_dwordx4 a[252:255], v4, s[8:11], s38 offen offset:1024
 s_waitcnt vmcnt(48)
 s_add_u32 s38, s38, 2048
 buffer_load_dwordx4 v[160:163], v4, s[8:11], s38 offen offset:0
 buffer_load_dwordx4 v[164:167], v4, s[8:11], s38 offen offset:1024
 s_waitcnt vmcnt(48)
 s_add_u32 s38, s38, 2048
 s_add_u32 s41, s40, 16384
 s_mov_b32 m0, s41
 s_nop 0
 buffer_load_dwordx4 v4, s[8:11], s38 offen lds
 buffer_load_dwordx4 v4, s[8:11], s38 offen offset:1024 lds
 s_waitcnt vmcnt(48)
 s_add_u32 s38, s38, 2048
 s_lshl_b32 s38, s36, 2
 s_add_u32 s38, s38, 3
 s_mul_i32 s38, s38, 28
 s_lshl_b32 s39, s35, 1
 s_add_u32 s38, s38, s39
 s_add_u32 s38, s38, 0
 s_mul_i32 s38, s38, 14336
 buffer_load_dwordx4 v[168:171], v4, s[8:11], s38 offen offset:0
 buffer_load_dwordx4 v[172:175], v4, s[8:11], s38 offen offset:1024
 s_waitcnt vmcnt(48)
 s_add_u32 s38, s38, 2048
 buffer_load_dwordx4 v[176:179], v4, s[8:11], s38 offen offset:0
 buffer_load_dwordx4 v[180:183], v4, s[8:11], s38 offen offset:1024
 s_waitcnt vmcnt(48)
 s_add_u32 s38, s38, 2048
 buffer_load_dwordx4 v[184:187], v4, s[8:11], s38 offen offset:0
 buffer_load_dwordx4 v[188:191], v4, s[8:11], s38 offen offset:1024
 s_waitcnt vmcnt(48)
 s_add_u32 s38, s38, 2048
 buffer_load_dwordx4 v[192:195], v4, s[8:11], s38 offen offset:0
 buffer_load_dwordx4 v[196:199], v4, s[8:11], s38 offen offset:1024
 s_waitcnt vmcnt(48)
 s_add_u32 s38, s38, 2048
 buffer_load_dwordx4 v[200:203], v4, s[8:11], s38 offen offset:0
 buffer_load_dwordx4 v[204:207], v4, s[8:11], s38 offen offset:1024
 s_waitcnt vmcnt(48)
 s_add_u32 s38, s38, 2048
 buffer_load_dwordx4 v[208:211], v4, s[8:11], s38 offen offset:0
 buffer_load_dwordx4 v[212:215], v4, s[8:11], s38 offen offset:1024
 s_waitcnt vmcnt(48)
 s_add_u32 s38, s38, 2048
 s_add_u32 s41, s40, 18432
 s_mov_b32 m0, s41
 s_nop 0
 buffer_load_dwordx4 v4, s[8:11], s38 offen lds
 buffer_load_dwordx4 v4, s[8:11], s38 offen offset:1024 lds
 s_waitcnt vmcnt(48)
 s_add_u32 s38, s38, 2048
 s_lshl_b32 s38, s36, 2
 s_add_u32 s38, s38, 3
 s_mul_i32 s38, s38, 28
 s_lshl_b32 s39, s35, 1
 s_add_u32 s38, s38, s39
 s_add_u32 s38, s38, 1
 s_mul_i32 s38, s38, 14336
 buffer_load_dwordx4 v[216:219], v4, s[8:11], s38 offen offset:0
 buffer_load_dwordx4 v[220:223], v4, s[8:11], s38 offen offset:1024
 s_waitcnt vmcnt(48)
 s_add_u32 s38, s38, 2048
 buffer_load_dwordx4 v[224:227], v4, s[8:11], s38 offen offset:0
 buffer_load_dwordx4 v[228:231], v4, s[8:11], s38 offen offset:1024
 s_waitcnt vmcnt(48)
 s_add_u32 s38, s38, 2048
 buffer_load_dwordx4 v[232:235], v4, s[8:11], s38 offen offset:0
 buffer_load_dwordx4 v[236:239], v4, s[8:11], s38 offen offset:1024
 s_waitcnt vmcnt(48)
 s_add_u32 s38, s38, 2048
 s_add_u32 s41, s40, 20480
 s_mov_b32 m0, s41
 s_nop 0
 buffer_load_dwordx4 v4, s[8:11], s38 offen lds
 buffer_load_dwordx4 v4, s[8:11], s38 offen offset:1024 lds
 s_waitcnt vmcnt(48)
 s_add_u32 s38, s38, 2048
 buffer_load_dwordx4 v[240:243], v4, s[8:11], s38 offen offset:0
 buffer_load_dwordx4 v[244:247], v4, s[8:11], s38 offen offset:1024
 s_waitcnt vmcnt(48)
 s_add_u32 s38, s38, 2048
 buffer_load_dwordx4 v[248:251], v4, s[8:11], s38 offen offset:0
 buffer_load_dwordx4 v[252:255], v4, s[8:11], s38 offen offset:1024
 s_waitcnt vmcnt(48)
 s_add_u32 s38, s38, 2048
 s_add_u32 s41, s40, 22528
 s_mov_b32 m0, s41
 s_nop 0
 buffer_load_dwordx4 v4, s[8:11], s38 offen lds
 buffer_load_dwordx4 v4, s[8:11], s38 offen offset:1024 lds
 s_waitcnt vmcnt(48)
 s_add_u32 s38, s38, 2048
 v_and_b32 v1, 63, v0
 v_lshlrev_b32 v4, 4, v1
 s_lshl_b32 s38, s36, 10
 v_add_u32 v2, s38, v4
 s_add_u32 s39, s38, 4096
 s_cmp_eq_u32 s36, 3
 s_cselect_b32 s38, s38, s39
 v_add_u32 v3, s38, v4
 v_and_b32 v5, 1, v1
 v_cmp_eq_u32 vcc, 0, v5
 v_mov_b32 v5, 0xeeee
 v_mov_b32 v19, 0x4444
 v_cndmask_b32 v5, v5, v19, vcc
 v_and_b32 v20, 15, v1
 v_lshrrev_b32 v21, 4, v1

 v_lshrrev_b32 v22, 2, v20
 v_and_b32 v23, 3, v20
 v_lshlrev_b32 v23, 4, v23
 v_lshl_add_u32 v24, v22, 7, v23
 v_and_b32 v25, 1, v21
 v_lshl_add_u32 v24, v25, 6, v24
 v_lshrrev_b32 v25, 1, v21
 v_lshl_add_u32 v24, v25, 9, v24
 s_lshl_b32 s38, s36, 11
 v_add_u32 v6, s38, v24

 v_and_b32 v24, 1, v20
 v_lshlrev_b32 v24, 8, v24
 v_lshl_add_u32 v24, v25, 9, v24
 v_lshrrev_b32 v22, 1, v20
 v_lshl_add_u32 v24, v22, 5, v24
 v_and_b32 v22, 1, v21
 v_lshl_add_u32 v24, v22, 4, v24
 s_lshl_b32 s38, s36, 10
 s_add_u32 s38, s38, 8192
 v_add_u32 v7, s38, v4

 s_mul_i32 s38, s36, 112
 s_lshl_b32 s39, s35, 1
 s_add_u32 s38, s38, s39
 s_lshl_b32 s38, s38, 10
 v_add_u32 v8, s38, v4

 v_lshrrev_b32 v22, 4, v0
 v_mul_u32_u24 v22, 28672, v22
 v_and_b32 v23, 15, v0
 v_lshl_add_u32 v22, v23, 7, v22
 s_lshl_b32 s38, s35, 11
 s_add_u32 s38, s38, 458752
 v_add_u32 v14, s38, v22

 s_mul_i32 s38, s36, 1024
 s_add_u32 s38, s38, 8192
 v_lshrrev_b32 v22, 1, v21
 v_lshlrev_b32 v22, 6, v22
 v_and_b32 v23, 1, v21
 v_lshl_add_u32 v22, v23, 4, v22
 v_add_u32 v22, v22, v20
 v_lshlrev_b32 v22, 2, v22
 v_add_u32 v10, s38, v22

 v_bfe_u32 v22, v1, 3, 1
 v_lshlrev_b32 v24, 5, v22
 v_bfe_u32 v22, v1, 4, 1
 v_lshl_add_u32 v24, v22, 4, v24
 v_and_b32 v23, 3, v1
 v_lshl_add_u32 v24, v23, 2, v24
 v_bfe_u32 v23, v1, 2, 1
 v_lshl_add_u32 v24, v23, 1, v24
 s_lshl_b32 s38, s36, 6
 v_add_u32 v24, s38, v24
 v_lshlrev_b32 v24, 2, v24
 v_add_u32 v11, 8192, v24

 s_lshl_b32 s38, s35, 9
 s_lshl_b32 s39, s36, 7
 s_add_u32 s38, s38, s39
 v_lshlrev_b32 v22, 2, v1
 v_add_u32 v22, s38, v22
 v_mov_b32 v23, 0x40000000
 v_cmp_gt_u32 vcc, 32, v1
 s_nop 1
 v_cndmask_b32 v12, v23, v22, vcc

 v_lshrrev_b32 v22, 2, v1
 v_lshlrev_b32 v22, 8, v22
 v_and_b32 v24, 3, v1
 v_lshl_add_u32 v146, v24, 4, v22
 s_mov_b32 s78, 0
 s_mov_b32 s50, 0
 s_mov_b32 s51, 28672
 s_mov_b32 s52, 57344
 s_mov_b32 s53, 86016
 s_load_dwordx2 s[60:61], s[0:1], 88
 v_mov_b32 v154, 0
 s_waitcnt lgkmcnt(0)
 global_load_dword v15, v154, s[60:61] sc0 sc1
 v_and_b32 v22, 63, v0
 v_lshlrev_b32 v22, 4, v22
 v_add_u32 v22, 24150016, v22
 global_load_dwordx4 v[24:27], v22, s[4:5] sc1
 s_waitcnt vmcnt(0) lgkmcnt(0)
ka_tm_120:
 v_readfirstlane_b32 s37, v15
 s_and_b32 s38, s37, 0xffff
 s_cmp_ge_u32 s38, 32
 s_cbranch_scc1 ka_tk_121
 s_add_u32 s34, s34, 1
 s_cmp_lt_u32 s34, 400000
 s_cbranch_scc0 ka_end
 global_load_dword v15, v154, s[60:61] sc0 sc1
 s_waitcnt vmcnt(0)
 s_branch ka_tm_120
ka_tk_121:
 s_lshr_b32 s37, s37, 16
 s_mov_b32 s49, 0
ka_pd_122:
 v_min_u32 v24, v24, v25
 v_min3_u32 v24, v24, v26, v27
 v_cmp_eq_u32 vcc, 0, v24
 s_nop 1
 s_and_b64 vcc, vcc, exec
 s_cbranch_scc0 ka_pk_123
 s_add_u32 s49, s49, 1
 s_cmp_lt_u32 s49, 400000
 s_cbranch_scc0 ka_end
 s_sleep 1
 global_load_dwordx4 v[24:27], v22, s[4:5] sc1
 s_waitcnt vmcnt(0)
 s_branch ka_pd_122
ka_pk_123:
ka_vo_layer:
 s_add_u32 s20, s76, 26021888
 s_addc_u32 s21, s77, 0
 s_mov_b32 s22, 29360128
 s_mov_b32 s23, 0x20000
 s_add_u32 s84, s76, 70761984
 s_addc_u32 s85, s77, 0
 s_mov_b32 s86, 29184
 s_mov_b32 s87, 0x20000
 s_add_u32 s80, s76, 55848960
 s_addc_u32 s81, s77, 0
 s_mov_b32 s82, 465920
 s_mov_b32 s83, 0x20000
 s_mov_b32 s78, 0
 s_mov_b32 s49, 0
 s_mul_i32 s63, s3, 4
 s_cmp_eq_u32 s3, 0
 s_cbranch_scc1 ka_mk_125
 v_lshrrev_b32 v136, 2, v4
 s_mov_b32 s38, 20992
ka_mf_124:
 buffer_load_dword v137, v136, s[84:87], s38 offen sc0 sc1
 s_waitcnt vmcnt(0)
 v_cmp_eq_u32 vcc, 0, v137
 s_cbranch_vccz ka_mk_125
 s_add_u32 s34, s34, 1
 s_cmp_lt_u32 s34, 400000
 s_cbranch_scc1 ka_mf_124
 s_branch ka_end
ka_mk_125:
 s_mov_b32 s50, 0
 s_mov_b32 s51, 28672
 s_mov_b32 s52, 57344
 s_mov_b32 s53, 86016
 v_mov_b64 v[44:45], 0
 v_mov_b64 v[46:47], 0
 v_mov_b64 v[48:49], 0
 v_mov_b64 v[50:51], 0
ka_vo_loop:
 buffer_load_dwordx4 v[100:103], v2, s[12:15], s31 offen sc1
 buffer_load_dwordx4 v[104:107], v3, s[12:15], s31 offen sc1
ka_pl_130:
 s_waitcnt vmcnt(0)
 v_max3_u32 v136, v100, v101, v102
 v_max3_u32 v137, v103, v104, v105
 v_max3_u32 v138, v136, v137, v106
 v_max_u32 v139, v138, v107
 v_cmp_eq_u32 vcc, -1, v139
 s_cbranch_vccz ka_ok_131
 buffer_load_dwordx4 v[100:103], v2, s[12:15], s31 offen sc1
 buffer_load_dwordx4 v[104:107], v3, s[12:15], s31 offen sc1
 s_add_u32 s34, s34, 1
 s_cmp_lt_u32 s34, 400000
 s_cbranch_scc0 ka_end
 s_branch ka_pl_130
ka_ok_131:
 ds_write_b128 v2, v[100:103]
 ds_write_b128 v3, v[104:107]
ka_mj_129:
 s_add_u32 s38, s30, s49
 s_min_u32 s38, s38, 63
 s_cmp_lt_u32 s38, s78
 s_cbranch_scc1 ka_xo_127
 s_cmp_lg_u32 s63, 0
 s_cbranch_scc1 ka_xo_127
ka_xw_126:
 s_add_u32 s38, s78, 2
 s_lshl_b32 s38, s38, 8
 buffer_load_dwordx4 v[148:151], v146, s[84:87], s38 offen sc0 sc1
 s_waitcnt vmcnt(0)
 v_min_u32 v148, v148, v149
 v_min3_u32 v148, v148, v150, v151
 v_cmp_ne_u32 vcc, 0, v148
 s_nop 1
 s_ff0_i32_b64 s38, vcc
 s_cmp_eq_u32 s38, -1
 s_cselect_b32 s38, 64, s38
 s_lshr_b32 s38, s38, 2
 s_add_u32 s78, s78, s38
 s_add_u32 s34, s34, 1
 s_cmp_lt_u32 s34, 400000
 s_cbranch_scc0 ka_end
 s_add_u32 s38, s30, s49
 s_min_u32 s38, s38, 63
 s_cmp_lt_u32 s38, s78
 s_cbranch_scc0 ka_xw_126
ka_xo_127:
 buffer_load_dwordx4 v[68:71], v8, s[20:23], s50 offen offset:0 sc1
 buffer_load_dwordx4 v[84:87], v8, s[20:23], s50 offen offset:1024 sc1
 s_waitcnt lgkmcnt(0)
 s_barrier
 ds_read_b128 v[16:19], v4 offset:0
 ds_read_b128 v[20:23], v4 offset:1024
 ds_read_b128 v[24:27], v4 offset:2048
 ds_read_b128 v[28:31], v4 offset:3072
 ds_read_b128 v[32:35], v4 offset:4096
 ds_read_b128 v[36:39], v4 offset:5120
 ds_read_b128 v[40:43], v4 offset:6144
 ds_read_b128 v[120:123], v13 offset:0
 ds_read_b128 v[124:127], v13 offset:1024
 ds_read_b128 v[128:131], v13 offset:2048
 ds_read_b128 v[132:135], v13 offset:3072
 s_add_u32 s38, s30, 4
 s_min_u32 s38, s38, 64
 s_cmp_lt_u32 s78, s38
 s_cselect_b32 s79, 1, 0
 s_cbranch_scc0 ka_xn_128
 s_add_u32 s38, s78, 2
 s_lshl_b32 s38, s38, 8
 buffer_load_dwordx4 v[148:151], v146, s[84:87], s38 offen sc0 sc1
ka_xn_128:
 s_waitcnt lgkmcnt(10)
 v_smfmac_f32_16x16x64_bf16 v[44:47], v[16:19], a[0:7], v5
 s_waitcnt lgkmcnt(9)
 buffer_load_dwordx4 v[72:75], v8, s[20:23], s51 offen offset:0 sc1
 v_smfmac_f32_16x16x64_bf16 v[44:47], v[20:23], a[8:15], v5
 s_waitcnt lgkmcnt(8)
 buffer_load_dwordx4 v[88:91], v8, s[20:23], s51 offen offset:1024 sc1
 v_smfmac_f32_16x16x64_bf16 v[44:47], v[24:27], a[16:23], v5
 s_waitcnt lgkmcnt(7)
 buffer_load_dwordx4 v[76:79], v8, s[20:23], s52 offen offset:0 sc1
 v_smfmac_f32_16x16x64_bf16 v[44:47], v[28:31], a[24:31], v5
 s_waitcnt lgkmcnt(6)
 buffer_load_dwordx4 v[92:95], v8, s[20:23], s52 offen offset:1024 sc1
 v_smfmac_f32_16x16x64_bf16 v[44:47], v[32:35], a[32:39], v5
 s_waitcnt lgkmcnt(5)
 buffer_load_dwordx4 v[80:83], v8, s[20:23], s53 offen offset:0 sc1
 v_smfmac_f32_16x16x64_bf16 v[44:47], v[36:39], a[40:47], v5
 s_waitcnt lgkmcnt(4)
 s_waitcnt lgkmcnt(2)
 buffer_load_dwordx4 v[96:99], v8, s[20:23], s53 offen offset:1024 sc1
 v_smfmac_f32_16x16x64_bf16 v[44:47], v[40:43], v[120:127], v5
 ds_read_b128 v[120:123], v13 offset:4096
 ds_read_b128 v[124:127], v13 offset:5120
 v_smfmac_f32_16x16x64_bf16 v[48:51], v[16:19], a[48:55], v5
 v_smfmac_f32_16x16x64_bf16 v[48:51], v[20:23], a[56:63], v5
 v_smfmac_f32_16x16x64_bf16 v[48:51], v[24:27], a[64:71], v5
 s_waitcnt lgkmcnt(2)
 v_smfmac_f32_16x16x64_bf16 v[48:51], v[28:31], v[128:135], v5
 ds_read_b128 v[128:131], v13 offset:6144
 ds_read_b128 v[132:135], v13 offset:7168
 v_cvt_pk_bf16_f32 v52, v44, v45
 v_cvt_pk_bf16_f32 v54, v46, v47
 v_smfmac_f32_16x16x64_bf16 v[48:51], v[32:35], a[72:79], v5
 v_mov_b64 v[44:45], 0
 v_mov_b64 v[46:47], 0
 v_smfmac_f32_16x16x64_bf16 v[48:51], v[36:39], a[80:87], v5
 s_waitcnt lgkmcnt(2)
 v_smfmac_f32_16x16x64_bf16 v[48:51], v[40:43], v[120:127], v5
 ds_read_b128 v[120:123], v13 offset:8192
 ds_read_b128 v[124:127], v13 offset:9216
 v_smfmac_f32_16x16x64_bf16 v[44:47], v[16:19], a[88:95], v5
 v_smfmac_f32_16x16x64_bf16 v[44:47], v[20:23], a[96:103], v5
 v_smfmac_f32_16x16x64_bf16 v[44:47], v[24:27], a[104:111], v5
 v_smfmac_f32_16x16x64_bf16 v[44:47], v[28:31], a[112:119], v5
 v_cvt_pk_bf16_f32 v60, v48, v49
 v_cvt_pk_bf16_f32 v62, v50, v51
 v_smfmac_f32_16x16x64_bf16 v[44:47], v[32:35], a[120:127], v5
 v_mov_b64 v[48:49], 0
 v_mov_b64 v[50:51], 0
 v_smfmac_f32_16x16x64_bf16 v[44:47], v[36:39], a[128:135], v5
 s_waitcnt lgkmcnt(2)
 v_smfmac_f32_16x16x64_bf16 v[44:47], v[40:43], v[128:135], v5
 ds_read_b128 v[128:131], v13 offset:10240
 ds_read_b128 v[132:135], v13 offset:11264
 v_smfmac_f32_16x16x64_bf16 v[48:51], v[16:19], a[136:143], v5
 v_smfmac_f32_16x16x64_bf16 v[48:51], v[20:23], a[144:151], v5
 v_smfmac_f32_16x16x64_bf16 v[48:51], v[24:27], a[152:159], v5
 s_waitcnt lgkmcnt(2)
 v_smfmac_f32_16x16x64_bf16 v[48:51], v[28:31], v[120:127], v5
 ds_read_b128 v[120:123], v13 offset:12288
 ds_read_b128 v[124:127], v13 offset:13312
 v_cvt_pk_bf16_f32 v53, v44, v45
 v_cvt_pk_bf16_f32 v55, v46, v47
 v_smfmac_f32_16x16x64_bf16 v[48:51], v[32:35], a[160:167], v5
 v_mov_b64 v[44:45], 0
 v_mov_b64 v[46:47], 0
 v_smfmac_f32_16x16x64_bf16 v[48:51], v[36:39], a[168:175], v5
 s_waitcnt lgkmcnt(2)
 v_smfmac_f32_16x16x64_bf16 v[48:51], v[40:43], v[128:135], v5
 ds_read_b128 v[128:131], v13 offset:14336
 ds_read_b128 v[132:135], v13 offset:15360
 v_smfmac_f32_16x16x64_bf16 v[44:47], v[16:19], a[176:183], v5
 v_smfmac_f32_16x16x64_bf16 v[44:47], v[20:23], a[184:191], v5
 v_smfmac_f32_16x16x64_bf16 v[44:47], v[24:27], a[192:199], v5
 v_smfmac_f32_16x16x64_bf16 v[44:47], v[28:31], a[200:207], v5
 v_cvt_pk_bf16_f32 v61, v48, v49
 v_cvt_pk_bf16_f32 v63, v50, v51
 v_smfmac_f32_16x16x64_bf16 v[44:47], v[32:35], a[208:215], v5
 v_mov_b64 v[48:49], 0
 v_mov_b64 v[50:51], 0
 v_smfmac_f32_16x16x64_bf16 v[44:47], v[36:39], a[216:223], v5
 s_waitcnt lgkmcnt(2)
 v_smfmac_f32_16x16x64_bf16 v[44:47], v[40:43], v[120:127], v5
 ds_read_b128 v[120:123], v13 offset:16384
 ds_read_b128 v[124:127], v13 offset:17408
 v_smfmac_f32_16x16x64_bf16 v[48:51], v[16:19], a[224:231], v5
 v_smfmac_f32_16x16x64_bf16 v[48:51], v[20:23], a[232:239], v5
 v_smfmac_f32_16x16x64_bf16 v[48:51], v[24:27], a[240:247], v5
 s_waitcnt lgkmcnt(2)
 v_smfmac_f32_16x16x64_bf16 v[48:51], v[28:31], v[128:135], v5
 ds_read_b128 v[128:131], v13 offset:18432
 ds_read_b128 v[132:135], v13 offset:19456
 v_cvt_pk_bf16_f32 v56, v44, v45
 v_cvt_pk_bf16_f32 v58, v46, v47
 v_smfmac_f32_16x16x64_bf16 v[48:51], v[32:35], a[248:255], v5
 v_mov_b64 v[44:45], 0
 v_mov_b64 v[46:47], 0
 v_smfmac_f32_16x16x64_bf16 v[48:51], v[36:39], v[160:167], v5
 s_waitcnt lgkmcnt(2)
 v_smfmac_f32_16x16x64_bf16 v[48:51], v[40:43], v[120:127], v5
 ds_read_b128 v[120:123], v13 offset:20480
 ds_read_b128 v[124:127], v13 offset:21504
 v_smfmac_f32_16x16x64_bf16 v[44:47], v[16:19], v[168:175], v5
 v_smfmac_f32_16x16x64_bf16 v[44:47], v[20:23], v[176:183], v5
 v_smfmac_f32_16x16x64_bf16 v[44:47], v[24:27], v[184:191], v5
 v_smfmac_f32_16x16x64_bf16 v[44:47], v[28:31], v[192:199], v5
 v_cvt_pk_bf16_f32 v64, v48, v49
 v_cvt_pk_bf16_f32 v66, v50, v51
 v_smfmac_f32_16x16x64_bf16 v[44:47], v[32:35], v[200:207], v5
 v_mov_b64 v[48:49], 0
 v_mov_b64 v[50:51], 0
 v_smfmac_f32_16x16x64_bf16 v[44:47], v[36:39], v[208:215], v5
 s_waitcnt lgkmcnt(2)
 v_smfmac_f32_16x16x64_bf16 v[44:47], v[40:43], v[128:135], v5
 ds_read_b128 v[128:131], v13 offset:22528
 ds_read_b128 v[132:135], v13 offset:23552
 v_smfmac_f32_16x16x64_bf16 v[48:51], v[16:19], v[216:223], v5
 v_smfmac_f32_16x16x64_bf16 v[48:51], v[20:23], v[224:231], v5
 v_smfmac_f32_16x16x64_bf16 v[48:51], v[24:27], v[232:239], v5
 s_waitcnt lgkmcnt(2)
 v_smfmac_f32_16x16x64_bf16 v[48:51], v[28:31], v[120:127], v5
 v_cvt_pk_bf16_f32 v57, v44, v45
 v_cvt_pk_bf16_f32 v59, v46, v47
 v_smfmac_f32_16x16x64_bf16 v[48:51], v[32:35], v[240:247], v5
 v_smfmac_f32_16x16x64_bf16 v[48:51], v[36:39], v[248:255], v5
 s_waitcnt lgkmcnt(0)
 v_smfmac_f32_16x16x64_bf16 v[48:51], v[40:43], v[128:135], v5
 s_nop 7
 v_cvt_pk_bf16_f32 v65, v48, v49
 v_cvt_pk_bf16_f32 v67, v50, v51
 s_cmp_lg_u32 s63, 0
 s_cbranch_scc1 ka_x0_132
ka_x0b_133:
 buffer_load_dwordx4 v[100:103], v6, s[16:19], s32 offen sc1
 buffer_load_dwordx4 v[104:107], v6, s[16:19], s32 offen offset:1024 sc1
 buffer_load_dwordx4 v[108:111], v7, s[16:19], s32 offen sc1
 v_mov_b32 v112, 0
 v_mov_b32 v113, 0
 v_mov_b32 v114, 0
 v_mov_b32 v115, 0
 v_mov_b32 v116, 0
 v_mov_b32 v117, 0
 v_mov_b32 v118, 0
 v_mov_b32 v119, 0
 v_mov_b32 v44, 0
 v_mov_b32 v45, 0
 v_mov_b32 v46, 0
 v_mov_b32 v47, 0
 v_mov_b32 v48, 0
 v_mov_b32 v49, 0
 v_mov_b32 v50, 0
 v_mov_b32 v51, 0
 s_add_u32 s50, s50, 458752
 s_add_u32 s51, s51, 458752
 s_add_u32 s52, s52, 458752
 s_add_u32 s53, s53, 458752
 s_add_u32 s48, s31, 7168
 buffer_load_dwordx4 v[16:19], v6, s[16:19], s32 offen sc1
 buffer_load_dwordx4 v[20:23], v6, s[16:19], s32 offen offset:1024 sc1
 buffer_load_dwordx4 v[24:27], v7, s[16:19], s32 offen sc1
ka_pl_134:
 s_waitcnt vmcnt(3)
 v_max3_u32 v136, v100, v104, v108
 v_cmp_eq_u32 vcc, -1, v136
 s_cbranch_vccz ka_ok_135
 buffer_load_dwordx4 v[100:103], v6, s[16:19], s32 offen sc1
 buffer_load_dwordx4 v[104:107], v6, s[16:19], s32 offen offset:1024 sc1
 buffer_load_dwordx4 v[108:111], v7, s[16:19], s32 offen sc1
 s_waitcnt vmcnt(3)
 v_max3_u32 v136, v16, v20, v24
 v_cmp_eq_u32 vcc, -1, v136
 s_cbranch_vccz ka_ok_136
 buffer_load_dwordx4 v[16:19], v6, s[16:19], s32 offen sc1
 buffer_load_dwordx4 v[20:23], v6, s[16:19], s32 offen offset:1024 sc1
 buffer_load_dwordx4 v[24:27], v7, s[16:19], s32 offen sc1
 s_add_u32 s34, s34, 1
 s_cmp_lt_u32 s34, 400000
 s_cbranch_scc1 ka_pl_134
 s_branch ka_end
ka_ok_136:
 v_smfmac_f32_16x16x64_bf16 v[112:115], v[16:19], v[68:75], v5
 v_smfmac_f32_16x16x64_bf16 v[116:119], v[16:19], v[84:91], v5
 v_smfmac_f32_16x16x64_bf16 v[112:115], v[20:23], v[76:83], v5
 v_smfmac_f32_16x16x64_bf16 v[116:119], v[20:23], v[92:99], v5
 v_smfmac_f32_16x16x64_bf16 v[112:115], v[24:27], v[52:59], v5
 v_smfmac_f32_16x16x64_bf16 v[116:119], v[24:27], v[60:67], v5
 s_branch ka_pj_137
ka_ok_135:
 v_smfmac_f32_16x16x64_bf16 v[112:115], v[100:103], v[68:75], v5
 v_smfmac_f32_16x16x64_bf16 v[116:119], v[100:103], v[84:91], v5
 v_smfmac_f32_16x16x64_bf16 v[112:115], v[104:107], v[76:83], v5
 v_smfmac_f32_16x16x64_bf16 v[116:119], v[104:107], v[92:99], v5
 v_smfmac_f32_16x16x64_bf16 v[112:115], v[108:111], v[52:59], v5
 v_smfmac_f32_16x16x64_bf16 v[116:119], v[108:111], v[60:67], v5
ka_pj_137:
 s_nop 3
 v_add_f32 v112, v112, v113
 s_nop 0
 v_add_f32 v114, v114, v115
 ds_write2_b32 v10, v112, v114 offset0:0 offset1:32
 v_add_f32 v116, v116, v117
 v_add_f32 v118, v118, v119
 ds_write2_b32 v10, v116, v118 offset0:128 offset1:160
 s_waitcnt lgkmcnt(0)
 s_barrier
 ds_read_b64 v[136:137], v11 offset:0
 ds_read_b64 v[138:139], v11 offset:1024
 ds_read_b64 v[140:141], v11 offset:2048
 ds_read_b64 v[142:143], v11 offset:3072
 s_cmp_eq_u32 s30, 62
 s_cbranch_scc1 ka_mx_138
 s_cmp_lg_u32 s37, 0
 s_cbranch_scc1 ka_slow_140
 s_waitcnt lgkmcnt(2)
 v_add_f32 v136, v136, v138
 v_add_f32 v137, v137, v139
 s_waitcnt lgkmcnt(0)
 v_add_f32 v140, v140, v142
 v_add_f32 v141, v141, v143
 v_add_f32 v136, v136, v140
 v_add_f32 v137, v137, v141
 v_cvt_pk_bf16_f32 v136, v136, v137
 v_min_u32 v136, -2, v136
 buffer_store_dword v136, v12, s[12:15], s48 offen
ka_mxb_139:
 s_waitcnt vmcnt(0)
 s_cmp_eq_u32 s79, 0
 s_cbranch_scc1 ka_xu_141
 v_min_u32 v148, v148, v149
 v_min3_u32 v148, v148, v150, v151
 v_cmp_ne_u32 vcc, 0, v148
 s_nop 1
 s_ff0_i32_b64 s38, vcc
 s_cmp_eq_u32 s38, -1
 s_cselect_b32 s38, 64, s38
 s_lshr_b32 s38, s38, 2
 s_add_u32 s78, s78, s38
ka_xu_141:
 s_mov_b32 s31, s48
 s_add_u32 s32, s32, 12288
 s_add_u32 s30, s30, 1
 s_cmp_lt_u32 s30, 63
 s_cbranch_scc1 ka_vo_loop
 s_waitcnt vmcnt(0)
 s_cmp_eq_u32 s3, 0
 s_cbranch_scc0 ka_last_142
 s_waitcnt vmcnt(0) lgkmcnt(0)
 s_mov_b32 s3, 1
 s_add_u32 s76, s76, 46661632
 s_addc_u32 s77, s77, 0
 s_add_u32 s12, s76, 55382016
 s_addc_u32 s13, s77, 0
 s_mov_b32 s14, 465920
 s_mov_b32 s15, 0x20000
 s_add_u32 s16, s76, 56315904
 s_addc_u32 s17, s77, 0
 s_mov_b32 s18, 786432
 s_mov_b32 s19, 0x20000
 s_mov_b32 s30, 0
 s_mov_b32 s31, 0
 s_mov_b32 s32, 0
 s_mov_b32 s34, 0
 s_branch ka_vo_layer
ka_last_142:
 s_branch ka_done
ka_slow_140:
 s_waitcnt lgkmcnt(2)
 v_add_f32 v136, v136, v138
 v_add_f32 v137, v137, v139
 s_waitcnt lgkmcnt(0)
 v_add_f32 v140, v140, v142
 v_add_f32 v141, v141, v143
 v_add_f32 v136, v136, v140
 v_add_f32 v137, v137, v141
 v_cvt_pk_bf16_f32 v136, v136, v137
 v_min_u32 v136, -2, v136
 buffer_store_dword v136, v12, s[12:15], s48 offen sc1
 s_branch ka_mxb_139
ka_x0_132:
 s_sub_u32 s63, s63, 1
ka_x0l_143:
 s_waitcnt vmcnt(0)
 v_max3_u32 v136, v68, v72, v76
 v_max3_u32 v137, v80, v84, v88
 v_max3_u32 v138, v136, v137, v92
 v_max_u32 v139, v138, v96
 v_cmp_eq_u32 vcc, -1, v139
 s_cbranch_vccz ka_x0b_133
 s_add_u32 s34, s34, 1
 s_cmp_lt_u32 s34, 400000
 s_cbranch_scc0 ka_end
 buffer_load_dwordx4 v[68:71], v8, s[20:23], s50 offen offset:0 sc1
 buffer_load_dwordx4 v[84:87], v8, s[20:23], s50 offen offset:1024 sc1
 buffer_load_dwordx4 v[72:75], v8, s[20:23], s51 offen offset:0 sc1
 buffer_load_dwordx4 v[88:91], v8, s[20:23], s51 offen offset:1024 sc1
 buffer_load_dwordx4 v[76:79], v8, s[20:23], s52 offen offset:0 sc1
 buffer_load_dwordx4 v[92:95], v8, s[20:23], s52 offen offset:1024 sc1
 buffer_load_dwordx4 v[80:83], v8, s[20:23], s53 offen offset:0 sc1
 buffer_load_dwordx4 v[96:99], v8, s[20:23], s53 offen offset:1024 sc1
 s_branch ka_x0l_143
ka_mx_138:
 s_waitcnt lgkmcnt(2)
 v_add_f32 v136, v136, v138
 v_add_f32 v137, v137, v139
 s_waitcnt lgkmcnt(0)
 v_add_f32 v140, v140, v142
 v_add_f32 v141, v141, v143
 v_add_f32 v136, v136, v140
 v_add_f32 v137, v137, v141
 v_cvt_pk_bf16_f32 v136, v136, v137
 v_min_u32 v136, -2, v136
 buffer_store_dword v136, v12, s[80:83], s48 offen sc1
 s_branch ka_mxb_139
ka_done:
 s_waitcnt vmcnt(0) lgkmcnt(0)
 s_add_u32 s56, s76, 70782976
 s_addc_u32 s57, s77, 0
 s_mov_b32 s58, 256
 s_mov_b32 s59, 0x20000
 v_and_b32 v10, 63, v0
 v_lshlrev_b32 v10, 2, v10
 s_cmp_lg_u32 s6, 0
 s_cbranch_scc1 ka_wk_146
 s_mov_b32 s50, 0
ka_wl_145:
 buffer_load_dword v11, v10, s[56:59], 0 offen sc0 sc1
 s_waitcnt vmcnt(0)
 v_cmp_eq_u32 vcc, 0, v11
 s_cbranch_vccz ka_wk_146
 s_add_u32 s50, s50, 1
 s_cmp_lt_u32 s50, 400000
 s_cbranch_scc0 ka_end
 s_mov_b64 exec, vcc
 s_sleep 4
 s_branch ka_wl_145
ka_wk_146:
 s_mov_b64 exec, -1
 s_barrier
 s_add_u32 s56, s4, 13246464
 s_addc_u32 s57, s5, 0
 s_mov_b32 s58, 401408
 s_mov_b32 s59, 0x20000
 s_cmp_eq_u32 s3, 0
 s_cselect_b32 s91, s93, s94
 s_cmp_eq_u32 s91, -1
 s_cbranch_scc1 b3t_skip_147
 s_lshr_b32 s43, s91, 2
 s_and_b32 s44, s91, 3
 v_and_b32 v1, 63, v0
 v_lshlrev_b32 v2, 4, v1
 v_and_b32 v7, 15, v1
 v_lshrrev_b32 v8, 4, v1
 s_mul_i32 s40, s44, 7
 s_add_u32 s40, s40, 1
 s_lshr_b32 s40, s40, 1
 s_add_u32 s40, s40, s6
 s_lshr_b32 s41, s44, 1
 s_mul_i32 s41, s41, 7
 s_add_u32 s41, s41, 3
 s_and_b32 s42, s44, 1
 s_cmp_eq_u32 s6, 3
 s_cselect_b32 s45, s41, s40
 s_cselect_b32 s42, s42, 0
 s_cselect_b64 vcc, -1, 0
 s_mul_i32 s8, s45, 28672
 v_add_u32 v9, s8, v2
 v_add_u32 v10, 14336, v9

 v_bfe_u32 v11, v7, 2, 1
 v_mul_u32_u24 v11, 14336, v11
 v_lshrrev_b32 v12, 3, v7
 s_lshl_b32 s9, s42, 1
 v_add_u32 v12, s9, v12
 v_lshlrev_b32 v12, 2, v12
 v_and_b32 v13, 3, v7
 v_add_u32 v12, v12, v13
 v_lshl_add_u32 v12, v8, 4, v12
 v_lshl_add_u32 v11, v12, 4, v11
 v_add_u32 v11, s8, v11
 v_cndmask_b32 v9, v9, v11, vcc
 v_mov_b32 v11, 1073741824
 v_cndmask_b32 v10, v10, v11, vcc
 s_mov_b32 s12, 0
 buffer_load_dwordx4 a[112:115], v9, s[56:59], s12 offen offset:0 sc1
 buffer_load_dwordx4 a[116:119], v10, s[56:59], s12 offen offset:0 sc1
 buffer_load_dwordx4 a[120:123], v9, s[56:59], s12 offen offset:1024 sc1
 buffer_load_dwordx4 a[124:127], v10, s[56:59], s12 offen offset:1024 sc1
 buffer_load_dwordx4 a[128:131], v9, s[56:59], s12 offen offset:2048 sc1
 buffer_load_dwordx4 a[132:135], v10, s[56:59], s12 offen offset:2048 sc1
 buffer_load_dwordx4 a[136:139], v9, s[56:59], s12 offen offset:3072 sc1
 buffer_load_dwordx4 a[140:143], v10, s[56:59], s12 offen offset:3072 sc1
 s_mov_b32 s12, 4096
 buffer_load_dwordx4 a[144:147], v9, s[56:59], s12 offen offset:0 sc1
 buffer_load_dwordx4 a[148:151], v10, s[56:59], s12 offen offset:0 sc1
 buffer_load_dwordx4 a[152:155], v9, s[56:59], s12 offen offset:1024 sc1
 buffer_load_dwordx4 a[156:159], v10, s[56:59], s12 offen offset:1024 sc1
 buffer_load_dwordx4 a[160:163], v9, s[56:59], s12 offen offset:2048 sc1
 buffer_load_dwordx4 a[164:167], v10, s[56:59], s12 offen offset:2048 sc1
 buffer_load_dwordx4 a[168:171], v9, s[56:59], s12 offen offset:3072 sc1
 buffer_load_dwordx4 a[172:175], v10, s[56:59], s12 offen offset:3072 sc1
 s_mov_b32 s12, 8192
 buffer_load_dwordx4 a[176:179], v9, s[56:59], s12 offen offset:0 sc1
 buffer_load_dwordx4 a[180:183], v10, s[56:59], s12 offen offset:0 sc1
 buffer_load_dwordx4 a[184:187], v9, s[56:59], s12 offen offset:1024 sc1
 buffer_load_dwordx4 a[188:191], v10, s[56:59], s12 offen offset:1024 sc1
 buffer_load_dwordx4 a[192:195], v9, s[56:59], s12 offen offset:2048 sc1
 buffer_load_dwordx4 a[196:199], v10, s[56:59], s12 offen offset:2048 sc1
 buffer_load_dwordx4 a[200:203], v9, s[56:59], s12 offen offset:3072 sc1
 buffer_load_dwordx4 a[204:207], v10, s[56:59], s12 offen offset:3072 sc1
 s_mov_b32 s12, 12288
 buffer_load_dwordx4 a[208:211], v9, s[56:59], s12 offen offset:0 sc1
 buffer_load_dwordx4 a[212:215], v10, s[56:59], s12 offen offset:0 sc1
 buffer_load_dwordx4 a[216:219], v9, s[56:59], s12 offen offset:1024 sc1
 buffer_load_dwordx4 a[220:223], v10, s[56:59], s12 offen offset:1024 sc1
b3t_skip_147:
 v_and_b32 v232, 15, v0
 v_bfe_u32 v233, v0, 4, 2
 s_lshl_b32 s8, s6, 4
 v_add_u32 v234, s8, v232
 v_lshlrev_b32 v236, 3, v233
 v_mul_u32_u24 v236, v236, v234
 v_and_b32 v240, 63, v236
 v_add_u32 v236, v236, v234
 v_cvt_f32_u32 v240, v240
 v_mul_f32 v240, 0x3c800000, v240
 v_cos_f32 v242, v240
 v_sin_f32 v244, v240
 v_and_b32 v241, 63, v236
 v_add_u32 v236, v236, v234
 v_cvt_f32_u32 v241, v241
 v_mul_f32 v241, 0x3c800000, v241
 v_cos_f32 v243, v241
 v_sin_f32 v245, v241
 s_nop 0
 v_cvt_pk_bf16_f32 v168, v242, v243
 v_cvt_pk_bf16_f32 v176, -v244, -v245
 v_cvt_pk_bf16_f32 v184, v244, v245
 v_and_b32 v240, 63, v236
 v_add_u32 v236, v236, v234
 v_cvt_f32_u32 v240, v240
 v_mul_f32 v240, 0x3c800000, v240
 v_cos_f32 v242, v240
 v_sin_f32 v244, v240
 v_and_b32 v241, 63, v236
 v_add_u32 v236, v236, v234
 v_cvt_f32_u32 v241, v241
 v_mul_f32 v241, 0x3c800000, v241
 v_cos_f32 v243, v241
 v_sin_f32 v245, v241
 s_nop 0
 v_cvt_pk_bf16_f32 v169, v242, v243
 v_cvt_pk_bf16_f32 v177, -v244, -v245
 v_cvt_pk_bf16_f32 v185, v244, v245
 v_and_b32 v240, 63, v236
 v_add_u32 v236, v236, v234
 v_cvt_f32_u32 v240, v240
 v_mul_f32 v240, 0x3c800000, v240
 v_cos_f32 v242, v240
 v_sin_f32 v244, v240
 v_and_b32 v241, 63, v236
 v_add_u32 v236, v236, v234
 v_cvt_f32_u32 v241, v241
 v_mul_f32 v241, 0x3c800000, v241
 v_cos_f32 v243, v241
 v_sin_f32 v245, v241
 s_nop 0
 v_cvt_pk_bf16_f32 v170, v242, v243
 v_cvt_pk_bf16_f32 v178, -v244, -v245
 v_cvt_pk_bf16_f32 v186, v244, v245
 v_and_b32 v240, 63, v236
 v_add_u32 v236, v236, v234
 v_cvt_f32_u32 v240, v240
 v_mul_f32 v240, 0x3c800000, v240
 v_cos_f32 v242, v240
 v_sin_f32 v244, v240
 v_and_b32 v241, 63, v236
 v_add_u32 v236, v236, v234
 v_cvt_f32_u32 v241, v241
 v_mul_f32 v241, 0x3c800000, v241
 v_cos_f32 v243, v241
 v_sin_f32 v245, v241
 s_nop 0
 v_cvt_pk_bf16_f32 v171, v242, v243
 v_cvt_pk_bf16_f32 v179, -v244, -v245
 v_cvt_pk_bf16_f32 v187, v244, v245
 v_mul_u32_u24 v237, 24, v234
 v_add_u32 v236, v236, v237
 v_and_b32 v240, 63, v236
 v_add_u32 v236, v236, v234
 v_cvt_f32_u32 v240, v240
 v_mul_f32 v240, 0x3c800000, v240
 v_cos_f32 v242, v240
 v_sin_f32 v244, v240
 v_and_b32 v241, 63, v236
 v_add_u32 v236, v236, v234
 v_cvt_f32_u32 v241, v241
 v_mul_f32 v241, 0x3c800000, v241
 v_cos_f32 v243, v241
 v_sin_f32 v245, v241
 s_nop 0
 v_cvt_pk_bf16_f32 v172, v242, v243
 v_cvt_pk_bf16_f32 v180, -v244, -v245
 v_cvt_pk_bf16_f32 v188, v244, v245
 v_and_b32 v240, 63, v236
 v_add_u32 v236, v236, v234
 v_cvt_f32_u32 v240, v240
 v_mul_f32 v240, 0x3c800000, v240
 v_cos_f32 v242, v240
 v_sin_f32 v244, v240
 v_and_b32 v241, 63, v236
 v_add_u32 v236, v236, v234
 v_cvt_f32_u32 v241, v241
 v_mul_f32 v241, 0x3c800000, v241
 v_cos_f32 v243, v241
 v_sin_f32 v245, v241
 s_nop 0
 v_cvt_pk_bf16_f32 v173, v242, v243
 v_cvt_pk_bf16_f32 v181, -v244, -v245
 v_cvt_pk_bf16_f32 v189, v244, v245
 v_and_b32 v240, 63, v236
 v_add_u32 v236, v236, v234
 v_cvt_f32_u32 v240, v240
 v_mul_f32 v240, 0x3c800000, v240
 v_cos_f32 v242, v240
 v_sin_f32 v244, v240
 v_and_b32 v241, 63, v236
 v_add_u32 v236, v236, v234
 v_cvt_f32_u32 v241, v241
 v_mul_f32 v241, 0x3c800000, v241
 v_cos_f32 v243, v241
 v_sin_f32 v245, v241
 s_nop 0
 v_cvt_pk_bf16_f32 v174, v242, v243
 v_cvt_pk_bf16_f32 v182, -v244, -v245
 v_cvt_pk_bf16_f32 v190, v244, v245
 v_and_b32 v240, 63, v236
 v_add_u32 v236, v236, v234
 v_cvt_f32_u32 v240, v240
 v_mul_f32 v240, 0x3c800000, v240
 v_cos_f32 v242, v240
 v_sin_f32 v244, v240
 v_and_b32 v241, 63, v236
 v_add_u32 v236, v236, v234
 v_cvt_f32_u32 v241, v241
 v_mul_f32 v241, 0x3c800000, v241
 v_cos_f32 v243, v241
 v_sin_f32 v245, v241
 s_nop 0
 v_cvt_pk_bf16_f32 v175, v242, v243
 v_cvt_pk_bf16_f32 v183, -v244, -v245
 v_cvt_pk_bf16_f32 v191, v244, v245
 v_lshrrev_b32 v237, 2, v232
 v_lshlrev_b32 v237, 3, v237
 v_and_b32 v236, 3, v232
 v_add_u32 v237, v237, v236
 v_add_u32 v237, 0, v237
 v_lshlrev_b32 v236, 3, v233
 v_mul_u32_u24 v236, v236, v237
 v_and_b32 v240, 31, v236
 v_add_u32 v236, v236, v237
 v_cvt_f32_u32 v240, v240
 v_mul_f32 v240, 0x3d000000, v240
 v_cos_f32 v242, v240
 v_sin_f32 v244, v240
 v_and_b32 v241, 31, v236
 v_add_u32 v236, v236, v237
 v_cvt_f32_u32 v241, v241
 v_mul_f32 v241, 0x3d000000, v241
 v_cos_f32 v243, v241
 v_sin_f32 v245, v241
 s_nop 0
 v_cvt_pk_bf16_f32 v192, v242, v243
 v_cvt_pk_bf16_f32 v200, -v244, -v245
 v_cvt_pk_bf16_f32 v208, v244, v245
 v_and_b32 v240, 31, v236
 v_add_u32 v236, v236, v237
 v_cvt_f32_u32 v240, v240
 v_mul_f32 v240, 0x3d000000, v240
 v_cos_f32 v242, v240
 v_sin_f32 v244, v240
 v_and_b32 v241, 31, v236
 v_add_u32 v236, v236, v237
 v_cvt_f32_u32 v241, v241
 v_mul_f32 v241, 0x3d000000, v241
 v_cos_f32 v243, v241
 v_sin_f32 v245, v241
 s_nop 0
 v_cvt_pk_bf16_f32 v193, v242, v243
 v_cvt_pk_bf16_f32 v201, -v244, -v245
 v_cvt_pk_bf16_f32 v209, v244, v245
 v_and_b32 v240, 31, v236
 v_add_u32 v236, v236, v237
 v_cvt_f32_u32 v240, v240
 v_mul_f32 v240, 0x3d000000, v240
 v_cos_f32 v242, v240
 v_sin_f32 v244, v240
 v_and_b32 v241, 31, v236
 v_add_u32 v236, v236, v237
 v_cvt_f32_u32 v241, v241
 v_mul_f32 v241, 0x3d000000, v241
 v_cos_f32 v243, v241
 v_sin_f32 v245, v241
 s_nop 0
 v_cvt_pk_bf16_f32 v194, v242, v243
 v_cvt_pk_bf16_f32 v202, -v244, -v245
 v_cvt_pk_bf16_f32 v210, v244, v245
 v_and_b32 v240, 31, v236
 v_add_u32 v236, v236, v237
 v_cvt_f32_u32 v240, v240
 v_mul_f32 v240, 0x3d000000, v240
 v_cos_f32 v242, v240
 v_sin_f32 v244, v240
 v_and_b32 v241, 31, v236
 v_add_u32 v236, v236, v237
 v_cvt_f32_u32 v241, v241
 v_mul_f32 v241, 0x3d000000, v241
 v_cos_f32 v243, v241
 v_sin_f32 v245, v241
 s_nop 0
 v_cvt_pk_bf16_f32 v195, v242, v243
 v_cvt_pk_bf16_f32 v203, -v244, -v245
 v_cvt_pk_bf16_f32 v211, v244, v245
 v_lshrrev_b32 v237, 2, v232
 v_lshlrev_b32 v237, 3, v237
 v_and_b32 v236, 3, v232
 v_add_u32 v237, v237, v236
 v_add_u32 v237, 4, v237
 v_lshlrev_b32 v236, 3, v233
 v_mul_u32_u24 v236, v236, v237
 v_and_b32 v240, 31, v236
 v_add_u32 v236, v236, v237
 v_cvt_f32_u32 v240, v240
 v_mul_f32 v240, 0x3d000000, v240
 v_cos_f32 v242, v240
 v_sin_f32 v244, v240
 v_and_b32 v241, 31, v236
 v_add_u32 v236, v236, v237
 v_cvt_f32_u32 v241, v241
 v_mul_f32 v241, 0x3d000000, v241
 v_cos_f32 v243, v241
 v_sin_f32 v245, v241
 s_nop 0
 v_cvt_pk_bf16_f32 v196, v242, v243
 v_cvt_pk_bf16_f32 v204, -v244, -v245
 v_cvt_pk_bf16_f32 v212, v244, v245
 v_and_b32 v240, 31, v236
 v_add_u32 v236, v236, v237
 v_cvt_f32_u32 v240, v240
 v_mul_f32 v240, 0x3d000000, v240
 v_cos_f32 v242, v240
 v_sin_f32 v244, v240
 v_and_b32 v241, 31, v236
 v_add_u32 v236, v236, v237
 v_cvt_f32_u32 v241, v241
 v_mul_f32 v241, 0x3d000000, v241
 v_cos_f32 v243, v241
 v_sin_f32 v245, v241
 s_nop 0
 v_cvt_pk_bf16_f32 v197, v242, v243
 v_cvt_pk_bf16_f32 v205, -v244, -v245
 v_cvt_pk_bf16_f32 v213, v244, v245
 v_and_b32 v240, 31, v236
 v_add_u32 v236, v236, v237
 v_cvt_f32_u32 v240, v240
 v_mul_f32 v240, 0x3d000000, v240
 v_cos_f32 v242, v240
 v_sin_f32 v244, v240
 v_and_b32 v241, 31, v236
 v_add_u32 v236, v236, v237
 v_cvt_f32_u32 v241, v241
 v_mul_f32 v241, 0x3d000000, v241
 v_cos_f32 v243, v241
 v_sin_f32 v245, v241
 s_nop 0
 v_cvt_pk_bf16_f32 v198, v242, v243
 v_cvt_pk_bf16_f32 v206, -v244, -v245
 v_cvt_pk_bf16_f32 v214, v244, v245
 v_and_b32 v240, 31, v236
 v_add_u32 v236, v236, v237
 v_cvt_f32_u32 v240, v240
 v_mul_f32 v240, 0x3d000000, v240
 v_cos_f32 v242, v240
 v_sin_f32 v244, v240
 v_and_b32 v241, 31, v236
 v_add_u32 v236, v236, v237
 v_cvt_f32_u32 v241, v241
 v_mul_f32 v241, 0x3d000000, v241
 v_cos_f32 v243, v241
 v_sin_f32 v245, v241
 s_nop 0
 v_cvt_pk_bf16_f32 v199, v242, v243
 v_cvt_pk_bf16_f32 v207, -v244, -v245
 v_cvt_pk_bf16_f32 v215, v244, v245
 v_lshlrev_b32 v236, 3, v233
 v_mul_u32_u24 v236, v236, v234
 v_cvt_f32_u32 v240, v236
 v_add_u32 v236, v236, v234
 v_mul_f32 v240, 0x3a000000, v240
 v_cos_f32 v216, v240
 v_sin_f32 v224, v240
 v_cvt_f32_u32 v240, v236
 v_add_u32 v236, v236, v234
 v_mul_f32 v240, 0x3a000000, v240
 v_cos_f32 v217, v240
 v_sin_f32 v225, v240
 v_cvt_f32_u32 v240, v236
 v_add_u32 v236, v236, v234
 v_mul_f32 v240, 0x3a000000, v240
 v_cos_f32 v218, v240
 v_sin_f32 v226, v240
 v_cvt_f32_u32 v240, v236
 v_add_u32 v236, v236, v234
 v_mul_f32 v240, 0x3a000000, v240
 v_cos_f32 v219, v240
 v_sin_f32 v227, v240
 v_cvt_f32_u32 v240, v236
 v_add_u32 v236, v236, v234
 v_mul_f32 v240, 0x3a000000, v240
 v_cos_f32 v220, v240
 v_sin_f32 v228, v240
 v_cvt_f32_u32 v240, v236
 v_add_u32 v236, v236, v234
 v_mul_f32 v240, 0x3a000000, v240
 v_cos_f32 v221, v240
 v_sin_f32 v229, v240
 v_cvt_f32_u32 v240, v236
 v_add_u32 v236, v236, v234
 v_mul_f32 v240, 0x3a000000, v240
 v_cos_f32 v222, v240
 v_sin_f32 v230, v240
 v_cvt_f32_u32 v240, v236
 v_add_u32 v236, v236, v234
 v_mul_f32 v240, 0x3a000000, v240
 v_cos_f32 v223, v240
 v_sin_f32 v231, v240
ka_bp_ready:
 s_add_u32 s52, s76, 70758400
 s_addc_u32 s53, s77, 0
 s_mov_b32 s54, 32768
 s_mov_b32 s55, 0x20000

 s_sub_u32 s47, s94, 32
 s_cmp_eq_u32 s94, 30
 s_cselect_b32 s47, 224, s47
 s_cmp_gt_u32 s47, 224
 s_cbranch_scc1 ka_b3_144
 s_add_u32 s16, s76, 67063808
 s_addc_u32 s17, s77, 0
 s_mov_b32 s18, 1835008
 s_mov_b32 s19, 0x20000
 s_add_u32 s20, s76, 68911104
 s_addc_u32 s21, s77, 0
 s_mov_b32 s22, 1835008
 s_mov_b32 s23, 0x20000
 s_add_u32 s24, s4, 19152896
 s_addc_u32 s25, s5, 0
 s_mov_b32 s26, 1843200
 s_mov_b32 s27, 0x20000
 v_and_b32 v1, 63, v0
 v_lshlrev_b32 v2, 4, v1

 v_lshrrev_b32 v10, 2, v1
 s_lshl_b32 s8, s6, 4
 v_add_u32 v10, s8, v10
 v_mul_u32_u24 v10, 28672, v10
 v_and_b32 v11, 3, v1
 v_lshl_add_u32 v10, v11, 4, v10
 s_lshl_b32 s8, s47, 6
 v_add_u32 v3, s8, v10
 v_add_u32 v4, 14336, v3
 v_mov_b32 v10, 1073741824
 s_cmp_eq_u32 s47, 0
 s_cselect_b64 vcc, -1, 0
 s_cmp_eq_u32 s47, 224
 s_cselect_b64 s[10:11], -1, 0
 s_or_b64 vcc, vcc, s[10:11]
 v_cndmask_b32 v4, v4, v10, vcc
 v_and_b32 v7, 15, v1
 v_lshrrev_b32 v8, 4, v1
 s_lshl_b32 s8, s6, 4
 v_add_u32 v9, s8, v7

 v_lshrrev_b32 v10, 2, v7
 v_lshl_add_u32 v10, v8, 3, v10
 v_lshlrev_b32 v10, 6, v10
 v_and_b32 v11, 3, v7
 v_lshl_add_u32 v5, v11, 4, v10

 v_lshlrev_b32 v10, 6, v9
 v_lshl_add_u32 v10, v8, 4, v10
 v_add_u32 v6, 8192, v10
 s_lshl_b32 s8, s6, 10
 v_add_u32 v154, s8, v2
 s_lshl_b32 s8, s47, 13
 s_lshl_b32 s9, s6, 11
 s_add_u32 s12, s8, s9
 v_lshlrev_b32 v155, 5, v1
 buffer_load_dwordx4 v[136:139], v155, s[24:27], s12 offen sc1
 buffer_load_dwordx4 v[140:143], v155, s[24:27], s12 offen offset:16 sc1
 s_mov_b32 s50, 0
ka_dl_148:
 buffer_load_dwordx4 v[144:147], v3, s[16:19], 0 offen sc1
 buffer_load_dwordx4 v[148:151], v4, s[16:19], 0 offen sc1
 s_waitcnt vmcnt(0)
 v_max_u32 v10, v144, v148
 v_cmp_eq_u32 vcc, -1, v10
 s_cbranch_vccz ka_dk_149
 s_add_u32 s50, s50, 1
 s_cmp_lt_u32 s50, 400000
 s_cbranch_scc0 ka_end
 s_mov_b64 exec, vcc
 s_sleep 2
 s_branch ka_dl_148
ka_dk_149:
 s_mov_b64 exec, -1
 ds_write_b128 v154, v[144:147]
 ds_write_b128 v154, v[148:151] offset:4096
 s_waitcnt lgkmcnt(0)
 s_barrier
 ds_read_b64_tr_b16 v[80:81], v5 offset:0
 ds_read_b64_tr_b16 v[82:83], v5 offset:256
 ds_read_b64_tr_b16 v[84:85], v5 offset:2048
 ds_read_b64_tr_b16 v[86:87], v5 offset:2304
 ds_read_b64_tr_b16 v[88:89], v5 offset:8
 ds_read_b64_tr_b16 v[90:91], v5 offset:264
 ds_read_b64_tr_b16 v[92:93], v5 offset:2056
 ds_read_b64_tr_b16 v[94:95], v5 offset:2312
 ds_read_b64_tr_b16 v[96:97], v5 offset:4096
 ds_read_b64_tr_b16 v[98:99], v5 offset:4352
 ds_read_b64_tr_b16 v[100:101], v5 offset:6144
 ds_read_b64_tr_b16 v[102:103], v5 offset:6400
 ds_read_b64_tr_b16 v[104:105], v5 offset:4104
 ds_read_b64_tr_b16 v[106:107], v5 offset:4360
 ds_read_b64_tr_b16 v[108:109], v5 offset:6152
 ds_read_b64_tr_b16 v[110:111], v5 offset:6408
 s_waitcnt lgkmcnt(0)
 v_mfma_f32_16x16x32_bf16 v[112:115], v[80:83], v[168:171], 0
 v_mfma_f32_16x16x32_bf16 v[120:123], v[80:83], v[176:179], 0
 v_mfma_f32_16x16x32_bf16 v[112:115], v[84:87], v[172:175], v[112:115]
 v_mfma_f32_16x16x32_bf16 v[120:123], v[84:87], v[180:183], v[120:123]
 v_mfma_f32_16x16x32_bf16 v[116:119], v[88:91], v[168:171], 0
 v_mfma_f32_16x16x32_bf16 v[124:127], v[88:91], v[176:179], 0
 v_mfma_f32_16x16x32_bf16 v[116:119], v[92:95], v[172:175], v[116:119]
 v_mfma_f32_16x16x32_bf16 v[124:127], v[92:95], v[180:183], v[124:127]
 v_mfma_f32_16x16x32_bf16 v[112:115], v[96:99], v[184:187], v[112:115]
 v_mfma_f32_16x16x32_bf16 v[120:123], v[96:99], v[168:171], v[120:123]
 v_mfma_f32_16x16x32_bf16 v[112:115], v[100:103], v[188:191], v[112:115]
 v_mfma_f32_16x16x32_bf16 v[120:123], v[100:103], v[172:175], v[120:123]
 v_mfma_f32_16x16x32_bf16 v[116:119], v[104:107], v[184:187], v[116:119]
 v_mfma_f32_16x16x32_bf16 v[124:127], v[104:107], v[168:171], v[124:127]
 v_mfma_f32_16x16x32_bf16 v[116:119], v[108:111], v[188:191], v[116:119]
 v_mfma_f32_16x16x32_bf16 v[124:127], v[108:111], v[172:175], v[124:127]
 v_mul_f32 v152, v112, v216
 v_mul_f32 v160, v120, v216
 v_mul_f32 v153, v113, v217
 v_mul_f32 v161, v121, v217
 v_mul_f32 v154, v114, v218
 v_mul_f32 v162, v122, v218
 v_mul_f32 v155, v115, v219
 v_mul_f32 v163, v123, v219
 v_mul_f32 v156, v116, v220
 v_mul_f32 v164, v124, v220
 v_mul_f32 v157, v117, v221
 v_mul_f32 v165, v125, v221
 v_mul_f32 v158, v118, v222
 v_mul_f32 v166, v126, v222
 v_mul_f32 v159, v119, v223
 v_mul_f32 v167, v127, v223
 v_fma_f32 v152, v120, v224, v152
 v_fma_f32 v160, -v112, v224, v160
 v_fma_f32 v153, v121, v225, v153
 v_fma_f32 v161, -v113, v225, v161
 v_fma_f32 v154, v122, v226, v154
 v_fma_f32 v162, -v114, v226, v162
 v_fma_f32 v155, v123, v227, v155
 v_fma_f32 v163, -v115, v227, v163
 v_fma_f32 v156, v124, v228, v156
 v_fma_f32 v164, -v116, v228, v164
 v_fma_f32 v157, v125, v229, v157
 v_fma_f32 v165, -v117, v229, v165
 v_fma_f32 v158, v126, v230, v158
 v_fma_f32 v166, -v118, v230, v166
 v_fma_f32 v159, v127, v231, v159
 v_fma_f32 v167, -v119, v231, v167
 v_cvt_pk_bf16_f32 v128, v152, v153
 v_cvt_pk_bf16_f32 v132, v160, v161
 v_cvt_pk_bf16_f32 v129, v154, v155
 v_cvt_pk_bf16_f32 v133, v162, v163
 v_cvt_pk_bf16_f32 v130, v156, v157
 v_cvt_pk_bf16_f32 v134, v164, v165
 v_cvt_pk_bf16_f32 v131, v158, v159
 v_cvt_pk_bf16_f32 v135, v166, v167
 s_nop 0
 v_mfma_f32_16x16x32_bf16 v[112:115], v[192:195], v[128:131], 0
 v_mfma_f32_16x16x32_bf16 v[120:123], v[200:203], v[128:131], 0
 v_mfma_f32_16x16x32_bf16 v[116:119], v[196:199], v[128:131], 0
 v_mfma_f32_16x16x32_bf16 v[124:127], v[204:207], v[128:131], 0
 v_mfma_f32_16x16x32_bf16 v[112:115], v[208:211], v[132:135], v[112:115]
 v_mfma_f32_16x16x32_bf16 v[120:123], v[192:195], v[132:135], v[120:123]
 v_mfma_f32_16x16x32_bf16 v[116:119], v[212:215], v[132:135], v[116:119]
 v_mfma_f32_16x16x32_bf16 v[124:127], v[196:199], v[132:135], v[124:127]
 s_waitcnt vmcnt(0)
 v_lshlrev_b32 v80, 16, v136
 v_and_b32 v88, 0xffff0000, v136
 v_lshlrev_b32 v81, 16, v137
 v_and_b32 v89, 0xffff0000, v137
 v_lshlrev_b32 v82, 16, v138
 v_and_b32 v90, 0xffff0000, v138
 v_lshlrev_b32 v83, 16, v139
 v_and_b32 v91, 0xffff0000, v139
 v_lshlrev_b32 v84, 16, v140
 v_and_b32 v92, 0xffff0000, v140
 v_lshlrev_b32 v85, 16, v141
 v_and_b32 v93, 0xffff0000, v141
 v_lshlrev_b32 v86, 16, v142
 v_and_b32 v94, 0xffff0000, v142
 v_lshlrev_b32 v87, 16, v143
 v_and_b32 v95, 0xffff0000, v143
 v_mul_f32 v152, v112, v80
 v_mul_f32 v160, v120, v80
 v_mul_f32 v153, v113, v81
 v_mul_f32 v161, v121, v81
 v_mul_f32 v154, v114, v82
 v_mul_f32 v162, v122, v82
 v_mul_f32 v155, v115, v83
 v_mul_f32 v163, v123, v83
 v_mul_f32 v156, v116, v84
 v_mul_f32 v164, v124, v84
 v_mul_f32 v157, v117, v85
 v_mul_f32 v165, v125, v85
 v_mul_f32 v158, v118, v86
 v_mul_f32 v166, v126, v86
 v_mul_f32 v159, v119, v87
 v_mul_f32 v167, v127, v87
 v_fma_f32 v152, -v120, v88, v152
 v_fma_f32 v160, v112, v88, v160
 v_fma_f32 v153, -v121, v89, v153
 v_fma_f32 v161, v113, v89, v161
 v_fma_f32 v154, -v122, v90, v154
 v_fma_f32 v162, v114, v90, v162
 v_fma_f32 v155, -v123, v91, v155
 v_fma_f32 v163, v115, v91, v163
 v_fma_f32 v156, -v124, v92, v156
 v_fma_f32 v164, v116, v92, v164
 v_fma_f32 v157, -v125, v93, v157
 v_fma_f32 v165, v117, v93, v165
 v_fma_f32 v158, -v126, v94, v158
 v_fma_f32 v166, v118, v94, v166
 v_fma_f32 v159, -v127, v95, v159
 v_fma_f32 v167, v119, v95, v167
 v_cvt_pk_bf16_f32 v128, v152, v153
 v_cvt_pk_bf16_f32 v132, v160, v161
 v_cvt_pk_bf16_f32 v129, v154, v155
 v_cvt_pk_bf16_f32 v133, v162, v163
 v_cvt_pk_bf16_f32 v130, v156, v157
 v_cvt_pk_bf16_f32 v134, v164, v165
 v_cvt_pk_bf16_f32 v131, v158, v159
 v_cvt_pk_bf16_f32 v135, v166, v167
 s_nop 0
 v_mfma_f32_16x16x32_bf16 v[112:115], v[192:195], v[128:131], 0
 v_mfma_f32_16x16x32_bf16 v[120:123], v[208:211], v[128:131], 0
 v_mfma_f32_16x16x32_bf16 v[116:119], v[196:199], v[128:131], 0
 v_mfma_f32_16x16x32_bf16 v[124:127], v[212:215], v[128:131], 0
 v_mfma_f32_16x16x32_bf16 v[112:115], v[200:203], v[132:135], v[112:115]
 v_mfma_f32_16x16x32_bf16 v[120:123], v[192:195], v[132:135], v[120:123]
 v_mfma_f32_16x16x32_bf16 v[116:119], v[204:207], v[132:135], v[116:119]
 v_mfma_f32_16x16x32_bf16 v[124:127], v[196:199], v[132:135], v[124:127]
 v_mul_f32 v152, v112, v216
 v_mul_f32 v160, v120, v216
 v_mul_f32 v153, v113, v217
 v_mul_f32 v161, v121, v217
 v_mul_f32 v154, v114, v218
 v_mul_f32 v162, v122, v218
 v_mul_f32 v155, v115, v219
 v_mul_f32 v163, v123, v219
 v_mul_f32 v156, v116, v220
 v_mul_f32 v164, v124, v220
 v_mul_f32 v157, v117, v221
 v_mul_f32 v165, v125, v221
 v_mul_f32 v158, v118, v222
 v_mul_f32 v166, v126, v222
 v_mul_f32 v159, v119, v223
 v_mul_f32 v167, v127, v223
 v_fma_f32 v152, -v120, v224, v152
 v_fma_f32 v160, v112, v224, v160
 v_fma_f32 v153, -v121, v225, v153
 v_fma_f32 v161, v113, v225, v161
 v_fma_f32 v154, -v122, v226, v154
 v_fma_f32 v162, v114, v226, v162
 v_fma_f32 v155, -v123, v227, v155
 v_fma_f32 v163, v115, v227, v163
 v_fma_f32 v156, -v124, v228, v156
 v_fma_f32 v164, v116, v228, v164
 v_fma_f32 v157, -v125, v229, v157
 v_fma_f32 v165, v117, v229, v165
 v_fma_f32 v158, -v126, v230, v158
 v_fma_f32 v166, v118, v230, v166
 v_fma_f32 v159, -v127, v231, v159
 v_fma_f32 v167, v119, v231, v167
 v_cvt_pk_bf16_f32 v128, v152, v153
 v_cvt_pk_bf16_f32 v132, v160, v161
 v_cvt_pk_bf16_f32 v129, v154, v155
 v_cvt_pk_bf16_f32 v133, v162, v163
 v_cvt_pk_bf16_f32 v130, v156, v157
 v_cvt_pk_bf16_f32 v134, v164, v165
 v_cvt_pk_bf16_f32 v131, v158, v159
 v_cvt_pk_bf16_f32 v135, v166, v167
 ds_write_b128 v6, v[128:131]
 ds_write_b128 v6, v[132:135] offset:4096
 s_waitcnt lgkmcnt(0)
 s_barrier
 ds_read_b64_tr_b16 v[80:81], v5 offset:8192
 ds_read_b64_tr_b16 v[82:83], v5 offset:8448
 ds_read_b64_tr_b16 v[84:85], v5 offset:10240
 ds_read_b64_tr_b16 v[86:87], v5 offset:10496
 ds_read_b64_tr_b16 v[88:89], v5 offset:8200
 ds_read_b64_tr_b16 v[90:91], v5 offset:8456
 ds_read_b64_tr_b16 v[92:93], v5 offset:10248
 ds_read_b64_tr_b16 v[94:95], v5 offset:10504
 ds_read_b64_tr_b16 v[96:97], v5 offset:12288
 ds_read_b64_tr_b16 v[98:99], v5 offset:12544
 ds_read_b64_tr_b16 v[100:101], v5 offset:14336
 ds_read_b64_tr_b16 v[102:103], v5 offset:14592
 ds_read_b64_tr_b16 v[104:105], v5 offset:12296
 ds_read_b64_tr_b16 v[106:107], v5 offset:12552
 ds_read_b64_tr_b16 v[108:109], v5 offset:14344
 ds_read_b64_tr_b16 v[110:111], v5 offset:14600
 s_waitcnt lgkmcnt(0)
 v_mfma_f32_16x16x32_bf16 v[112:115], v[80:83], v[168:171], 0
 v_mfma_f32_16x16x32_bf16 v[120:123], v[80:83], v[184:187], 0
 v_mfma_f32_16x16x32_bf16 v[112:115], v[84:87], v[172:175], v[112:115]
 v_mfma_f32_16x16x32_bf16 v[120:123], v[84:87], v[188:191], v[120:123]
 v_mfma_f32_16x16x32_bf16 v[116:119], v[88:91], v[168:171], 0
 v_mfma_f32_16x16x32_bf16 v[124:127], v[88:91], v[184:187], 0
 v_mfma_f32_16x16x32_bf16 v[116:119], v[92:95], v[172:175], v[116:119]
 v_mfma_f32_16x16x32_bf16 v[124:127], v[92:95], v[188:191], v[124:127]
 v_mfma_f32_16x16x32_bf16 v[112:115], v[96:99], v[176:179], v[112:115]
 v_mfma_f32_16x16x32_bf16 v[120:123], v[96:99], v[168:171], v[120:123]
 v_mfma_f32_16x16x32_bf16 v[112:115], v[100:103], v[180:183], v[112:115]
 v_mfma_f32_16x16x32_bf16 v[120:123], v[100:103], v[172:175], v[120:123]
 v_mfma_f32_16x16x32_bf16 v[116:119], v[104:107], v[176:179], v[116:119]
 v_mfma_f32_16x16x32_bf16 v[124:127], v[104:107], v[168:171], v[124:127]
 v_mfma_f32_16x16x32_bf16 v[116:119], v[108:111], v[180:183], v[116:119]
 v_mfma_f32_16x16x32_bf16 v[124:127], v[108:111], v[172:175], v[124:127]
 v_lshlrev_b32 v10, 6, v9
 v_lshl_add_u32 v10, v8, 4, v10
 s_lshl_b32 s8, s47, 12
 v_add_u32 v3, s8, v10
 v_add_u32 v11, 917504, v3
 v_cmp_eq_u32 vcc, 1073741824, v4
 s_nop 1
 v_cndmask_b32 v4, v11, v4, vcc
 v_cvt_pk_bf16_f32 v128, v112, v113
 v_cvt_pk_bf16_f32 v132, v120, v121
 v_cvt_pk_bf16_f32 v129, v114, v115
 v_cvt_pk_bf16_f32 v133, v122, v123
 v_cvt_pk_bf16_f32 v130, v116, v117
 v_cvt_pk_bf16_f32 v134, v124, v125
 v_cvt_pk_bf16_f32 v131, v118, v119
 v_cvt_pk_bf16_f32 v135, v126, v127
 v_min_u32 v128, -2, v128
 v_min_u32 v132, -2, v132
 buffer_store_dwordx4 v[128:131], v3, s[20:23], 0 offen sc1
 buffer_store_dwordx4 v[132:135], v4, s[20:23], 0 offen sc1
 s_barrier
 s_cmp_eq_u32 s91, -1
 s_cbranch_scc1 ka_again
 s_branch ka_b4_150
ka_b3_144:
 s_cmp_eq_u32 s91, -1
 s_cbranch_scc1 ka_again
 v_and_b32 v1, 63, v0
 v_lshlrev_b32 v2, 4, v1
 s_cmp_lg_u32 s6, 0
 s_cbranch_scc1 ka_wk_152
 s_mov_b32 s50, 0
ka_wl_151:
 s_mov_b32 s51, 21504
 buffer_load_dwordx4 v[12:15], v2, s[52:55], s51 offen sc1
 s_waitcnt vmcnt(0)
 v_min_u32 v12, v12, v13
 v_min3_u32 v12, v12, v14, v15
 v_cmp_eq_u32 vcc, 0, v12
 s_cbranch_vccz ka_wk_152
 s_add_u32 s50, s50, 1
 s_cmp_lt_u32 s50, 400000
 s_cbranch_scc0 ka_end
 s_mov_b64 exec, vcc
 s_sleep 2
 s_branch ka_wl_151
ka_wk_152:
 s_mov_b64 exec, -1
 s_barrier
ka_b4_150:
ka_b3_top:
 s_add_u32 s20, s76, 68911104
 s_addc_u32 s21, s77, 0
 s_mov_b32 s22, 1835008
 s_mov_b32 s23, 0x20000
 s_add_u32 s8, s4, 13647872
 s_addc_u32 s9, s5, 0
 s_add_u32 s24, s4, 17317888
 s_addc_u32 s25, s5, 0
 s_cmp_eq_u32 s3, 0
 s_cselect_b32 s24, s8, s24
 s_cselect_b32 s25, s9, s25
 s_mov_b32 s26, 1835008
 s_mov_b32 s27, 0x20000
 v_and_b32 v1, 63, v0
 v_lshlrev_b32 v2, 4, v1
 v_and_b32 v7, 15, v1
 v_lshrrev_b32 v8, 4, v1

 v_lshrrev_b32 v11, 2, v1
 s_mul_i32 s8, s6, 112
 v_add_u32 v11, s8, v11
 v_lshlrev_b32 v11, 12, v11
 v_and_b32 v12, 3, v1
 v_lshl_add_u32 v11, v12, 4, v11
 s_lshl_b32 s8, s43, 6
 v_add_u32 v6, s8, v11

 v_lshrrev_b32 v11, 2, v7
 v_lshlrev_b32 v11, 3, v11
 v_and_b32 v12, 3, v7
 v_add_u32 v11, v11, v12
 s_lshl_b32 s8, s43, 5
 v_add_u32 v11, s8, v11
 v_mul_u32_u24 v11, 896, v11
 s_cmp_eq_u32 s6, 3
 s_cselect_b32 s9, 3, 4
 v_lshlrev_b32 v12, s9, v8
 v_add_u32 v11, v11, v12
 s_lshl_b32 s8, s45, 6
 s_lshl_b32 s9, s42, 5
 s_add_u32 s8, s8, s9
 v_add_u32 v4, s8, v11
 v_add_u32 v5, 3584, v4

 s_load_dwordx2 s[8:9], s[0:1], 80
 s_add_u32 s28, s4, 15482880
 s_addc_u32 s29, s5, 0
 v_lshrrev_b32 v11, 2, v7
 v_lshl_add_u32 v11, v8, 3, v11
 v_lshlrev_b32 v11, 6, v11
 v_and_b32 v12, 3, v7
 v_lshl_add_u32 v3, v12, 4, v11
 s_waitcnt lgkmcnt(0)
 s_cmp_eq_u32 s3, 0
 s_cselect_b32 s28, s28, s8
 s_cselect_b32 s29, s29, s9
 s_mov_b32 s30, 1835008
 s_mov_b32 s31, 0x20000
 s_add_u32 s32, s4, 70844416
 s_addc_u32 s33, s5, 0
 s_mov_b32 s34, 1835008
 s_mov_b32 s35, 0x20000
 s_add_u32 s36, s4, 23887872
 s_addc_u32 s37, s5, 0
 s_mov_b32 s38, 262144
 s_mov_b32 s39, 0x20000
 s_add_u32 s52, s76, 70758400
 s_addc_u32 s53, s77, 0
 s_mov_b32 s54, 32768
 s_mov_b32 s55, 0x20000
 buffer_load_dwordx4 v[52:55], v4, s[24:27], 0 offen sc1
 buffer_load_dwordx4 v[56:59], v5, s[24:27], 0 offen sc1
 s_mul_i32 s8, s6, 7168
 v_add_u32 v11, s8, v2
 v_mov_b32 v136, v6
 v_add_u32 v137, 65536, v6
 v_add_u32 v138, 131072, v6
 v_add_u32 v139, 196608, v6
 v_add_u32 v140, 262144, v6
 v_add_u32 v141, 327680, v6
 v_add_u32 v142, 393216, v6
 s_mov_b32 s50, 0
ka_dl_153:
 buffer_load_dwordx4 v[108:111], v136, s[20:23], 0 offen sc1
 buffer_load_dwordx4 v[112:115], v137, s[20:23], 0 offen sc1
 buffer_load_dwordx4 v[116:119], v138, s[20:23], 0 offen sc1
 buffer_load_dwordx4 v[120:123], v139, s[20:23], 0 offen sc1
 buffer_load_dwordx4 v[124:127], v140, s[20:23], 0 offen sc1
 buffer_load_dwordx4 v[128:131], v141, s[20:23], 0 offen sc1
 buffer_load_dwordx4 v[132:135], v142, s[20:23], 0 offen sc1
 s_waitcnt vmcnt(0)
 v_max3_u32 v92, v108, v112, v116
 v_max3_u32 v93, v120, v124, v128
 v_max3_u32 v94, v92, v93, v132
 v_cmp_eq_u32 vcc, -1, v94
 s_cbranch_vccz ka_dk_154
 s_add_u32 s50, s50, 1
 s_cmp_lt_u32 s50, 400000
 s_cbranch_scc0 ka_end
 s_mov_b64 exec, vcc
 s_sleep 2
 s_branch ka_dl_153
ka_dk_154:
 s_mov_b64 exec, -1
 ds_write_b128 v11, v[108:111] offset:0
 ds_write_b128 v11, v[112:115] offset:1024
 ds_write_b128 v11, v[116:119] offset:2048
 ds_write_b128 v11, v[120:123] offset:3072
 ds_write_b128 v11, v[124:127] offset:4096
 ds_write_b128 v11, v[128:131] offset:5120
 ds_write_b128 v11, v[132:135] offset:6144
 s_waitcnt lgkmcnt(0)
 s_barrier
 ds_read_b64_tr_b16 v[20:21], v3 offset:0
 ds_read_b64_tr_b16 v[22:23], v3 offset:256
 ds_read_b64_tr_b16 v[24:25], v3 offset:8
 ds_read_b64_tr_b16 v[26:27], v3 offset:264
 ds_read_b64_tr_b16 v[28:29], v3 offset:2048
 ds_read_b64_tr_b16 v[30:31], v3 offset:2304
 ds_read_b64_tr_b16 v[32:33], v3 offset:2056
 ds_read_b64_tr_b16 v[34:35], v3 offset:2312
 s_waitcnt lgkmcnt(4)
 v_mfma_f32_16x16x32_bf16 v[36:39], a[112:115], v[20:23], 0
 v_mfma_f32_16x16x32_bf16 v[40:43], a[112:115], v[24:27], 0
 v_mfma_f32_16x16x32_bf16 v[44:47], a[116:119], v[20:23], 0
 v_mfma_f32_16x16x32_bf16 v[48:51], a[116:119], v[24:27], 0
 ds_read_b64_tr_b16 v[20:21], v3 offset:4096
 ds_read_b64_tr_b16 v[22:23], v3 offset:4352
 ds_read_b64_tr_b16 v[24:25], v3 offset:4104
 ds_read_b64_tr_b16 v[26:27], v3 offset:4360
 s_waitcnt lgkmcnt(4)
 v_mfma_f32_16x16x32_bf16 v[36:39], a[120:123], v[28:31], v[36:39]
 v_mfma_f32_16x16x32_bf16 v[40:43], a[120:123], v[32:35], v[40:43]
 v_mfma_f32_16x16x32_bf16 v[44:47], a[124:127], v[28:31], v[44:47]
 v_mfma_f32_16x16x32_bf16 v[48:51], a[124:127], v[32:35], v[48:51]
 ds_read_b64_tr_b16 v[28:29], v3 offset:6144
 ds_read_b64_tr_b16 v[30:31], v3 offset:6400
 ds_read_b64_tr_b16 v[32:33], v3 offset:6152
 ds_read_b64_tr_b16 v[34:35], v3 offset:6408
 s_waitcnt lgkmcnt(4)
 v_mfma_f32_16x16x32_bf16 v[36:39], a[128:131], v[20:23], v[36:39]
 v_mfma_f32_16x16x32_bf16 v[40:43], a[128:131], v[24:27], v[40:43]
 v_mfma_f32_16x16x32_bf16 v[44:47], a[132:135], v[20:23], v[44:47]
 v_mfma_f32_16x16x32_bf16 v[48:51], a[132:135], v[24:27], v[48:51]
 ds_read_b64_tr_b16 v[20:21], v3 offset:8192
 ds_read_b64_tr_b16 v[22:23], v3 offset:8448
 ds_read_b64_tr_b16 v[24:25], v3 offset:8200
 ds_read_b64_tr_b16 v[26:27], v3 offset:8456
 s_waitcnt lgkmcnt(4)
 v_mfma_f32_16x16x32_bf16 v[36:39], a[136:139], v[28:31], v[36:39]
 v_mfma_f32_16x16x32_bf16 v[40:43], a[136:139], v[32:35], v[40:43]
 v_mfma_f32_16x16x32_bf16 v[44:47], a[140:143], v[28:31], v[44:47]
 v_mfma_f32_16x16x32_bf16 v[48:51], a[140:143], v[32:35], v[48:51]
 ds_read_b64_tr_b16 v[28:29], v3 offset:10240
 ds_read_b64_tr_b16 v[30:31], v3 offset:10496
 ds_read_b64_tr_b16 v[32:33], v3 offset:10248
 ds_read_b64_tr_b16 v[34:35], v3 offset:10504
 s_waitcnt lgkmcnt(4)
 v_mfma_f32_16x16x32_bf16 v[36:39], a[144:147], v[20:23], v[36:39]
 v_mfma_f32_16x16x32_bf16 v[40:43], a[144:147], v[24:27], v[40:43]
 v_mfma_f32_16x16x32_bf16 v[44:47], a[148:151], v[20:23], v[44:47]
 v_mfma_f32_16x16x32_bf16 v[48:51], a[148:151], v[24:27], v[48:51]
 ds_read_b64_tr_b16 v[20:21], v3 offset:12288
 ds_read_b64_tr_b16 v[22:23], v3 offset:12544
 ds_read_b64_tr_b16 v[24:25], v3 offset:12296
 ds_read_b64_tr_b16 v[26:27], v3 offset:12552
 s_waitcnt lgkmcnt(4)
 v_mfma_f32_16x16x32_bf16 v[36:39], a[152:155], v[28:31], v[36:39]
 v_mfma_f32_16x16x32_bf16 v[40:43], a[152:155], v[32:35], v[40:43]
 v_mfma_f32_16x16x32_bf16 v[44:47], a[156:159], v[28:31], v[44:47]
 v_mfma_f32_16x16x32_bf16 v[48:51], a[156:159], v[32:35], v[48:51]
 ds_read_b64_tr_b16 v[28:29], v3 offset:14336
 ds_read_b64_tr_b16 v[30:31], v3 offset:14592
 ds_read_b64_tr_b16 v[32:33], v3 offset:14344
 ds_read_b64_tr_b16 v[34:35], v3 offset:14600
 s_waitcnt lgkmcnt(4)
 v_mfma_f32_16x16x32_bf16 v[36:39], a[160:163], v[20:23], v[36:39]
 v_mfma_f32_16x16x32_bf16 v[40:43], a[160:163], v[24:27], v[40:43]
 v_mfma_f32_16x16x32_bf16 v[44:47], a[164:167], v[20:23], v[44:47]
 v_mfma_f32_16x16x32_bf16 v[48:51], a[164:167], v[24:27], v[48:51]
 ds_read_b64_tr_b16 v[20:21], v3 offset:16384
 ds_read_b64_tr_b16 v[22:23], v3 offset:16640
 ds_read_b64_tr_b16 v[24:25], v3 offset:16392
 ds_read_b64_tr_b16 v[26:27], v3 offset:16648
 s_waitcnt lgkmcnt(4)
 v_mfma_f32_16x16x32_bf16 v[36:39], a[168:171], v[28:31], v[36:39]
 v_mfma_f32_16x16x32_bf16 v[40:43], a[168:171], v[32:35], v[40:43]
 v_mfma_f32_16x16x32_bf16 v[44:47], a[172:175], v[28:31], v[44:47]
 v_mfma_f32_16x16x32_bf16 v[48:51], a[172:175], v[32:35], v[48:51]
 ds_read_b64_tr_b16 v[28:29], v3 offset:18432
 ds_read_b64_tr_b16 v[30:31], v3 offset:18688
 ds_read_b64_tr_b16 v[32:33], v3 offset:18440
 ds_read_b64_tr_b16 v[34:35], v3 offset:18696
 s_waitcnt lgkmcnt(4)
 v_mfma_f32_16x16x32_bf16 v[36:39], a[176:179], v[20:23], v[36:39]
 v_mfma_f32_16x16x32_bf16 v[40:43], a[176:179], v[24:27], v[40:43]
 v_mfma_f32_16x16x32_bf16 v[44:47], a[180:183], v[20:23], v[44:47]
 v_mfma_f32_16x16x32_bf16 v[48:51], a[180:183], v[24:27], v[48:51]
 ds_read_b64_tr_b16 v[20:21], v3 offset:20480
 ds_read_b64_tr_b16 v[22:23], v3 offset:20736
 ds_read_b64_tr_b16 v[24:25], v3 offset:20488
 ds_read_b64_tr_b16 v[26:27], v3 offset:20744
 s_waitcnt lgkmcnt(4)
 v_mfma_f32_16x16x32_bf16 v[36:39], a[184:187], v[28:31], v[36:39]
 v_mfma_f32_16x16x32_bf16 v[40:43], a[184:187], v[32:35], v[40:43]
 v_mfma_f32_16x16x32_bf16 v[44:47], a[188:191], v[28:31], v[44:47]
 v_mfma_f32_16x16x32_bf16 v[48:51], a[188:191], v[32:35], v[48:51]
 ds_read_b64_tr_b16 v[28:29], v3 offset:22528
 ds_read_b64_tr_b16 v[30:31], v3 offset:22784
 ds_read_b64_tr_b16 v[32:33], v3 offset:22536
 ds_read_b64_tr_b16 v[34:35], v3 offset:22792
 s_waitcnt lgkmcnt(4)
 v_mfma_f32_16x16x32_bf16 v[36:39], a[192:195], v[20:23], v[36:39]
 v_mfma_f32_16x16x32_bf16 v[40:43], a[192:195], v[24:27], v[40:43]
 v_mfma_f32_16x16x32_bf16 v[44:47], a[196:199], v[20:23], v[44:47]
 v_mfma_f32_16x16x32_bf16 v[48:51], a[196:199], v[24:27], v[48:51]
 ds_read_b64_tr_b16 v[20:21], v3 offset:24576
 ds_read_b64_tr_b16 v[22:23], v3 offset:24832
 ds_read_b64_tr_b16 v[24:25], v3 offset:24584
 ds_read_b64_tr_b16 v[26:27], v3 offset:24840
 s_waitcnt lgkmcnt(4)
 v_mfma_f32_16x16x32_bf16 v[36:39], a[200:203], v[28:31], v[36:39]
 v_mfma_f32_16x16x32_bf16 v[40:43], a[200:203], v[32:35], v[40:43]
 v_mfma_f32_16x16x32_bf16 v[44:47], a[204:207], v[28:31], v[44:47]
 v_mfma_f32_16x16x32_bf16 v[48:51], a[204:207], v[32:35], v[48:51]
 ds_read_b64_tr_b16 v[28:29], v3 offset:26624
 ds_read_b64_tr_b16 v[30:31], v3 offset:26880
 ds_read_b64_tr_b16 v[32:33], v3 offset:26632
 ds_read_b64_tr_b16 v[34:35], v3 offset:26888
 s_waitcnt lgkmcnt(4)
 v_mfma_f32_16x16x32_bf16 v[36:39], a[208:211], v[20:23], v[36:39]
 v_mfma_f32_16x16x32_bf16 v[40:43], a[208:211], v[24:27], v[40:43]
 v_mfma_f32_16x16x32_bf16 v[44:47], a[212:215], v[20:23], v[44:47]
 v_mfma_f32_16x16x32_bf16 v[48:51], a[212:215], v[24:27], v[48:51]
 s_waitcnt lgkmcnt(0)
 v_mfma_f32_16x16x32_bf16 v[36:39], a[216:219], v[28:31], v[36:39]
 v_mfma_f32_16x16x32_bf16 v[40:43], a[216:219], v[32:35], v[40:43]
 v_mfma_f32_16x16x32_bf16 v[44:47], a[220:223], v[28:31], v[44:47]
 v_mfma_f32_16x16x32_bf16 v[48:51], a[220:223], v[32:35], v[48:51]
 s_waitcnt vmcnt(0)
 s_cmp_eq_u32 s6, 3
 s_cbranch_scc1 ka_w3_155
 v_lshlrev_b32 v92, 16, v52
 v_and_b32 v93, 0xffff0000, v52
 v_lshlrev_b32 v94, 16, v53
 v_and_b32 v95, 0xffff0000, v53
 v_add_f32 v36, v36, v92
 v_add_f32 v37, v37, v93
 v_add_f32 v38, v38, v94
 v_add_f32 v39, v39, v95
 v_cvt_pk_bf16_f32 v52, v36, v37
 v_cvt_pk_bf16_f32 v53, v38, v39
 v_lshlrev_b32 v92, 16, v54
 v_and_b32 v93, 0xffff0000, v54
 v_lshlrev_b32 v94, 16, v55
 v_and_b32 v95, 0xffff0000, v55
 v_add_f32 v44, v44, v92
 v_add_f32 v45, v45, v93
 v_add_f32 v46, v46, v94
 v_add_f32 v47, v47, v95
 v_cvt_pk_bf16_f32 v54, v44, v45
 v_cvt_pk_bf16_f32 v55, v46, v47
 v_lshlrev_b32 v92, 16, v56
 v_and_b32 v93, 0xffff0000, v56
 v_lshlrev_b32 v94, 16, v57
 v_and_b32 v95, 0xffff0000, v57
 v_add_f32 v40, v40, v92
 v_add_f32 v41, v41, v93
 v_add_f32 v42, v42, v94
 v_add_f32 v43, v43, v95
 v_cvt_pk_bf16_f32 v56, v40, v41
 v_cvt_pk_bf16_f32 v57, v42, v43
 v_lshlrev_b32 v92, 16, v58
 v_and_b32 v93, 0xffff0000, v58
 v_lshlrev_b32 v94, 16, v59
 v_and_b32 v95, 0xffff0000, v59
 v_add_f32 v48, v48, v92
 v_add_f32 v49, v49, v93
 v_add_f32 v50, v50, v94
 v_add_f32 v51, v51, v95
 v_cvt_pk_bf16_f32 v58, v48, v49
 v_cvt_pk_bf16_f32 v59, v50, v51
 s_cmp_eq_u32 s3, 0
 s_cbranch_scc1 ka_l0_156
 buffer_store_dwordx4 v[52:55], v4, s[28:31], 0 offen sc1
 buffer_store_dwordx4 v[56:59], v5, s[28:31], 0 offen sc1
 s_branch ka_b3_fin
ka_l0_156:
 v_lshlrev_b32 v60, 16, v52
 v_and_b32 v61, 0xffff0000, v52
 v_lshlrev_b32 v62, 16, v53
 v_and_b32 v63, 0xffff0000, v53
 v_lshlrev_b32 v64, 16, v54
 v_and_b32 v65, 0xffff0000, v54
 v_lshlrev_b32 v66, 16, v55
 v_and_b32 v67, 0xffff0000, v55
 v_lshlrev_b32 v68, 16, v56
 v_and_b32 v69, 0xffff0000, v56
 v_lshlrev_b32 v70, 16, v57
 v_and_b32 v71, 0xffff0000, v57
 v_lshlrev_b32 v72, 16, v58
 v_and_b32 v73, 0xffff0000, v58
 v_lshlrev_b32 v74, 16, v59
 v_and_b32 v75, 0xffff0000, v59
 v_add_f32 v100, v60, v61
 v_add_f32 v92, v62, v63
 v_add_f32 v94, v64, v65
 v_add_f32 v96, v66, v67
 v_add_f32 v92, v92, v94
 v_add_f32 v100, v100, v96
 v_add_f32 v100, v100, v92
 v_add_f32 v102, v68, v69
 v_add_f32 v93, v70, v71
 v_add_f32 v95, v72, v73
 v_add_f32 v97, v74, v75
 v_add_f32 v93, v93, v95
 v_add_f32 v102, v102, v97
 v_add_f32 v102, v102, v93
 v_mov_b32 v92, v100
 s_nop 1
 v_permlane16_swap_b32 v100, v92
 v_add_f32 v100, v100, v92
 v_mov_b32 v92, v100
 s_nop 1
 v_permlane32_swap_b32 v100, v92
 v_add_f32 v100, v100, v92
 v_mov_b32 v93, v102
 s_nop 1
 v_permlane16_swap_b32 v102, v93
 v_add_f32 v102, v102, v93
 v_mov_b32 v93, v102
 s_nop 1
 v_permlane32_swap_b32 v102, v93
 v_add_f32 v102, v102, v93
 v_mul_f32 v92, 0xbd000000, v100
 v_add_f32 v94, v60, v92
 v_mul_f32 v101, v94, v94
 v_add_f32 v94, v61, v92
 v_fmac_f32 v101, v94, v94
 v_add_f32 v94, v62, v92
 v_fmac_f32 v101, v94, v94
 v_add_f32 v94, v63, v92
 v_fmac_f32 v101, v94, v94
 v_add_f32 v94, v64, v92
 v_fmac_f32 v101, v94, v94
 v_add_f32 v94, v65, v92
 v_fmac_f32 v101, v94, v94
 v_add_f32 v94, v66, v92
 v_fmac_f32 v101, v94, v94
 v_add_f32 v94, v67, v92
 v_fmac_f32 v101, v94, v94
 v_mul_f32 v93, 0xbd000000, v102
 v_add_f32 v95, v68, v93
 v_mul_f32 v103, v95, v95
 v_add_f32 v95, v69, v93
 v_fmac_f32 v103, v95, v95
 v_add_f32 v95, v70, v93
 v_fmac_f32 v103, v95, v95
 v_add_f32 v95, v71, v93
 v_fmac_f32 v103, v95, v95
 v_add_f32 v95, v72, v93
 v_fmac_f32 v103, v95, v95
 v_add_f32 v95, v73, v93
 v_fmac_f32 v103, v95, v95
 v_add_f32 v95, v74, v93
 v_fmac_f32 v103, v95, v95
 v_add_f32 v95, v75, v93
 v_fmac_f32 v103, v95, v95
 v_mov_b32 v92, v101
 s_nop 1
 v_permlane16_swap_b32 v101, v92
 v_add_f32 v101, v101, v92
 v_mov_b32 v92, v101
 s_nop 1
 v_permlane32_swap_b32 v101, v92
 v_add_f32 v101, v101, v92
 v_mov_b32 v93, v103
 s_nop 1
 v_permlane16_swap_b32 v103, v93
 v_add_f32 v103, v103, v93
 v_mov_b32 v93, v103
 s_nop 1
 v_permlane32_swap_b32 v103, v93
 v_add_f32 v103, v103, v93
 v_min_u32 v101, -2, v101
 v_min_u32 v103, -2, v103
 v_cmp_eq_u32 vcc, 1, v8
 s_nop 1
 v_cndmask_b32 v92, v100, v102, vcc
 v_cndmask_b32 v93, v101, v103, vcc
 s_lshl_b32 s9, s44, 2
 s_add_u32 s9, s9, s6
 s_lshl_b32 s9, s9, 8
 s_lshl_b32 s10, s43, 12
 s_add_u32 s9, s9, s10
 v_lshlrev_b32 v11, 4, v7
 v_lshl_add_u32 v11, v8, 3, v11
 v_mov_b32 v12, 1073741824
 v_cmp_gt_u32 vcc, 2, v8
 s_nop 1
 v_cndmask_b32 v11, v12, v11, vcc
 buffer_store_dwordx2 v[92:93], v11, s[36:39], s9 offen sc0 sc1
 s_mov_b32 s46, 0
ka_sp_157:
 buffer_load_dwordx4 v[76:79], v2, s[36:39], s10 offen offset:0 sc0 sc1
 buffer_load_dwordx4 v[80:83], v2, s[36:39], s10 offen offset:1024 sc0 sc1
 buffer_load_dwordx4 v[84:87], v2, s[36:39], s10 offen offset:2048 sc0 sc1
 buffer_load_dwordx4 v[88:91], v2, s[36:39], s10 offen offset:3072 sc0 sc1
 s_waitcnt vmcnt(0)
 v_max3_u32 v92, v77, v79, v81
 v_max3_u32 v93, v83, v85, v87
 v_max3_u32 v92, v92, v89, v91
 v_max_u32 v92, v92, v93
 v_cmp_eq_u32 vcc, -1, v92
 s_cbranch_vccz ka_sk_158
 s_add_u32 s46, s46, 1
 s_cmp_lt_u32 s46, 400000
 s_cbranch_scc0 ka_end
 s_branch ka_sp_157
ka_sk_158:
 buffer_store_dwordx4 v[52:55], v4, s[28:31], 0 offen sc1
 buffer_store_dwordx4 v[56:59], v5, s[28:31], 0 offen sc1
 v_cmp_eq_u32 vcc, 3, v8
 v_mov_b32 v104, 0x42000000
 v_mov_b32 v92, 0x41800000
 v_cndmask_b32 v104, v104, v92, vcc
 v_mov_b32 v105, 0x3d000000
 v_mov_b32 v92, 0x3d800000
 v_cndmask_b32 v105, v105, v92, vcc
 v_add_f32 v100, v76, v80
 v_add_f32 v92, v84, v88
 v_add_f32 v100, v100, v92
 v_add_f32 v102, v78, v82
 v_add_f32 v93, v86, v90
 v_add_f32 v102, v102, v93
 v_mov_b32 v92, v100
 s_nop 1
 v_permlane16_swap_b32 v100, v92
 v_add_f32 v100, v100, v92
 v_mov_b32 v92, v100
 s_nop 1
 v_permlane32_swap_b32 v100, v92
 v_add_f32 v100, v100, v92
 v_mov_b32 v93, v102
 s_nop 1
 v_permlane16_swap_b32 v102, v93
 v_add_f32 v102, v102, v93
 v_mov_b32 v93, v102
 s_nop 1
 v_permlane32_swap_b32 v102, v93
 v_add_f32 v102, v102, v93
 v_mul_f32 v100, 0xbb124925, v100
 v_add_f32 v101, v77, v81
 v_add_f32 v92, v85, v89
 v_add_f32 v101, v101, v92
 v_fma_f32 v94, v104, v100, v76
 v_mul_f32 v96, v94, v105
 v_fmac_f32 v101, v94, v96
 v_fma_f32 v94, v104, v100, v80
 v_mul_f32 v96, v94, v105
 v_fmac_f32 v101, v94, v96
 v_fma_f32 v94, v104, v100, v84
 v_mul_f32 v96, v94, v105
 v_fmac_f32 v101, v94, v96
 v_fma_f32 v94, v104, v100, v88
 v_mul_f32 v96, v94, v105
 v_fmac_f32 v101, v94, v96
 v_mul_f32 v102, 0xbb124925, v102
 v_add_f32 v103, v79, v83
 v_add_f32 v93, v87, v91
 v_add_f32 v103, v103, v93
 v_fma_f32 v95, v104, v102, v78
 v_mul_f32 v97, v95, v105
 v_fmac_f32 v103, v95, v97
 v_fma_f32 v95, v104, v102, v82
 v_mul_f32 v97, v95, v105
 v_fmac_f32 v103, v95, v97
 v_fma_f32 v95, v104, v102, v86
 v_mul_f32 v97, v95, v105
 v_fmac_f32 v103, v95, v97
 v_fma_f32 v95, v104, v102, v90
 v_mul_f32 v97, v95, v105
 v_fmac_f32 v103, v95, v97
 v_mov_b32 v92, v101
 s_nop 1
 v_permlane16_swap_b32 v101, v92
 v_add_f32 v101, v101, v92
 v_mov_b32 v92, v101
 s_nop 1
 v_permlane32_swap_b32 v101, v92
 v_add_f32 v101, v101, v92
 v_mov_b32 v93, v103
 s_nop 1
 v_permlane16_swap_b32 v103, v93
 v_add_f32 v103, v103, v93
 v_mov_b32 v93, v103
 s_nop 1
 v_permlane32_swap_b32 v103, v93
 v_add_f32 v103, v103, v93
 v_mov_b32 v92, 0x3727c5ac
 v_fmac_f32 v92, 0x3b124925, v101
 v_rsq_f32 v92, v92
 v_add_f32 v60, v60, v100
 v_add_f32 v61, v61, v100
 v_add_f32 v62, v62, v100
 v_add_f32 v63, v63, v100
 v_add_f32 v64, v64, v100
 v_add_f32 v65, v65, v100
 v_add_f32 v66, v66, v100
 v_add_f32 v67, v67, v100
 v_mul_f32 v60, v60, v92
 v_mul_f32 v61, v61, v92
 v_mul_f32 v62, v62, v92
 v_mul_f32 v63, v63, v92
 v_mul_f32 v64, v64, v92
 v_mul_f32 v65, v65, v92
 v_mul_f32 v66, v66, v92
 v_mul_f32 v67, v67, v92
 v_cvt_pk_bf16_f32 v52, v60, v61
 v_cvt_pk_bf16_f32 v53, v62, v63
 v_cvt_pk_bf16_f32 v54, v64, v65
 v_cvt_pk_bf16_f32 v55, v66, v67
 v_min_u32 v53, -2, v53
 v_min_u32 v55, -2, v55
 v_mov_b32 v93, 0x3727c5ac
 v_fmac_f32 v93, 0x3b124925, v103
 v_rsq_f32 v93, v93
 v_add_f32 v68, v68, v102
 v_add_f32 v69, v69, v102
 v_add_f32 v70, v70, v102
 v_add_f32 v71, v71, v102
 v_add_f32 v72, v72, v102
 v_add_f32 v73, v73, v102
 v_add_f32 v74, v74, v102
 v_add_f32 v75, v75, v102
 v_mul_f32 v68, v68, v93
 v_mul_f32 v69, v69, v93
 v_mul_f32 v70, v70, v93
 v_mul_f32 v71, v71, v93
 v_mul_f32 v72, v72, v93
 v_mul_f32 v73, v73, v93
 v_mul_f32 v74, v74, v93
 v_mul_f32 v75, v75, v93
 v_cvt_pk_bf16_f32 v56, v68, v69
 v_cvt_pk_bf16_f32 v57, v70, v71
 v_cvt_pk_bf16_f32 v58, v72, v73
 v_cvt_pk_bf16_f32 v59, v74, v75
 v_min_u32 v57, -2, v57
 v_min_u32 v59, -2, v59
 s_mul_i32 s8, s43, 28672
 s_lshl_b32 s9, s45, 10
 s_add_u32 s8, s8, s9
 s_lshl_b32 s9, s42, 9
 s_add_u32 s8, s8, s9
 s_add_u32 s9, s8, 14336
 buffer_store_dwordx4 v[52:55], v2, s[32:35], s8 offen sc1
 buffer_store_dwordx4 v[56:59], v2, s[32:35], s9 offen sc1
 s_branch ka_b3_fin
ka_w3_155:
 v_lshlrev_b32 v92, 16, v52
 v_and_b32 v93, 0xffff0000, v52
 v_lshlrev_b32 v94, 16, v53
 v_and_b32 v95, 0xffff0000, v53
 v_add_f32 v36, v36, v92
 v_add_f32 v37, v37, v93
 v_add_f32 v38, v38, v94
 v_add_f32 v39, v39, v95
 v_cvt_pk_bf16_f32 v52, v36, v37
 v_cvt_pk_bf16_f32 v53, v38, v39
 v_lshlrev_b32 v92, 16, v56
 v_and_b32 v93, 0xffff0000, v56
 v_lshlrev_b32 v94, 16, v57
 v_and_b32 v95, 0xffff0000, v57
 v_add_f32 v40, v40, v92
 v_add_f32 v41, v41, v93
 v_add_f32 v42, v42, v94
 v_add_f32 v43, v43, v95
 v_cvt_pk_bf16_f32 v56, v40, v41
 v_cvt_pk_bf16_f32 v57, v42, v43
 s_cmp_eq_u32 s3, 0
 s_cbranch_scc1 ka_l0_159
 buffer_store_dwordx2 v[52:53], v4, s[28:31], 0 offen sc1
 buffer_store_dwordx2 v[56:57], v5, s[28:31], 0 offen sc1
 s_branch ka_b3_fin
ka_l0_159:
 v_lshlrev_b32 v60, 16, v52
 v_and_b32 v61, 0xffff0000, v52
 v_lshlrev_b32 v62, 16, v53
 v_and_b32 v63, 0xffff0000, v53
 v_lshlrev_b32 v68, 16, v56
 v_and_b32 v69, 0xffff0000, v56
 v_lshlrev_b32 v70, 16, v57
 v_and_b32 v71, 0xffff0000, v57
 v_add_f32 v100, v60, v61
 v_add_f32 v92, v62, v63
 v_add_f32 v100, v100, v92
 v_add_f32 v102, v68, v69
 v_add_f32 v93, v70, v71
 v_add_f32 v102, v102, v93
 v_mov_b32 v92, v100
 s_nop 1
 v_permlane16_swap_b32 v100, v92
 v_add_f32 v100, v100, v92
 v_mov_b32 v92, v100
 s_nop 1
 v_permlane32_swap_b32 v100, v92
 v_add_f32 v100, v100, v92
 v_mov_b32 v93, v102
 s_nop 1
 v_permlane16_swap_b32 v102, v93
 v_add_f32 v102, v102, v93
 v_mov_b32 v93, v102
 s_nop 1
 v_permlane32_swap_b32 v102, v93
 v_add_f32 v102, v102, v93
 v_mul_f32 v92, 0xbd800000, v100
 v_add_f32 v94, v60, v92
 v_mul_f32 v101, v94, v94
 v_add_f32 v94, v61, v92
 v_fmac_f32 v101, v94, v94
 v_add_f32 v94, v62, v92
 v_fmac_f32 v101, v94, v94
 v_add_f32 v94, v63, v92
 v_fmac_f32 v101, v94, v94
 v_mul_f32 v93, 0xbd800000, v102
 v_add_f32 v95, v68, v93
 v_mul_f32 v103, v95, v95
 v_add_f32 v95, v69, v93
 v_fmac_f32 v103, v95, v95
 v_add_f32 v95, v70, v93
 v_fmac_f32 v103, v95, v95
 v_add_f32 v95, v71, v93
 v_fmac_f32 v103, v95, v95
 v_mov_b32 v92, v101
 s_nop 1
 v_permlane16_swap_b32 v101, v92
 v_add_f32 v101, v101, v92
 v_mov_b32 v92, v101
 s_nop 1
 v_permlane32_swap_b32 v101, v92
 v_add_f32 v101, v101, v92
 v_mov_b32 v93, v103
 s_nop 1
 v_permlane16_swap_b32 v103, v93
 v_add_f32 v103, v103, v93
 v_mov_b32 v93, v103
 s_nop 1
 v_permlane32_swap_b32 v103, v93
 v_add_f32 v103, v103, v93
 v_min_u32 v101, -2, v101
 v_min_u32 v103, -2, v103
 v_cmp_eq_u32 vcc, 1, v8
 s_nop 1
 v_cndmask_b32 v92, v100, v102, vcc
 v_cndmask_b32 v93, v101, v103, vcc
 s_lshl_b32 s9, s44, 2
 s_add_u32 s9, s9, s6
 s_lshl_b32 s9, s9, 8
 s_lshl_b32 s10, s43, 12
 s_add_u32 s9, s9, s10
 v_lshlrev_b32 v11, 4, v7
 v_lshl_add_u32 v11, v8, 3, v11
 v_mov_b32 v12, 1073741824
 v_cmp_gt_u32 vcc, 2, v8
 s_nop 1
 v_cndmask_b32 v11, v12, v11, vcc
 buffer_store_dwordx2 v[92:93], v11, s[36:39], s9 offen sc0 sc1
 s_mov_b32 s46, 0
ka_sp_160:
 buffer_load_dwordx4 v[76:79], v2, s[36:39], s10 offen offset:0 sc0 sc1
 buffer_load_dwordx4 v[80:83], v2, s[36:39], s10 offen offset:1024 sc0 sc1
 buffer_load_dwordx4 v[84:87], v2, s[36:39], s10 offen offset:2048 sc0 sc1
 buffer_load_dwordx4 v[88:91], v2, s[36:39], s10 offen offset:3072 sc0 sc1
 s_waitcnt vmcnt(0)
 v_max3_u32 v92, v77, v79, v81
 v_max3_u32 v93, v83, v85, v87
 v_max3_u32 v92, v92, v89, v91
 v_max_u32 v92, v92, v93
 v_cmp_eq_u32 vcc, -1, v92
 s_cbranch_vccz ka_sk_161
 s_add_u32 s46, s46, 1
 s_cmp_lt_u32 s46, 400000
 s_cbranch_scc0 ka_end
 s_branch ka_sp_160
ka_sk_161:
 buffer_store_dwordx2 v[52:53], v4, s[28:31], 0 offen sc1
 buffer_store_dwordx2 v[56:57], v5, s[28:31], 0 offen sc1
 v_cmp_eq_u32 vcc, 3, v8
 v_mov_b32 v104, 0x42000000
 v_mov_b32 v92, 0x41800000
 v_cndmask_b32 v104, v104, v92, vcc
 v_mov_b32 v105, 0x3d000000
 v_mov_b32 v92, 0x3d800000
 v_cndmask_b32 v105, v105, v92, vcc
 v_add_f32 v100, v76, v80
 v_add_f32 v92, v84, v88
 v_add_f32 v100, v100, v92
 v_add_f32 v102, v78, v82
 v_add_f32 v93, v86, v90
 v_add_f32 v102, v102, v93
 v_mov_b32 v92, v100
 s_nop 1
 v_permlane16_swap_b32 v100, v92
 v_add_f32 v100, v100, v92
 v_mov_b32 v92, v100
 s_nop 1
 v_permlane32_swap_b32 v100, v92
 v_add_f32 v100, v100, v92
 v_mov_b32 v93, v102
 s_nop 1
 v_permlane16_swap_b32 v102, v93
 v_add_f32 v102, v102, v93
 v_mov_b32 v93, v102
 s_nop 1
 v_permlane32_swap_b32 v102, v93
 v_add_f32 v102, v102, v93
 v_mul_f32 v100, 0xbb124925, v100
 v_add_f32 v101, v77, v81
 v_add_f32 v92, v85, v89
 v_add_f32 v101, v101, v92
 v_fma_f32 v94, v104, v100, v76
 v_mul_f32 v96, v94, v105
 v_fmac_f32 v101, v94, v96
 v_fma_f32 v94, v104, v100, v80
 v_mul_f32 v96, v94, v105
 v_fmac_f32 v101, v94, v96
 v_fma_f32 v94, v104, v100, v84
 v_mul_f32 v96, v94, v105
 v_fmac_f32 v101, v94, v96
 v_fma_f32 v94, v104, v100, v88
 v_mul_f32 v96, v94, v105
 v_fmac_f32 v101, v94, v96
 v_mul_f32 v102, 0xbb124925, v102
 v_add_f32 v103, v79, v83
 v_add_f32 v93, v87, v91
 v_add_f32 v103, v103, v93
 v_fma_f32 v95, v104, v102, v78
 v_mul_f32 v97, v95, v105
 v_fmac_f32 v103, v95, v97
 v_fma_f32 v95, v104, v102, v82
 v_mul_f32 v97, v95, v105
 v_fmac_f32 v103, v95, v97
 v_fma_f32 v95, v104, v102, v86
 v_mul_f32 v97, v95, v105
 v_fmac_f32 v103, v95, v97
 v_fma_f32 v95, v104, v102, v90
 v_mul_f32 v97, v95, v105
 v_fmac_f32 v103, v95, v97
 v_mov_b32 v92, v101
 s_nop 1
 v_permlane16_swap_b32 v101, v92
 v_add_f32 v101, v101, v92
 v_mov_b32 v92, v101
 s_nop 1
 v_permlane32_swap_b32 v101, v92
 v_add_f32 v101, v101, v92
 v_mov_b32 v93, v103
 s_nop 1
 v_permlane16_swap_b32 v103, v93
 v_add_f32 v103, v103, v93
 v_mov_b32 v93, v103
 s_nop 1
 v_permlane32_swap_b32 v103, v93
 v_add_f32 v103, v103, v93
 v_mov_b32 v92, 0x3727c5ac
 v_fmac_f32 v92, 0x3b124925, v101
 v_rsq_f32 v92, v92
 v_add_f32 v60, v60, v100
 v_add_f32 v61, v61, v100
 v_add_f32 v62, v62, v100
 v_add_f32 v63, v63, v100
 v_mul_f32 v60, v60, v92
 v_mul_f32 v61, v61, v92
 v_mul_f32 v62, v62, v92
 v_mul_f32 v63, v63, v92
 v_cvt_pk_bf16_f32 v52, v60, v61
 v_cvt_pk_bf16_f32 v53, v62, v63
 v_min_u32 v53, -2, v53
 v_mov_b32 v93, 0x3727c5ac
 v_fmac_f32 v93, 0x3b124925, v103
 v_rsq_f32 v93, v93
 v_add_f32 v68, v68, v102
 v_add_f32 v69, v69, v102
 v_add_f32 v70, v70, v102
 v_add_f32 v71, v71, v102
 v_mul_f32 v68, v68, v93
 v_mul_f32 v69, v69, v93
 v_mul_f32 v70, v70, v93
 v_mul_f32 v71, v71, v93
 v_cvt_pk_bf16_f32 v56, v68, v69
 v_cvt_pk_bf16_f32 v57, v70, v71
 v_min_u32 v57, -2, v57
 s_mul_i32 s8, s43, 28672
 s_lshl_b32 s9, s45, 10
 s_add_u32 s8, s8, s9
 s_lshl_b32 s9, s42, 9
 s_add_u32 s8, s8, s9
 s_add_u32 s9, s8, 14336
 v_lshrrev_b32 v11, 1, v8
 v_lshl_add_u32 v11, v11, 4, v7
 v_lshlrev_b32 v11, 4, v11
 v_and_b32 v12, 1, v8
 v_lshl_add_u32 v11, v12, 3, v11
 buffer_store_dwordx2 v[52:53], v11, s[32:35], s8 offen sc1
 buffer_store_dwordx2 v[56:57], v11, s[32:35], s9 offen sc1
ka_b3_fin:
 s_cmp_eq_u32 s3, 0
 s_cbranch_scc0 ka_fin_162
 s_add_u32 s52, s4, 117448704
 s_addc_u32 s53, s5, 0
 s_mov_b32 s54, 4096
 s_mov_b32 s55, 0x20000
 s_lshl_b32 s8, s43, 6
 s_lshl_b32 s9, s44, 2
 s_add_u32 s8, s8, s9
 s_waitcnt vmcnt(0)
 s_barrier
 s_cmp_lg_u32 s6, 0
 s_cbranch_scc1 pf_163
 v_and_b32 v11, 63, v0
 v_lshlrev_b32 v11, 2, v11
 v_mov_b32 v12, 1
 s_mov_b64 exec, 1
 buffer_store_dword v12, v11, s[52:55], s8 offen sc1
 s_mov_b64 exec, -1
pf_163:
 s_cmp_ge_u32 s43, 24
 s_cbranch_scc1 ka_again
 s_add_u32 s43, s43, 40
 s_branch ka_b3_top
ka_fin_162:
 s_waitcnt vmcnt(0)
 s_branch ka_end
ka_again:
 s_waitcnt vmcnt(0) lgkmcnt(0)
 s_barrier
 s_mov_b32 s3, 1
 s_add_u32 s76, s76, 46661632
 s_addc_u32 s77, s77, 0
 s_mov_b32 s8, s92
 s_mov_b32 s7, s95
 s_branch ka_disp
ka_end:
 s_endpgm
.section .rodata,"a"
.p2align 6
.amdhsa_kernel interleave_layers__memory_aug_recurrent_mem_tr__spectral_gfnet__prompt_kernel
  .amdhsa_next_free_vgpr 512
  .amdhsa_next_free_sgpr 102
  .amdhsa_accum_offset 256
  .amdhsa_group_segment_fixed_size 0
  .amdhsa_kernarg_size 104
  .amdhsa_user_sgpr_count 2
  .amdhsa_user_sgpr_kernarg_segment_ptr 1
  .amdhsa_system_sgpr_workgroup_id_x 1
.end_amdhsa_kernel
```
